```python
import torch

def _softmax(x, axis=-1):
    return torch.softmax(x, dim=axis)

def _gelu(x):
    return torch.nn.functional.gelu(x, approximate='tanh')

def _silu(x):
    return torch.nn.functional.silu(x)

def _sigmoid(x):
    return torch.sigmoid(x)

def _layernorm(x, axis=-1, eps=1e-05):
    m = x.mean(dim=axis, keepdim=True)
    v = x.var(dim=axis, keepdim=True, unbiased=False)
    return (x - m) / torch.sqrt(v + eps)

def _scatter_add(tgt, idx, src, axis=0):
    return tgt.clone().index_add_(axis, idx, src)

def _segment_sum(src, seg, n):
    out = torch.zeros((n,) + src.shape[1:], dtype=src.dtype)
    return out.index_add_(0, seg, src)

def _pad(x, pw):
    flat = tuple((v for pair in reversed(pw) for v in pair))
    return torch.nn.functional.pad(x, flat)
kernel_name = 'adaLN_cond__grouped_kv_mqa__glu_gated_reglu__prompt'

def setup_inputs():

    _w = lambda a: (lambda t: t.to(torch.bfloat16) if t.is_floating_point() else t)(torch.as_tensor(a))

    def _A_setup():
        B, S, D, H = (1, 2048, 512, 32)
        Dh = D // H
        return {'x': _w((lambda *s: torch.randn(*s, dtype=torch.bfloat16) * 0.05)(B, S, D)), 'wq': _w((lambda *s: torch.randn(*s, dtype=torch.bfloat16) * 0.05)(D, H * Dh)), 'wk': _w((lambda *s: torch.randn(*s, dtype=torch.bfloat16) * 0.05)(D, Dh)), 'wv': _w((lambda *s: torch.randn(*s, dtype=torch.bfloat16) * 0.05)(D, Dh)), 'wo': _w((lambda *s: torch.randn(*s, dtype=torch.bfloat16) * 0.05)(H * Dh, D))}
    _A_in = _A_setup()

    def _B_setup():
        B, S, D, F = (1, 2048, 512, 1376)
        return {'x': _w((lambda *s: torch.randn(*s, dtype=torch.bfloat16) * 0.05)(B, S, D)), 'W_gate': _w((lambda *s: torch.randn(*s, dtype=torch.bfloat16) * 0.8)(D, F) * (2.0 / D) ** 0.5), 'W_up': _w((lambda *s: torch.randn(*s, dtype=torch.bfloat16) * 0.8)(D, F) * (2.0 / D) ** 0.5), 'W_down': _w((lambda *s: torch.randn(*s, dtype=torch.bfloat16) * 0.8)(F, D) * (1.0 / F) ** 0.5)}
    _B_in = _B_setup()
    return {'A_x': _A_in['x'], 'A_wq': _A_in['wq'], 'A_wk': _A_in['wk'], 'A_wv': _A_in['wv'], 'A_wo': _A_in['wo'], 'B_x': _B_in['x'], 'B_W_gate': _B_in['W_gate'], 'B_W_up': _B_in['W_up'], 'B_W_down': _B_in['W_down'], 'c': _w((lambda *s: torch.randn(*s, dtype=torch.bfloat16) * 0.2)(1, 512) * 8.0), 'w_mod': _w((lambda *s: torch.randn(*s, dtype=torch.bfloat16) * 0.2)(512, 6 * 512) * 512 ** (-0.5) * 8.0)}

def reference(A_x, A_wq, A_wk, A_wv, A_wo, B_x, B_W_gate, B_W_up, B_W_down, c, w_mod):

    def _A_ref(x, wq, wk, wv, wo):
        B, S, D = x.shape
        H = 32
        Dh = D // H
        q = (lambda x, *d: x.permute(*d))((x @ wq).reshape(B, S, H, Dh), 0, 2, 1, 3)
        k = x @ wk
        v = x @ wv
        scores = torch.einsum('bhqd,bkd->bhqk', q, k) * Dh ** (-0.5)
        p = _softmax(scores, axis=-1)
        o = torch.einsum('bhqk,bkd->bhqd', p, v)
        return (lambda x, *d: x.permute(*d))(o, 0, 2, 1, 3).reshape(B, S, H * Dh) @ wo

    def _B_ref(x, W_gate, W_up, W_down):
        gate = torch.einsum('bsd,df->bsf', x, W_gate)
        up = torch.einsum('bsd,df->bsf', x, W_up)
        gate = gate * (lambda x, dt: x.to(dt))(gate > 0, gate.dtype)
        h = gate * up
        return torch.einsum('bsf,fd->bsd', h, W_down)
    x = A_x
    mod = (_silu(c) @ w_mod).reshape(c.shape[0], 6, 1, -1)
    sa, ca, ga, sb, cb, gb = (mod[:, 0].clone(), mod[:, 1].clone(), mod[:, 2].clone(), mod[:, 3].clone(), mod[:, 4].clone(), mod[:, 5].clone())
    h = _layernorm(x, axis=-1) * (1 + ca) + sa
    x = x + ga * _A_ref(h, A_wq, A_wk, A_wv, A_wo)
    h = _layernorm(x, axis=-1) * (1 + cb) + sb
    x = x + gb * _B_ref(h, B_W_gate, B_W_up, B_W_down)
    return x
```

```asm
; @launch grid=(256,1,1) block=(256,1,1) lds=163840
.amdgcn_target "amdgcn-amd-amdhsa--gfx950"
.text
.globl adaLN_cond__grouped_kv_mqa__glu_gated_reglu__prompt_kernel
.p2align 8
.type adaLN_cond__grouped_kv_mqa__glu_gated_reglu__prompt_kernel,@function
adaLN_cond__grouped_kv_mqa__glu_gated_reglu__prompt_kernel:
    s_cmp_ge_u32 s2, 256
    s_cbranch_scc1 L_end
    s_load_dwordx16 s[44:59], s[0:1], 0
    s_load_dwordx8 s[60:67], s[0:1], 64
    s_load_dwordx2 s[8:9], s[0:1], 104
    v_lshrrev_b32 v3, 6, v0
    v_and_b32 v1, 63, v0
    v_readfirstlane_b32 s32, v3
    v_lshlrev_b32 v2, 4, v1
    s_lshr_b32 s34, s2, 3
    s_and_b32 s34, s34, 7
    s_lshr_b32 s33, s2, 6
    s_sub_u32 s3, s34, 3
    s_cmp_gt_u32 s3, 1
    s_cbranch_scc1 L_nocode
    s_getpc_b64 s[38:39]
L_pc:
    s_lshl_b32 s3, s3, 2
    s_add_u32 s3, s3, s33
    s_mul_i32 s3, s3, 6144
    v_mul_u32_u24 v4, 24, v0
    v_add_u32 v4, s3, v4
    v_min_u32 v4, L_end-L_pc, v4
    global_load_dword v5, v4, s[38:39]
L_nocode:
    s_lshl_b32 s33, s33, 3
    s_and_b32 s3, s2, 7
    s_add_u32 s33, s33, s3
    s_and_b32 s36, s32, 1
    s_lshr_b32 s37, s32, 1
    s_mov_b32 s10, 33554432
    s_mov_b32 s11, 0x20000
    s_bfe_u32 s38, s2, 0x10007
    s_lshl_b32 s39, s38, 2
    s_xor_b32 s3, s3, s39
    s_lshl_b32 s38, s38, 3
    s_add_u32 s3, s3, s38
    s_lshl_b32 s3, s3, 1
    s_bfe_u32 s38, s2, 0x10006
    s_add_u32 s41, s3, s38
    v_lshrrev_b32 v89, 2, v0
    v_and_b32 v90, 3, v0
    v_lshlrev_b32 v91, 2, v89
    v_lshl_add_u32 v91, v90, 8, v91
    v_mul_u32_u24 v89, 12288, v89
    v_lshl_add_u32 v89, v90, 4, v89
    s_lshl_b32 s42, s41, 6
    s_and_b32 s38, s34, 1
    s_lshl_b32 s38, s38, 15
    s_lshl_b32 s43, s33, 16
    s_lshl_b32 s40, s32, 13
    s_add_u32 s43, s43, s40
    s_add_u32 s43, s43, s38
    s_waitcnt lgkmcnt(0)
    s_mov_b32 s28, s64
    s_mov_b32 s29, s65
    s_mov_b32 s30, 3145728
    s_mov_b32 s31, 0x20000
    s_mov_b32 s4, s62
    s_mov_b32 s5, s63
    s_mov_b32 s6, 1024
    s_mov_b32 s7, 0x20000
    s_mov_b32 s20, s44
    s_mov_b32 s21, s45
    s_mov_b32 s22, 2097152
    s_mov_b32 s23, 0x20000
    s_cmp_lg_u32 s34, 2
    s_cbranch_scc1 L_not_crit
    buffer_load_dword v88, v91, s[4:7], 0 offen
    buffer_load_dwordx4 v[32:35], v89, s[28:31], s42 offen
    s_add_u32 s42, s42, 6144
    buffer_load_dwordx4 v[36:39], v89, s[28:31], s42 offen
    s_add_u32 s42, s42, 780288
    buffer_load_dwordx4 v[40:43], v89, s[28:31], s42 offen
    s_add_u32 s42, s42, 6144
    buffer_load_dwordx4 v[44:47], v89, s[28:31], s42 offen
    s_add_u32 s42, s42, 780288
    buffer_load_dwordx4 v[48:51], v89, s[28:31], s42 offen
    s_add_u32 s42, s42, 6144
    buffer_load_dwordx4 v[52:55], v89, s[28:31], s42 offen
    s_add_u32 s42, s42, 780288
    buffer_load_dwordx4 v[56:59], v89, s[28:31], s42 offen
    s_add_u32 s42, s42, 6144
    buffer_load_dwordx4 v[60:63], v89, s[28:31], s42 offen
    buffer_load_dword v7, off, s[8:11], 0 offset:0 sc1
    s_waitcnt vmcnt(9)
    v_lshlrev_b32 v8, 16, v88
    v_and_b32 v9, 0xffff0000, v88
    v_mul_f32 v10, 0xbfb8aa3b, v8
    v_mul_f32 v11, 0xbfb8aa3b, v9
    v_exp_f32 v10, v10
    v_exp_f32 v11, v11
    v_mov_b32 v12, 0
    v_mov_b32 v13, 0
    v_mov_b32 v14, 0
    v_mov_b32 v15, 0
    v_mov_b32 v16, 0
    v_mov_b32 v17, 0
    v_mov_b32 v18, 0
    v_mov_b32 v19, 0
    v_add_f32 v10, 1.0, v10
    v_add_f32 v11, 1.0, v11
    v_rcp_f32 v10, v10
    v_rcp_f32 v11, v11
    s_mov_b32 s38, 0x05040100
    s_mov_b32 s39, 0x07060302
    v_mul_f32 v8, v8, v10
    v_mul_f32 v9, v9, v11
    v_cvt_pk_bf16_f32 v8, v8, v9
    s_waitcnt vmcnt(7)
    v_perm_b32 v20, v36, v32, s38
    v_perm_b32 v21, v36, v32, s39
    v_perm_b32 v22, v37, v33, s38
    v_perm_b32 v23, v37, v33, s39
    v_perm_b32 v24, v38, v34, s38
    v_perm_b32 v25, v38, v34, s39
    v_perm_b32 v26, v39, v35, s38
    v_perm_b32 v27, v39, v35, s39
    v_dot2c_f32_bf16_dpp v12, v8, v20 quad_perm:[0,0,0,0] row_mask:0xf bank_mask:0xf
    v_dot2c_f32_bf16_dpp v13, v8, v21 quad_perm:[0,0,0,0] row_mask:0xf bank_mask:0xf
    v_dot2c_f32_bf16_dpp v14, v8, v22 quad_perm:[0,0,0,0] row_mask:0xf bank_mask:0xf
    v_dot2c_f32_bf16_dpp v15, v8, v23 quad_perm:[0,0,0,0] row_mask:0xf bank_mask:0xf
    v_dot2c_f32_bf16_dpp v16, v8, v24 quad_perm:[0,0,0,0] row_mask:0xf bank_mask:0xf
    v_dot2c_f32_bf16_dpp v17, v8, v25 quad_perm:[0,0,0,0] row_mask:0xf bank_mask:0xf
    v_dot2c_f32_bf16_dpp v18, v8, v26 quad_perm:[0,0,0,0] row_mask:0xf bank_mask:0xf
    v_dot2c_f32_bf16_dpp v19, v8, v27 quad_perm:[0,0,0,0] row_mask:0xf bank_mask:0xf
    s_waitcnt vmcnt(5)
    v_perm_b32 v20, v44, v40, s38
    v_perm_b32 v21, v44, v40, s39
    v_perm_b32 v22, v45, v41, s38
    v_perm_b32 v23, v45, v41, s39
    v_perm_b32 v24, v46, v42, s38
    v_perm_b32 v25, v46, v42, s39
    v_perm_b32 v26, v47, v43, s38
    v_perm_b32 v27, v47, v43, s39
    v_dot2c_f32_bf16_dpp v12, v8, v20 quad_perm:[1,1,1,1] row_mask:0xf bank_mask:0xf
    v_dot2c_f32_bf16_dpp v13, v8, v21 quad_perm:[1,1,1,1] row_mask:0xf bank_mask:0xf
    v_dot2c_f32_bf16_dpp v14, v8, v22 quad_perm:[1,1,1,1] row_mask:0xf bank_mask:0xf
    v_dot2c_f32_bf16_dpp v15, v8, v23 quad_perm:[1,1,1,1] row_mask:0xf bank_mask:0xf
    v_dot2c_f32_bf16_dpp v16, v8, v24 quad_perm:[1,1,1,1] row_mask:0xf bank_mask:0xf
    v_dot2c_f32_bf16_dpp v17, v8, v25 quad_perm:[1,1,1,1] row_mask:0xf bank_mask:0xf
    v_dot2c_f32_bf16_dpp v18, v8, v26 quad_perm:[1,1,1,1] row_mask:0xf bank_mask:0xf
    v_dot2c_f32_bf16_dpp v19, v8, v27 quad_perm:[1,1,1,1] row_mask:0xf bank_mask:0xf
    s_waitcnt vmcnt(3)
    v_perm_b32 v20, v52, v48, s38
    v_perm_b32 v21, v52, v48, s39
    v_perm_b32 v22, v53, v49, s38
    v_perm_b32 v23, v53, v49, s39
    v_perm_b32 v24, v54, v50, s38
    v_perm_b32 v25, v54, v50, s39
    v_perm_b32 v26, v55, v51, s38
    v_perm_b32 v27, v55, v51, s39
    v_dot2c_f32_bf16_dpp v12, v8, v20 quad_perm:[2,2,2,2] row_mask:0xf bank_mask:0xf
    v_dot2c_f32_bf16_dpp v13, v8, v21 quad_perm:[2,2,2,2] row_mask:0xf bank_mask:0xf
    v_dot2c_f32_bf16_dpp v14, v8, v22 quad_perm:[2,2,2,2] row_mask:0xf bank_mask:0xf
    v_dot2c_f32_bf16_dpp v15, v8, v23 quad_perm:[2,2,2,2] row_mask:0xf bank_mask:0xf
    v_dot2c_f32_bf16_dpp v16, v8, v24 quad_perm:[2,2,2,2] row_mask:0xf bank_mask:0xf
    v_dot2c_f32_bf16_dpp v17, v8, v25 quad_perm:[2,2,2,2] row_mask:0xf bank_mask:0xf
    v_dot2c_f32_bf16_dpp v18, v8, v26 quad_perm:[2,2,2,2] row_mask:0xf bank_mask:0xf
    v_dot2c_f32_bf16_dpp v19, v8, v27 quad_perm:[2,2,2,2] row_mask:0xf bank_mask:0xf
    s_waitcnt vmcnt(1)
    v_perm_b32 v20, v60, v56, s38
    v_perm_b32 v21, v60, v56, s39
    v_perm_b32 v22, v61, v57, s38
    v_perm_b32 v23, v61, v57, s39
    v_perm_b32 v24, v62, v58, s38
    v_perm_b32 v25, v62, v58, s39
    v_perm_b32 v26, v63, v59, s38
    v_perm_b32 v27, v63, v59, s39
    v_dot2c_f32_bf16_dpp v12, v8, v20 quad_perm:[3,3,3,3] row_mask:0xf bank_mask:0xf
    v_dot2c_f32_bf16_dpp v13, v8, v21 quad_perm:[3,3,3,3] row_mask:0xf bank_mask:0xf
    v_dot2c_f32_bf16_dpp v14, v8, v22 quad_perm:[3,3,3,3] row_mask:0xf bank_mask:0xf
    v_dot2c_f32_bf16_dpp v15, v8, v23 quad_perm:[3,3,3,3] row_mask:0xf bank_mask:0xf
    v_dot2c_f32_bf16_dpp v16, v8, v24 quad_perm:[3,3,3,3] row_mask:0xf bank_mask:0xf
    v_dot2c_f32_bf16_dpp v17, v8, v25 quad_perm:[3,3,3,3] row_mask:0xf bank_mask:0xf
    v_dot2c_f32_bf16_dpp v18, v8, v26 quad_perm:[3,3,3,3] row_mask:0xf bank_mask:0xf
    v_dot2c_f32_bf16_dpp v19, v8, v27 quad_perm:[3,3,3,3] row_mask:0xf bank_mask:0xf
    v_permlane32_swap_b32 v12, v16
    v_permlane32_swap_b32 v13, v17
    v_permlane32_swap_b32 v14, v18
    v_permlane32_swap_b32 v15, v19
    v_add_f32 v12, v12, v16
    v_add_f32 v13, v13, v17
    v_add_f32 v14, v14, v18
    v_add_f32 v15, v15, v19
    v_lshrrev_b32 v8, 4, v1
    v_permlane16_swap_b32 v12, v14
    v_permlane16_swap_b32 v13, v15
    v_add_f32 v12, v12, v14
    v_add_f32 v13, v13, v15
    v_and_b32 v9, 3, v1
    v_lshl_add_u32 v8, v9, 2, v8
    v_add_f32_dpp v12, v12, v12 row_ror:8 row_mask:0xf bank_mask:0xf
    v_add_f32_dpp v13, v13, v13 row_ror:8 row_mask:0xf bank_mask:0xf
    s_lshl_b32 s38, s32, 7
    v_lshl_add_u32 v8, v8, 3, s38
    v_add_f32_dpp v12, v12, v12 row_ror:4 row_mask:0xf bank_mask:0xf
    v_add_f32_dpp v13, v13, v13 row_ror:4 row_mask:0xf bank_mask:0xf
    v_add_u32 v8, 138240, v8
    ds_write_b64 v8, v[12:13]
    s_waitcnt vmcnt(0)
    v_readfirstlane_b32 s35, v7
    s_nop 0
    s_mul_i32 s35, s35, 1664525
    s_add_u32 s35, s35, 1013904223
    s_waitcnt lgkmcnt(0)
    s_barrier
    s_cmp_lg_u32 s32, 0
    s_cbranch_scc1 L_crit_done
    v_and_b32 v8, 15, v1
    v_lshlrev_b32 v8, 3, v8
    v_add_u32 v9, 138240, v8
    ds_read_b64 v[10:11], v9 offset:0
    ds_read_b64 v[12:13], v9 offset:128
    ds_read_b64 v[14:15], v9 offset:256
    ds_read_b64 v[16:17], v9 offset:384
    s_lshr_b32 s38, s41, 4
    s_cmp_eq_u32 s38, 1
    s_cselect_b32 s39, 1.0, 0
    s_lshl_b32 s38, s41, 7
    s_add_u32 s38, s38, 4096
    s_waitcnt lgkmcnt(2)
    v_pk_add_f32 v[10:11], v[10:11], v[12:13]
    s_waitcnt lgkmcnt(0)
    v_pk_add_f32 v[14:15], v[14:15], v[16:17]
    v_pk_add_f32 v[10:11], v[10:11], v[14:15]
    v_cvt_pk_bf16_f32 v10, v10, v11
    v_mov_b32 v13, s35
    v_and_b32 v11, 0xffff0000, v10
    v_lshlrev_b32 v10, 16, v10
    v_add_f32 v11, s39, v11
    v_add_f32 v10, s39, v10
    v_cvt_pk_bf16_f32 v12, v10, v11
    s_mov_b64 exec, 0xffff
    buffer_store_dwordx2 v[12:13], v8, s[8:11], s38 offen sc1
    s_mov_b64 exec, -1
L_crit_done:
    s_barrier
    buffer_load_dwordx4 v[192:195], v2, s[20:23], s43 offen offset:0
    buffer_load_dwordx4 v[196:199], v2, s[20:23], s43 offen offset:1024
    buffer_load_dwordx4 v[200:203], v2, s[20:23], s43 offen offset:2048
    buffer_load_dwordx4 v[204:207], v2, s[20:23], s43 offen offset:3072
    s_add_u32 s43, s43, 4096
    buffer_load_dwordx4 v[208:211], v2, s[20:23], s43 offen offset:0
    buffer_load_dwordx4 v[212:215], v2, s[20:23], s43 offen offset:1024
    buffer_load_dwordx4 v[216:219], v2, s[20:23], s43 offen offset:2048
    buffer_load_dwordx4 v[220:223], v2, s[20:23], s43 offen offset:3072
    s_xor_b32 s43, s43, 0x9000
    buffer_load_dwordx4 v[224:227], v2, s[20:23], s43 offen offset:0
    buffer_load_dwordx4 v[228:231], v2, s[20:23], s43 offen offset:1024
    buffer_load_dwordx4 v[232:235], v2, s[20:23], s43 offen offset:2048
    buffer_load_dwordx4 v[236:239], v2, s[20:23], s43 offen offset:3072
    s_add_u32 s43, s43, 4096
    buffer_load_dwordx4 v[240:243], v2, s[20:23], s43 offen offset:0
    buffer_load_dwordx4 v[244:247], v2, s[20:23], s43 offen offset:1024
    buffer_load_dwordx4 v[248:251], v2, s[20:23], s43 offen offset:2048
    buffer_load_dwordx4 v[252:255], v2, s[20:23], s43 offen offset:3072
    s_branch L_ln
L_not_crit:
    s_sub_u32 s38, s34, 4
    s_cmp_gt_u32 s38, 3
    s_cbranch_scc1 L_notw
    s_lshl_b32 s38, s38, 5
    s_add_u32 s38, s38, s33
    s_lshl_b32 s38, s38, 2
    s_add_u32 s38, s38, s32
    s_lshl_b32 s39, s38, 10
    s_mul_i32 s38, s38, 6144
    v_and_b32 v4, 15, v1
    v_lshlrev_b32 v4, 7, v4
    buffer_load_dword v10, v4, s[28:31], s38 offen
    s_mov_b32 s12, s46
    s_mov_b32 s13, s47
    s_mov_b32 s14, 524288
    s_mov_b32 s15, 0x20000
    v_and_b32 v4, 0x380, v4
    buffer_load_dword v9, v4, s[12:15], s39 offen
L_notw:
    buffer_load_dwordx4 v[192:195], v2, s[20:23], s43 offen offset:0
    buffer_load_dwordx4 v[196:199], v2, s[20:23], s43 offen offset:1024
    buffer_load_dwordx4 v[200:203], v2, s[20:23], s43 offen offset:2048
    buffer_load_dwordx4 v[204:207], v2, s[20:23], s43 offen offset:3072
    s_add_u32 s43, s43, 4096
    buffer_load_dwordx4 v[208:211], v2, s[20:23], s43 offen offset:0
    buffer_load_dwordx4 v[212:215], v2, s[20:23], s43 offen offset:1024
    buffer_load_dwordx4 v[216:219], v2, s[20:23], s43 offen offset:2048
    buffer_load_dwordx4 v[220:223], v2, s[20:23], s43 offen offset:3072
    s_xor_b32 s43, s43, 0x9000
    buffer_load_dwordx4 v[224:227], v2, s[20:23], s43 offen offset:0
    buffer_load_dwordx4 v[228:231], v2, s[20:23], s43 offen offset:1024
    buffer_load_dwordx4 v[232:235], v2, s[20:23], s43 offen offset:2048
    buffer_load_dwordx4 v[236:239], v2, s[20:23], s43 offen offset:3072
    s_add_u32 s43, s43, 4096
    buffer_load_dwordx4 v[240:243], v2, s[20:23], s43 offen offset:0
    buffer_load_dwordx4 v[244:247], v2, s[20:23], s43 offen offset:1024
    buffer_load_dwordx4 v[248:251], v2, s[20:23], s43 offen offset:2048
    buffer_load_dwordx4 v[252:255], v2, s[20:23], s43 offen offset:3072
    buffer_load_dword v7, off, s[8:11], 0 offset:0 sc1
    s_cmp_le_u32 s34, 4
    s_cbranch_scc1 L_ln
    s_sub_u32 s38, s34, 5
    s_lshl_b32 s38, s38, 5
    s_add_u32 s38, s38, s33
    s_lshl_b32 s38, s38, 2
    s_add_u32 s38, s38, s32
    s_cmp_lt_u32 s38, 352
    s_cselect_b32 s40, 1409024, 0
    s_mov_b32 s28, s56
    s_mov_b32 s29, s57
    s_mov_b32 s30, s40
    s_mov_b32 s31, 0x20000
    s_mov_b32 s4, s58
    s_mov_b32 s5, s59
    s_mov_b32 s6, s40
    s_mov_b32 s7, 0x20000
    s_lshr_b32 s3, s38, 5
    s_and_b32 s38, s38, 31
    s_mul_i32 s41, s38, 44032
    s_lshl_b32 s39, s3, 8
    s_add_u32 s41, s41, s39
    s_lshl_b32 s42, s3, 18
    s_lshl_b32 s38, s38, 10
    s_add_u32 s42, s42, s38
    s_add_u32 s42, s42, 1048576
L_ln:
    s_mov_b32 s24, s66
    s_mov_b32 s25, s67
    s_mov_b32 s26, 2097152
    s_mov_b32 s27, 0x20000
    s_mov_b32 s16, s8
    s_mov_b32 s17, s9
    s_mov_b32 s18, 33554432
    s_mov_b32 s19, 0x20000
    s_mov_b32 s12, s46
    s_mov_b32 s13, s47
    s_mov_b32 s14, 524288
    s_mov_b32 s15, 0x20000
    v_lshrrev_b32 v6, 3, v1
    v_lshrrev_b32 v4, 2, v1
    v_and_b32 v4, 4, v4
    v_xor_b32 v4, v4, v1
    v_and_b32 v4, 7, v4
    v_lshlrev_b32 v4, 4, v4
    v_lshl_add_u32 v6, v6, 10, v4
    s_lshl_b32 s38, s32, 17
    s_cmp_eq_u32 s34, 3
    s_cselect_b32 s39, 5, s34
    s_cmp_eq_u32 s34, 5
    s_cselect_b32 s39, 3, s39
    s_lshl_b32 s39, s39, 7
    s_add_u32 s38, s38, s39
    s_lshl_b32 s39, s32, 14
    v_mov_b32 v3, 0x3f803f80
    s_waitcnt vmcnt(15)
    v_dot2_f32_bf16 v96, v192, v3, 0
    v_dot2_f32_bf16 v112, v192, v192, 0
    s_waitcnt vmcnt(14)
    v_dot2_f32_bf16 v97, v196, v3, 0
    v_dot2_f32_bf16 v113, v196, v196, 0
    v_dot2c_f32_bf16 v96, v193, v3
    v_dot2c_f32_bf16 v112, v193, v193
    v_dot2c_f32_bf16 v96, v194, v3
    v_dot2c_f32_bf16 v112, v194, v194
    v_dot2c_f32_bf16 v96, v195, v3
    v_dot2c_f32_bf16 v112, v195, v195
    v_lshlrev_b32 v128, 16, v192
    v_and_b32 v129, 0xffff0000, v192
    v_lshlrev_b32 v130, 16, v193
    v_and_b32 v131, 0xffff0000, v193
    v_lshlrev_b32 v132, 16, v194
    v_and_b32 v133, 0xffff0000, v194
    v_lshlrev_b32 v134, 16, v195
    v_and_b32 v135, 0xffff0000, v195
    s_waitcnt vmcnt(13)
    v_dot2_f32_bf16 v98, v200, v3, 0
    v_dot2_f32_bf16 v114, v200, v200, 0
    v_dot2c_f32_bf16 v97, v197, v3
    v_dot2c_f32_bf16 v113, v197, v197
    v_dot2c_f32_bf16 v97, v198, v3
    v_dot2c_f32_bf16 v113, v198, v198
    v_dot2c_f32_bf16 v97, v199, v3
    v_dot2c_f32_bf16 v113, v199, v199
    v_lshlrev_b32 v136, 16, v196
    v_and_b32 v137, 0xffff0000, v196
    v_lshlrev_b32 v138, 16, v197
    v_and_b32 v139, 0xffff0000, v197
    v_lshlrev_b32 v140, 16, v198
    v_and_b32 v141, 0xffff0000, v198
    v_lshlrev_b32 v142, 16, v199
    v_and_b32 v143, 0xffff0000, v199
    s_waitcnt vmcnt(12)
    v_dot2_f32_bf16 v99, v204, v3, 0
    v_dot2_f32_bf16 v115, v204, v204, 0
    v_dot2c_f32_bf16 v98, v201, v3
    v_dot2c_f32_bf16 v114, v201, v201
    v_dot2c_f32_bf16 v98, v202, v3
    v_dot2c_f32_bf16 v114, v202, v202
    v_dot2c_f32_bf16 v98, v203, v3
    v_dot2c_f32_bf16 v114, v203, v203
    v_lshlrev_b32 v144, 16, v200
    v_and_b32 v145, 0xffff0000, v200
    v_lshlrev_b32 v146, 16, v201
    v_and_b32 v147, 0xffff0000, v201
    v_lshlrev_b32 v148, 16, v202
    v_and_b32 v149, 0xffff0000, v202
    v_lshlrev_b32 v150, 16, v203
    v_and_b32 v151, 0xffff0000, v203
    s_waitcnt vmcnt(11)
    v_dot2_f32_bf16 v100, v208, v3, 0
    v_dot2_f32_bf16 v116, v208, v208, 0
    v_dot2c_f32_bf16 v99, v205, v3
    v_dot2c_f32_bf16 v115, v205, v205
    v_dot2c_f32_bf16 v99, v206, v3
    v_dot2c_f32_bf16 v115, v206, v206
    v_dot2c_f32_bf16 v99, v207, v3
    v_dot2c_f32_bf16 v115, v207, v207
    v_lshlrev_b32 v152, 16, v204
    v_and_b32 v153, 0xffff0000, v204
    v_lshlrev_b32 v154, 16, v205
    v_and_b32 v155, 0xffff0000, v205
    v_lshlrev_b32 v156, 16, v206
    v_and_b32 v157, 0xffff0000, v206
    v_lshlrev_b32 v158, 16, v207
    v_and_b32 v159, 0xffff0000, v207
    s_waitcnt vmcnt(10)
    v_dot2_f32_bf16 v101, v212, v3, 0
    v_dot2_f32_bf16 v117, v212, v212, 0
    v_dot2c_f32_bf16 v100, v209, v3
    v_dot2c_f32_bf16 v116, v209, v209
    v_dot2c_f32_bf16 v100, v210, v3
    v_dot2c_f32_bf16 v116, v210, v210
    v_dot2c_f32_bf16 v100, v211, v3
    v_dot2c_f32_bf16 v116, v211, v211
    v_lshlrev_b32 v160, 16, v208
    v_and_b32 v161, 0xffff0000, v208
    v_lshlrev_b32 v162, 16, v209
    v_and_b32 v163, 0xffff0000, v209
    v_lshlrev_b32 v164, 16, v210
    v_and_b32 v165, 0xffff0000, v210
    v_lshlrev_b32 v166, 16, v211
    v_and_b32 v167, 0xffff0000, v211
    s_waitcnt vmcnt(9)
    v_dot2_f32_bf16 v102, v216, v3, 0
    v_dot2_f32_bf16 v118, v216, v216, 0
    v_dot2c_f32_bf16 v101, v213, v3
    v_dot2c_f32_bf16 v117, v213, v213
    v_dot2c_f32_bf16 v101, v214, v3
    v_dot2c_f32_bf16 v117, v214, v214
    v_dot2c_f32_bf16 v101, v215, v3
    v_dot2c_f32_bf16 v117, v215, v215
    v_lshlrev_b32 v168, 16, v212
    v_and_b32 v169, 0xffff0000, v212
    v_lshlrev_b32 v170, 16, v213
    v_and_b32 v171, 0xffff0000, v213
    v_lshlrev_b32 v172, 16, v214
    v_and_b32 v173, 0xffff0000, v214
    v_lshlrev_b32 v174, 16, v215
    v_and_b32 v175, 0xffff0000, v215
    s_waitcnt vmcnt(8)
    v_dot2_f32_bf16 v103, v220, v3, 0
    v_dot2_f32_bf16 v119, v220, v220, 0
    v_dot2c_f32_bf16 v102, v217, v3
    v_dot2c_f32_bf16 v118, v217, v217
    v_dot2c_f32_bf16 v102, v218, v3
    v_dot2c_f32_bf16 v118, v218, v218
    v_dot2c_f32_bf16 v102, v219, v3
    v_dot2c_f32_bf16 v118, v219, v219
    v_lshlrev_b32 v176, 16, v216
    v_and_b32 v177, 0xffff0000, v216
    v_lshlrev_b32 v178, 16, v217
    v_and_b32 v179, 0xffff0000, v217
    v_lshlrev_b32 v180, 16, v218
    v_and_b32 v181, 0xffff0000, v218
    v_lshlrev_b32 v182, 16, v219
    v_and_b32 v183, 0xffff0000, v219
    s_waitcnt vmcnt(7)
    v_dot2_f32_bf16 v104, v224, v3, 0
    v_dot2_f32_bf16 v120, v224, v224, 0
    v_dot2c_f32_bf16 v103, v221, v3
    v_dot2c_f32_bf16 v119, v221, v221
    v_dot2c_f32_bf16 v103, v222, v3
    v_dot2c_f32_bf16 v119, v222, v222
    v_dot2c_f32_bf16 v103, v223, v3
    v_dot2c_f32_bf16 v119, v223, v223
    v_lshlrev_b32 v184, 16, v220
    v_and_b32 v185, 0xffff0000, v220
    v_lshlrev_b32 v186, 16, v221
    v_and_b32 v187, 0xffff0000, v221
    v_lshlrev_b32 v188, 16, v222
    v_and_b32 v189, 0xffff0000, v222
    v_lshlrev_b32 v190, 16, v223
    v_and_b32 v191, 0xffff0000, v223
    s_waitcnt vmcnt(6)
    v_dot2_f32_bf16 v105, v228, v3, 0
    v_dot2_f32_bf16 v121, v228, v228, 0
    v_dot2c_f32_bf16 v104, v225, v3
    v_dot2c_f32_bf16 v120, v225, v225
    v_dot2c_f32_bf16 v104, v226, v3
    v_dot2c_f32_bf16 v120, v226, v226
    v_dot2c_f32_bf16 v104, v227, v3
    v_dot2c_f32_bf16 v120, v227, v227
    s_waitcnt vmcnt(5)
    v_dot2_f32_bf16 v106, v232, v3, 0
    v_dot2_f32_bf16 v122, v232, v232, 0
    v_dot2c_f32_bf16 v105, v229, v3
    v_dot2c_f32_bf16 v121, v229, v229
    v_dot2c_f32_bf16 v105, v230, v3
    v_dot2c_f32_bf16 v121, v230, v230
    v_dot2c_f32_bf16 v105, v231, v3
    v_dot2c_f32_bf16 v121, v231, v231
    s_waitcnt vmcnt(4)
    v_dot2_f32_bf16 v107, v236, v3, 0
    v_dot2_f32_bf16 v123, v236, v236, 0
    v_dot2c_f32_bf16 v106, v233, v3
    v_dot2c_f32_bf16 v122, v233, v233
    v_dot2c_f32_bf16 v106, v234, v3
    v_dot2c_f32_bf16 v122, v234, v234
    v_dot2c_f32_bf16 v106, v235, v3
    v_dot2c_f32_bf16 v122, v235, v235
    s_waitcnt vmcnt(3)
    v_dot2_f32_bf16 v108, v240, v3, 0
    v_dot2_f32_bf16 v124, v240, v240, 0
    v_dot2c_f32_bf16 v107, v237, v3
    v_dot2c_f32_bf16 v123, v237, v237
    v_dot2c_f32_bf16 v107, v238, v3
    v_dot2c_f32_bf16 v123, v238, v238
    v_dot2c_f32_bf16 v107, v239, v3
    v_dot2c_f32_bf16 v123, v239, v239
    s_waitcnt vmcnt(2)
    v_dot2_f32_bf16 v109, v244, v3, 0
    v_dot2_f32_bf16 v125, v244, v244, 0
    v_dot2c_f32_bf16 v108, v241, v3
    v_dot2c_f32_bf16 v124, v241, v241
    v_dot2c_f32_bf16 v108, v242, v3
    v_dot2c_f32_bf16 v124, v242, v242
    v_dot2c_f32_bf16 v108, v243, v3
    v_dot2c_f32_bf16 v124, v243, v243
    s_waitcnt vmcnt(1)
    v_dot2_f32_bf16 v110, v248, v3, 0
    v_dot2_f32_bf16 v126, v248, v248, 0
    v_dot2c_f32_bf16 v109, v245, v3
    v_dot2c_f32_bf16 v125, v245, v245
    v_dot2c_f32_bf16 v109, v246, v3
    v_dot2c_f32_bf16 v125, v246, v246
    v_dot2c_f32_bf16 v109, v247, v3
    v_dot2c_f32_bf16 v125, v247, v247
    s_waitcnt vmcnt(0)
    v_dot2_f32_bf16 v111, v252, v3, 0
    v_dot2_f32_bf16 v127, v252, v252, 0
    v_dot2c_f32_bf16 v110, v249, v3
    v_dot2c_f32_bf16 v126, v249, v249
    v_dot2c_f32_bf16 v110, v250, v3
    v_dot2c_f32_bf16 v126, v250, v250
    v_dot2c_f32_bf16 v110, v251, v3
    v_dot2c_f32_bf16 v126, v251, v251
    s_cmp_gt_u32 s34, 1
    s_cbranch_scc1 L_nokvw
    s_cmp_eq_u32 s37, 0
    s_cselect_b32 s4, s48, s50
    s_cselect_b32 s5, s49, s51
    s_mov_b32 s6, 16384
    s_lshl_b32 m0, s32, 13
    s_lshl_b32 s3, s36, 13
    buffer_load_dwordx4 v2, s[4:7], s3 offen offset:0 lds
    buffer_load_dwordx4 v2, s[4:7], s3 offen offset:1024 lds
    buffer_load_dwordx4 v2, s[4:7], s3 offen offset:2048 lds
    buffer_load_dwordx4 v2, s[4:7], s3 offen offset:3072 lds
    s_add_u32 m0, m0, 4096
    s_add_u32 s3, s3, 4096
    buffer_load_dwordx4 v2, s[4:7], s3 offen offset:0 lds
    buffer_load_dwordx4 v2, s[4:7], s3 offen offset:1024 lds
    buffer_load_dwordx4 v2, s[4:7], s3 offen offset:2048 lds
    buffer_load_dwordx4 v2, s[4:7], s3 offen offset:3072 lds
    s_branch L_nokvw2
L_nokvw:
    s_cmp_lg_u32 s34, 2
    s_cbranch_scc1 L_nokvw2
    v_lshlrev_b32 v16, 4, v0
    s_mov_b32 s3, 4096
    buffer_load_dwordx4 v[12:15], v16, s[8:11], s3 offen sc1
L_nokvw2:
    s_add_u32 m0, s39, 67584
    v_dot2c_f32_bf16 v111, v253, v3
    buffer_load_dwordx4 v6, s[12:15], s38 offen lds
    s_add_u32 m0, m0, 1024
    s_add_u32 s38, s38, 8192
    v_dot2c_f32_bf16 v127, v253, v253
    v_dot2c_f32_bf16 v111, v254, v3
    v_dot2c_f32_bf16 v127, v254, v254
    v_dot2c_f32_bf16 v111, v255, v3
    v_dot2c_f32_bf16 v127, v255, v255
    v_permlane32_swap_b32 v96, v104
    v_permlane32_swap_b32 v97, v105
    v_permlane32_swap_b32 v98, v106
    v_permlane32_swap_b32 v99, v107
    v_permlane32_swap_b32 v100, v108
    v_permlane32_swap_b32 v101, v109
    buffer_load_dwordx4 v6, s[12:15], s38 offen lds
    s_add_u32 m0, m0, 1024
    s_add_u32 s38, s38, 8192
    v_permlane32_swap_b32 v102, v110
    v_permlane32_swap_b32 v103, v111
    v_permlane32_swap_b32 v112, v120
    v_permlane32_swap_b32 v113, v121
    v_permlane32_swap_b32 v114, v122
    v_permlane32_swap_b32 v115, v123
    v_permlane32_swap_b32 v116, v124
    v_permlane32_swap_b32 v117, v125
    v_permlane32_swap_b32 v118, v126
    v_permlane32_swap_b32 v119, v127
    v_add_f32 v96, v96, v104
    buffer_load_dwordx4 v6, s[12:15], s38 offen lds
    s_add_u32 m0, m0, 1024
    s_add_u32 s38, s38, 8192
    v_add_f32 v97, v97, v105
    v_add_f32 v98, v98, v106
    v_add_f32 v99, v99, v107
    v_add_f32 v100, v100, v108
    v_add_f32 v101, v101, v109
    v_add_f32 v102, v102, v110
    v_add_f32 v103, v103, v111
    v_add_f32 v112, v112, v120
    v_add_f32 v113, v113, v121
    v_add_f32 v114, v114, v122
    v_add_f32 v115, v115, v123
    buffer_load_dwordx4 v6, s[12:15], s38 offen lds
    s_add_u32 m0, m0, 1024
    s_add_u32 s38, s38, 8192
    v_add_f32 v116, v116, v124
    v_add_f32 v117, v117, v125
    v_add_f32 v118, v118, v126
    v_add_f32 v119, v119, v127
    v_permlane16_swap_b32 v96, v100
    v_permlane16_swap_b32 v97, v101
    v_permlane16_swap_b32 v98, v102
    v_permlane16_swap_b32 v99, v103
    v_permlane16_swap_b32 v112, v116
    v_permlane16_swap_b32 v113, v117
    v_permlane16_swap_b32 v114, v118
    buffer_load_dwordx4 v6, s[12:15], s38 offen lds
    s_add_u32 m0, m0, 1024
    s_add_u32 s38, s38, 8192
    v_permlane16_swap_b32 v115, v119
    v_add_f32 v96, v96, v100
    v_add_f32 v97, v97, v101
    v_add_f32 v98, v98, v102
    v_add_f32 v99, v99, v103
    v_add_f32 v112, v112, v116
    v_add_f32 v113, v113, v117
    v_add_f32 v114, v114, v118
    v_add_f32 v115, v115, v119
    v_add_f32_dpp v96, v96, v96 row_ror:8 row_mask:0xf bank_mask:0x3
    v_add_f32_dpp v97, v97, v97 row_ror:8 row_mask:0xf bank_mask:0x3
    buffer_load_dwordx4 v6, s[12:15], s38 offen lds
    s_add_u32 m0, m0, 1024
    s_add_u32 s38, s38, 8192
    v_add_f32_dpp v112, v112, v112 row_ror:8 row_mask:0xf bank_mask:0x3
    v_add_f32_dpp v113, v113, v113 row_ror:8 row_mask:0xf bank_mask:0x3
    v_add_f32_dpp v96, v98, v98 row_ror:8 row_mask:0xf bank_mask:0xc
    v_add_f32_dpp v97, v99, v99 row_ror:8 row_mask:0xf bank_mask:0xc
    v_add_f32_dpp v112, v114, v114 row_ror:8 row_mask:0xf bank_mask:0xc
    v_add_f32_dpp v113, v115, v115 row_ror:8 row_mask:0xf bank_mask:0xc
    v_add_f32_dpp v96, v96, v96 row_half_mirror row_mask:0xf bank_mask:0x5
    v_add_f32_dpp v112, v112, v112 row_half_mirror row_mask:0xf bank_mask:0x5
    v_lshlrev_b32 v192, 16, v224
    v_add_f32_dpp v96, v97, v97 row_half_mirror row_mask:0xf bank_mask:0xa
    v_add_f32_dpp v112, v113, v113 row_half_mirror row_mask:0xf bank_mask:0xa
    v_and_b32 v193, 0xffff0000, v224
    v_add_f32_dpp v96, v96, v96 quad_perm:[1,0,3,2] row_mask:0xf bank_mask:0xf
    v_add_f32_dpp v112, v112, v112 quad_perm:[1,0,3,2] row_mask:0xf bank_mask:0xf
    v_lshlrev_b32 v194, 16, v225
    v_add_f32_dpp v96, v96, v96 quad_perm:[2,3,0,1] row_mask:0xf bank_mask:0xf
    v_add_f32_dpp v112, v112, v112 quad_perm:[2,3,0,1] row_mask:0xf bank_mask:0xf
    v_mul_f32 v3, 0x3b000000, v96
    v_mul_f32 v4, 0x3b000000, v112
    v_fma_f32 v4, -v3, v3, v4
    v_max_f32 v4, 0, v4
    v_add_f32 v4, 0x3727c5ac, v4
    v_rsq_f32 v4, v4
    v_and_b32 v195, 0xffff0000, v225
    v_mul_f32 v3, -v3, v4
    v_readlane_b32 s44, v4, 0
    buffer_load_dwordx4 v6, s[12:15], s38 offen lds
    s_add_u32 m0, m0, 1024
    s_add_u32 s38, s38, 8192
    v_readlane_b32 s45, v3, 0
    v_readlane_b32 s46, v4, 4
    v_readlane_b32 s47, v3, 4
    v_readlane_b32 s48, v4, 8
    v_readlane_b32 s49, v3, 8
    v_readlane_b32 s50, v4, 12
    v_readlane_b32 s51, v3, 12
    v_readlane_b32 s52, v4, 16
    v_readlane_b32 s53, v3, 16
    v_readlane_b32 s54, v4, 20
    v_readlane_b32 s55, v3, 20
    buffer_load_dwordx4 v6, s[12:15], s38 offen lds
    s_add_u32 m0, m0, 1024
    s_add_u32 s38, s38, 8192
    v_readlane_b32 s56, v4, 24
    v_readlane_b32 s57, v3, 24
    v_readlane_b32 s58, v4, 28
    v_readlane_b32 s59, v3, 28
    v_readlane_b32 s60, v4, 32
    v_readlane_b32 s61, v3, 32
    v_readlane_b32 s62, v4, 36
    v_readlane_b32 s63, v3, 36
    v_readlane_b32 s64, v4, 40
    v_readlane_b32 s65, v3, 40
    v_readlane_b32 s66, v4, 44
    buffer_load_dwordx4 v6, s[12:15], s38 offen lds
    s_add_u32 m0, m0, 1024
    s_add_u32 s38, s38, 8192
    v_readlane_b32 s67, v3, 44
    v_readlane_b32 s68, v4, 48
    v_readlane_b32 s69, v3, 48
    v_readlane_b32 s70, v4, 52
    v_readlane_b32 s71, v3, 52
    v_readlane_b32 s72, v4, 56
    v_readlane_b32 s73, v3, 56
    v_readlane_b32 s74, v4, 60
    v_readlane_b32 s75, v3, 60
    v_lshlrev_b32 v196, 16, v226
    v_and_b32 v197, 0xffff0000, v226
    buffer_load_dwordx4 v6, s[12:15], s38 offen lds
    s_add_u32 m0, m0, 1024
    s_add_u32 s38, s38, 8192
    v_lshlrev_b32 v198, 16, v227
    v_and_b32 v199, 0xffff0000, v227
    v_lshlrev_b32 v200, 16, v228
    v_and_b32 v201, 0xffff0000, v228
    v_lshlrev_b32 v202, 16, v229
    v_and_b32 v203, 0xffff0000, v229
    v_lshlrev_b32 v204, 16, v230
    v_and_b32 v205, 0xffff0000, v230
    v_lshlrev_b32 v206, 16, v231
    v_and_b32 v207, 0xffff0000, v231
    v_lshlrev_b32 v208, 16, v232
    buffer_load_dwordx4 v6, s[12:15], s38 offen lds
    s_add_u32 m0, m0, 1024
    s_add_u32 s38, s38, 8192
    v_and_b32 v209, 0xffff0000, v232
    v_lshlrev_b32 v210, 16, v233
    v_and_b32 v211, 0xffff0000, v233
    v_lshlrev_b32 v212, 16, v234
    v_and_b32 v213, 0xffff0000, v234
    v_lshlrev_b32 v214, 16, v235
    v_and_b32 v215, 0xffff0000, v235
    v_lshlrev_b32 v216, 16, v236
    v_and_b32 v217, 0xffff0000, v236
    v_lshlrev_b32 v218, 16, v237
    v_and_b32 v219, 0xffff0000, v237
    buffer_load_dwordx4 v6, s[12:15], s38 offen lds
    s_add_u32 m0, m0, 1024
    s_add_u32 s38, s38, 8192
    v_lshlrev_b32 v220, 16, v238
    v_and_b32 v221, 0xffff0000, v238
    v_lshlrev_b32 v222, 16, v239
    v_and_b32 v223, 0xffff0000, v239
    v_lshlrev_b32 v224, 16, v240
    v_and_b32 v225, 0xffff0000, v240
    v_lshlrev_b32 v226, 16, v241
    v_and_b32 v227, 0xffff0000, v241
    v_lshlrev_b32 v228, 16, v242
    v_and_b32 v229, 0xffff0000, v242
    v_lshlrev_b32 v230, 16, v243
    buffer_load_dwordx4 v6, s[12:15], s38 offen lds
    s_add_u32 m0, m0, 1024
    s_add_u32 s38, s38, 8192
    v_and_b32 v231, 0xffff0000, v243
    v_lshlrev_b32 v232, 16, v244
    v_and_b32 v233, 0xffff0000, v244
    v_lshlrev_b32 v234, 16, v245
    v_and_b32 v235, 0xffff0000, v245
    v_lshlrev_b32 v236, 16, v246
    v_and_b32 v237, 0xffff0000, v246
    v_lshlrev_b32 v238, 16, v247
    v_and_b32 v239, 0xffff0000, v247
    v_lshlrev_b32 v240, 16, v248
    v_and_b32 v241, 0xffff0000, v248
    buffer_load_dwordx4 v6, s[12:15], s38 offen lds
    s_add_u32 m0, m0, 1024
    s_add_u32 s38, s38, 8192
    v_lshlrev_b32 v242, 16, v249
    v_and_b32 v243, 0xffff0000, v249
    v_lshlrev_b32 v244, 16, v250
    v_and_b32 v245, 0xffff0000, v250
    v_lshlrev_b32 v246, 16, v251
    v_and_b32 v247, 0xffff0000, v251
    v_lshlrev_b32 v248, 16, v252
    v_and_b32 v249, 0xffff0000, v252
    v_lshlrev_b32 v250, 16, v253
    v_and_b32 v251, 0xffff0000, v253
    v_lshlrev_b32 v252, 16, v254
    buffer_load_dwordx4 v6, s[12:15], s38 offen lds
    s_add_u32 m0, m0, 1024
    s_add_u32 s38, s38, 8192
    v_and_b32 v253, 0xffff0000, v254
    v_lshlrev_b32 v254, 16, v255
    v_and_b32 v255, 0xffff0000, v255
    v_pk_fma_f32 v[128:129], v[128:129], s[44:45], s[44:45] op_sel:[0,0,1] op_sel_hi:[1,0,1]
    v_pk_fma_f32 v[130:131], v[130:131], s[44:45], s[44:45] op_sel:[0,0,1] op_sel_hi:[1,0,1]
    v_pk_fma_f32 v[132:133], v[132:133], s[44:45], s[44:45] op_sel:[0,0,1] op_sel_hi:[1,0,1]
    v_pk_fma_f32 v[134:135], v[134:135], s[44:45], s[44:45] op_sel:[0,0,1] op_sel_hi:[1,0,1]
    v_pk_fma_f32 v[136:137], v[136:137], s[46:47], s[46:47] op_sel:[0,0,1] op_sel_hi:[1,0,1]
    v_pk_fma_f32 v[138:139], v[138:139], s[46:47], s[46:47] op_sel:[0,0,1] op_sel_hi:[1,0,1]
    v_pk_fma_f32 v[140:141], v[140:141], s[46:47], s[46:47] op_sel:[0,0,1] op_sel_hi:[1,0,1]
    v_pk_fma_f32 v[142:143], v[142:143], s[46:47], s[46:47] op_sel:[0,0,1] op_sel_hi:[1,0,1]
    buffer_load_dwordx4 v6, s[12:15], s38 offen lds
    v_pk_fma_f32 v[144:145], v[144:145], s[48:49], s[48:49] op_sel:[0,0,1] op_sel_hi:[1,0,1]
    v_pk_fma_f32 v[146:147], v[146:147], s[48:49], s[48:49] op_sel:[0,0,1] op_sel_hi:[1,0,1]
    v_pk_fma_f32 v[148:149], v[148:149], s[48:49], s[48:49] op_sel:[0,0,1] op_sel_hi:[1,0,1]
    v_pk_fma_f32 v[150:151], v[150:151], s[48:49], s[48:49] op_sel:[0,0,1] op_sel_hi:[1,0,1]
    v_pk_fma_f32 v[152:153], v[152:153], s[50:51], s[50:51] op_sel:[0,0,1] op_sel_hi:[1,0,1]
    v_pk_fma_f32 v[154:155], v[154:155], s[50:51], s[50:51] op_sel:[0,0,1] op_sel_hi:[1,0,1]
    v_pk_fma_f32 v[156:157], v[156:157], s[50:51], s[50:51] op_sel:[0,0,1] op_sel_hi:[1,0,1]
    v_pk_fma_f32 v[158:159], v[158:159], s[50:51], s[50:51] op_sel:[0,0,1] op_sel_hi:[1,0,1]
    v_pk_fma_f32 v[160:161], v[160:161], s[52:53], s[52:53] op_sel:[0,0,1] op_sel_hi:[1,0,1]
    v_pk_fma_f32 v[162:163], v[162:163], s[52:53], s[52:53] op_sel:[0,0,1] op_sel_hi:[1,0,1]
    v_pk_fma_f32 v[164:165], v[164:165], s[52:53], s[52:53] op_sel:[0,0,1] op_sel_hi:[1,0,1]
    v_pk_fma_f32 v[166:167], v[166:167], s[52:53], s[52:53] op_sel:[0,0,1] op_sel_hi:[1,0,1]
    v_pk_fma_f32 v[168:169], v[168:169], s[54:55], s[54:55] op_sel:[0,0,1] op_sel_hi:[1,0,1]
    v_pk_fma_f32 v[170:171], v[170:171], s[54:55], s[54:55] op_sel:[0,0,1] op_sel_hi:[1,0,1]
    v_pk_fma_f32 v[172:173], v[172:173], s[54:55], s[54:55] op_sel:[0,0,1] op_sel_hi:[1,0,1]
    v_pk_fma_f32 v[174:175], v[174:175], s[54:55], s[54:55] op_sel:[0,0,1] op_sel_hi:[1,0,1]
    v_pk_fma_f32 v[176:177], v[176:177], s[56:57], s[56:57] op_sel:[0,0,1] op_sel_hi:[1,0,1]
    v_pk_fma_f32 v[178:179], v[178:179], s[56:57], s[56:57] op_sel:[0,0,1] op_sel_hi:[1,0,1]
    v_pk_fma_f32 v[180:181], v[180:181], s[56:57], s[56:57] op_sel:[0,0,1] op_sel_hi:[1,0,1]
    v_pk_fma_f32 v[182:183], v[182:183], s[56:57], s[56:57] op_sel:[0,0,1] op_sel_hi:[1,0,1]
    v_pk_fma_f32 v[184:185], v[184:185], s[58:59], s[58:59] op_sel:[0,0,1] op_sel_hi:[1,0,1]
    v_pk_fma_f32 v[186:187], v[186:187], s[58:59], s[58:59] op_sel:[0,0,1] op_sel_hi:[1,0,1]
    v_pk_fma_f32 v[188:189], v[188:189], s[58:59], s[58:59] op_sel:[0,0,1] op_sel_hi:[1,0,1]
    v_pk_fma_f32 v[190:191], v[190:191], s[58:59], s[58:59] op_sel:[0,0,1] op_sel_hi:[1,0,1]
    v_pk_fma_f32 v[192:193], v[192:193], s[60:61], s[60:61] op_sel:[0,0,1] op_sel_hi:[1,0,1]
    v_pk_fma_f32 v[194:195], v[194:195], s[60:61], s[60:61] op_sel:[0,0,1] op_sel_hi:[1,0,1]
    v_pk_fma_f32 v[196:197], v[196:197], s[60:61], s[60:61] op_sel:[0,0,1] op_sel_hi:[1,0,1]
    v_pk_fma_f32 v[198:199], v[198:199], s[60:61], s[60:61] op_sel:[0,0,1] op_sel_hi:[1,0,1]
    v_pk_fma_f32 v[200:201], v[200:201], s[62:63], s[62:63] op_sel:[0,0,1] op_sel_hi:[1,0,1]
    v_pk_fma_f32 v[202:203], v[202:203], s[62:63], s[62:63] op_sel:[0,0,1] op_sel_hi:[1,0,1]
    v_pk_fma_f32 v[204:205], v[204:205], s[62:63], s[62:63] op_sel:[0,0,1] op_sel_hi:[1,0,1]
    v_pk_fma_f32 v[206:207], v[206:207], s[62:63], s[62:63] op_sel:[0,0,1] op_sel_hi:[1,0,1]
    v_pk_fma_f32 v[208:209], v[208:209], s[64:65], s[64:65] op_sel:[0,0,1] op_sel_hi:[1,0,1]
    v_pk_fma_f32 v[210:211], v[210:211], s[64:65], s[64:65] op_sel:[0,0,1] op_sel_hi:[1,0,1]
    v_pk_fma_f32 v[212:213], v[212:213], s[64:65], s[64:65] op_sel:[0,0,1] op_sel_hi:[1,0,1]
    v_pk_fma_f32 v[214:215], v[214:215], s[64:65], s[64:65] op_sel:[0,0,1] op_sel_hi:[1,0,1]
    v_pk_fma_f32 v[216:217], v[216:217], s[66:67], s[66:67] op_sel:[0,0,1] op_sel_hi:[1,0,1]
    v_pk_fma_f32 v[218:219], v[218:219], s[66:67], s[66:67] op_sel:[0,0,1] op_sel_hi:[1,0,1]
    v_pk_fma_f32 v[220:221], v[220:221], s[66:67], s[66:67] op_sel:[0,0,1] op_sel_hi:[1,0,1]
    v_pk_fma_f32 v[222:223], v[222:223], s[66:67], s[66:67] op_sel:[0,0,1] op_sel_hi:[1,0,1]
    v_pk_fma_f32 v[224:225], v[224:225], s[68:69], s[68:69] op_sel:[0,0,1] op_sel_hi:[1,0,1]
    v_pk_fma_f32 v[226:227], v[226:227], s[68:69], s[68:69] op_sel:[0,0,1] op_sel_hi:[1,0,1]
    v_pk_fma_f32 v[228:229], v[228:229], s[68:69], s[68:69] op_sel:[0,0,1] op_sel_hi:[1,0,1]
    v_pk_fma_f32 v[230:231], v[230:231], s[68:69], s[68:69] op_sel:[0,0,1] op_sel_hi:[1,0,1]
    v_pk_fma_f32 v[232:233], v[232:233], s[70:71], s[70:71] op_sel:[0,0,1] op_sel_hi:[1,0,1]
    v_pk_fma_f32 v[234:235], v[234:235], s[70:71], s[70:71] op_sel:[0,0,1] op_sel_hi:[1,0,1]
    v_pk_fma_f32 v[236:237], v[236:237], s[70:71], s[70:71] op_sel:[0,0,1] op_sel_hi:[1,0,1]
    v_pk_fma_f32 v[238:239], v[238:239], s[70:71], s[70:71] op_sel:[0,0,1] op_sel_hi:[1,0,1]
    v_pk_fma_f32 v[240:241], v[240:241], s[72:73], s[72:73] op_sel:[0,0,1] op_sel_hi:[1,0,1]
    v_pk_fma_f32 v[242:243], v[242:243], s[72:73], s[72:73] op_sel:[0,0,1] op_sel_hi:[1,0,1]
    v_pk_fma_f32 v[244:245], v[244:245], s[72:73], s[72:73] op_sel:[0,0,1] op_sel_hi:[1,0,1]
    v_pk_fma_f32 v[246:247], v[246:247], s[72:73], s[72:73] op_sel:[0,0,1] op_sel_hi:[1,0,1]
    v_pk_fma_f32 v[248:249], v[248:249], s[74:75], s[74:75] op_sel:[0,0,1] op_sel_hi:[1,0,1]
    v_pk_fma_f32 v[250:251], v[250:251], s[74:75], s[74:75] op_sel:[0,0,1] op_sel_hi:[1,0,1]
    v_pk_fma_f32 v[252:253], v[252:253], s[74:75], s[74:75] op_sel:[0,0,1] op_sel_hi:[1,0,1]
    v_pk_fma_f32 v[254:255], v[254:255], s[74:75], s[74:75] op_sel:[0,0,1] op_sel_hi:[1,0,1]
    s_mov_b32 s12, s8
    s_mov_b32 s13, s9
    s_mov_b32 s14, 0
    s_mov_b32 s15, 0x20000
    v_and_b32 v8, 3, v1
    v_lshlrev_b32 v8, 3, v8
    v_bfe_u32 v9, v1, 2, 2
    v_lshrrev_b32 v11, 5, v1
    s_cmp_eq_u32 s34, 2
    s_cbranch_scc1 L_hop1
    s_waitcnt vmcnt(16)
    v_readfirstlane_b32 s35, v7
    s_nop 0
    s_mul_i32 s35, s35, 1664525
    s_add_u32 s35, s35, 1013904223
L_hop1:
    v_lshlrev_b32 v3, 4, v0
    s_mov_b32 s38, 4096
    v_lshlrev_b32 v4, 3, v0
    v_add_u32 v4, 133120, v4
    s_and_b32 s39, s34, 1
    s_mul_i32 s44, s39, 33792
    s_xor_b32 s39, s39, 1
    s_mul_i32 s39, s39, 33792
    s_lshl_b32 s45, s32, 7
    v_mul_u32_u24 v5, 528, v1
    v_add_u32 v5, s45, v5
    v_add_u32 v6, s39, v5
    v_add_u32 v5, s44, v5
    s_waitcnt vmcnt(16)
    v_add_u32 v7, 133120, v2
    s_cmp_lg_u32 s34, 2
    s_cbranch_scc1 L_hop1b
    v_xor_b32 v13, s35, v13
    v_xor_b32 v15, s35, v15
    v_or_b32 v15, v13, v15
    v_cmp_ne_u32 vcc, 0, v15
    s_nop 0
    s_cbranch_vccz L_hop1c
L_hop1b:
    buffer_load_dwordx4 v[12:15], v3, s[8:11], s38 offen sc1
    s_cmp_gt_u32 s34, 1
    s_cbranch_scc1 L_nokvt
    v_lshrrev_b32 v16, 4, v1
    v_lshl_add_u32 v16, v16, 3, v9
    v_lshl_add_u32 v16, v16, 5, v8
    s_lshl_b32 s39, s37, 14
    v_add_u32 v16, s39, v16
    s_barrier
    ds_read_b64_tr_b16 a[128:129], v16 offset:0
    ds_read_b64_tr_b16 a[130:131], v16 offset:128
    ds_read_b64_tr_b16 a[132:133], v16 offset:1024
    ds_read_b64_tr_b16 a[134:135], v16 offset:1152
    ds_read_b64_tr_b16 a[136:137], v16 offset:2048
    ds_read_b64_tr_b16 a[138:139], v16 offset:2176
    ds_read_b64_tr_b16 a[140:141], v16 offset:3072
    ds_read_b64_tr_b16 a[142:143], v16 offset:3200
    ds_read_b64_tr_b16 a[144:145], v16 offset:4096
    ds_read_b64_tr_b16 a[146:147], v16 offset:4224
    ds_read_b64_tr_b16 a[148:149], v16 offset:5120
    ds_read_b64_tr_b16 a[150:151], v16 offset:5248
    ds_read_b64_tr_b16 a[152:153], v16 offset:6144
    ds_read_b64_tr_b16 a[154:155], v16 offset:6272
    ds_read_b64_tr_b16 a[156:157], v16 offset:7168
    ds_read_b64_tr_b16 a[158:159], v16 offset:7296
    ds_read_b64_tr_b16 a[160:161], v16 offset:8192
    ds_read_b64_tr_b16 a[162:163], v16 offset:8320
    ds_read_b64_tr_b16 a[164:165], v16 offset:9216
    ds_read_b64_tr_b16 a[166:167], v16 offset:9344
    ds_read_b64_tr_b16 a[168:169], v16 offset:10240
    ds_read_b64_tr_b16 a[170:171], v16 offset:10368
    ds_read_b64_tr_b16 a[172:173], v16 offset:11264
    ds_read_b64_tr_b16 a[174:175], v16 offset:11392
    ds_read_b64_tr_b16 a[176:177], v16 offset:12288
    ds_read_b64_tr_b16 a[178:179], v16 offset:12416
    ds_read_b64_tr_b16 a[180:181], v16 offset:13312
    ds_read_b64_tr_b16 a[182:183], v16 offset:13440
    ds_read_b64_tr_b16 a[184:185], v16 offset:14336
    ds_read_b64_tr_b16 a[186:187], v16 offset:14464
    ds_read_b64_tr_b16 a[188:189], v16 offset:15360
    ds_read_b64_tr_b16 a[190:191], v16 offset:15488
L_nokvt:
    s_waitcnt vmcnt(0)
    v_xor_b32 v13, s35, v13
    v_xor_b32 v15, s35, v15
    v_or_b32 v15, v13, v15
    v_cmp_ne_u32 vcc, 0, v15
    s_nop 0
    s_cbranch_vccz L_spun_2
    s_mov_b32 s3, 0
L_spin_1:
    buffer_load_dwordx4 v[12:15], v3, s[8:11], s38 offen sc1
    s_waitcnt vmcnt(0)
    v_xor_b32 v13, s35, v13
    v_xor_b32 v15, s35, v15
    v_or_b32 v15, v13, v15
    v_cmp_ne_u32 vcc, 0, v15
    s_nop 0
    s_cbranch_vccz L_spun_2
    s_add_u32 s3, s3, 1
    s_cmp_lt_u32 s3, 262144
    s_cbranch_scc1 L_spin_1
L_spun_2:
L_hop1c:
    v_mov_b32 v13, v14
    v_xor_b32 v16, 0x80008000, v12
    v_xor_b32 v17, 0x80008000, v14
    ds_write_b64 v4, v[12:13]
    ds_write_b64 v4, v[16:17] offset:2048
    s_waitcnt lgkmcnt(0)
    s_barrier
    ds_read_b128 v[12:15], v7
    ds_read_b128 v[64:67], v7 offset:1024
    s_sub_u32 s40, s34, 3
    s_cbranch_scc1 L_nomod2
    s_cmp_gt_u32 s40, 1
    s_cbranch_scc1 L_rl_st
    s_lshl_b32 s41, s40, 5
    s_add_u32 s41, s41, s33
    s_and_b32 s38, s41, 15
    s_lshr_b32 s39, s41, 4
    s_lshl_b32 s41, s38, 2
    s_add_u32 s41, s41, s39
    s_lshl_b32 s41, s41, 11
    s_lshl_b32 s38, s38, 2
    s_add_u32 s38, s38, s32
    s_lshl_b32 s3, s38, 4
    s_mul_i32 s42, s38, 49152
    s_lshl_b32 s39, s39, 10
    s_add_u32 s42, s42, s39
    v_and_b32 v91, 3, v1
    v_lshlrev_b32 v91, 2, v91
    buffer_load_dword v88, v91, s[4:7], s3 offen
    buffer_load_dwordx4 v[32:35], v2, s[28:31], s42 offen offset:2048
    s_add_u32 s42, s42, 6144
    buffer_load_dwordx4 v[36:39], v2, s[28:31], s42 offen offset:2048
    s_add_u32 s42, s42, 6144
    buffer_load_dwordx4 v[40:43], v2, s[28:31], s42 offen offset:2048
    s_add_u32 s42, s42, 6144
    buffer_load_dwordx4 v[44:47], v2, s[28:31], s42 offen offset:2048
    s_add_u32 s42, s42, 6144
    buffer_load_dwordx4 v[48:51], v2, s[28:31], s42 offen offset:2048
    s_add_u32 s42, s42, 6144
    buffer_load_dwordx4 v[52:55], v2, s[28:31], s42 offen offset:2048
    s_add_u32 s42, s42, 6144
    buffer_load_dwordx4 v[56:59], v2, s[28:31], s42 offen offset:2048
    s_add_u32 s42, s42, 6144
    buffer_load_dwordx4 v[60:63], v2, s[28:31], s42 offen offset:2048
    s_load_dwordx2 s[4:5], s[0:1], 32
    s_mov_b32 s6, 524288
    s_lshl_b32 s38, s40, 5
    s_add_u32 s38, s38, s33
    s_lshl_b32 s38, s38, 2
    s_add_u32 s38, s38, s32
    s_lshl_b32 s38, s38, 11
    v_and_b32 v91, 15, v1
    v_lshlrev_b32 v91, 7, v91
    s_waitcnt lgkmcnt(0)
    buffer_load_dword v90, v91, s[4:7], s38 offen
    s_branch L_nomod2
L_rl_st:
    v_lshrrev_b32 v89, 4, v1
    v_and_b32 v90, 15, v1
    v_mul_u32_u24 v89, 2752, v89
    v_lshl_add_u32 v89, v90, 4, v89
    buffer_load_dwordx4 v[32:35], v89, s[28:31], s41 offen
    buffer_load_dwordx4 v[36:39], v89, s[4:7], s41 offen
    s_add_u32 s41, s41, 11008
    buffer_load_dwordx4 v[40:43], v89, s[28:31], s41 offen
    buffer_load_dwordx4 v[44:47], v89, s[4:7], s41 offen
    s_add_u32 s41, s41, 11008
    buffer_load_dwordx4 v[48:51], v89, s[28:31], s41 offen
    buffer_load_dwordx4 v[52:55], v89, s[4:7], s41 offen
    s_add_u32 s41, s41, 11008
    buffer_load_dwordx4 v[56:59], v89, s[28:31], s41 offen
    buffer_load_dwordx4 v[60:63], v89, s[4:7], s41 offen
L_nomod2:
    s_waitcnt lgkmcnt(1)
    v_lshlrev_b32 v16, 16, v12
    v_and_b32 v17, 0xffff0000, v12
    v_lshlrev_b32 v18, 16, v13
    v_and_b32 v19, 0xffff0000, v13
    v_lshlrev_b32 v20, 16, v14
    v_and_b32 v21, 0xffff0000, v14
    v_lshlrev_b32 v22, 16, v15
    v_and_b32 v23, 0xffff0000, v15
    s_waitcnt lgkmcnt(0)
    v_lshlrev_b32 v24, 16, v64
    v_and_b32 v25, 0xffff0000, v64
    v_lshlrev_b32 v26, 16, v65
    v_and_b32 v27, 0xffff0000, v65
    v_lshlrev_b32 v28, 16, v66
    v_and_b32 v29, 0xffff0000, v66
    v_lshlrev_b32 v30, 16, v67
    v_and_b32 v31, 0xffff0000, v67
    v_pk_fma_f32 v[128:129], v[128:129], v[24:25], v[16:17]
    v_pk_fma_f32 v[130:131], v[130:131], v[26:27], v[18:19]
    v_pk_fma_f32 v[132:133], v[132:133], v[28:29], v[20:21]
    v_pk_fma_f32 v[134:135], v[134:135], v[30:31], v[22:23]
    v_cvt_pk_bf16_f32 v64, v128, v129
    v_cvt_pk_bf16_f32 v65, v130, v131
    v_cvt_pk_bf16_f32 v66, v132, v133
    v_cvt_pk_bf16_f32 v67, v134, v135
    ds_write_b128 v5, v[64:67] offset:0
    v_pk_fma_f32 v[136:137], v[136:137], v[24:25], v[16:17]
    v_pk_fma_f32 v[138:139], v[138:139], v[26:27], v[18:19]
    v_pk_fma_f32 v[140:141], v[140:141], v[28:29], v[20:21]
    v_pk_fma_f32 v[142:143], v[142:143], v[30:31], v[22:23]
    v_cvt_pk_bf16_f32 v68, v136, v137
    v_cvt_pk_bf16_f32 v69, v138, v139
    v_cvt_pk_bf16_f32 v70, v140, v141
    v_cvt_pk_bf16_f32 v71, v142, v143
    ds_write_b128 v5, v[68:71] offset:16
    v_pk_fma_f32 v[144:145], v[144:145], v[24:25], v[16:17]
    v_pk_fma_f32 v[146:147], v[146:147], v[26:27], v[18:19]
    v_pk_fma_f32 v[148:149], v[148:149], v[28:29], v[20:21]
    v_pk_fma_f32 v[150:151], v[150:151], v[30:31], v[22:23]
    v_cvt_pk_bf16_f32 v72, v144, v145
    v_cvt_pk_bf16_f32 v73, v146, v147
    v_cvt_pk_bf16_f32 v74, v148, v149
    v_cvt_pk_bf16_f32 v75, v150, v151
    ds_write_b128 v5, v[72:75] offset:32
    v_pk_fma_f32 v[152:153], v[152:153], v[24:25], v[16:17]
    v_pk_fma_f32 v[154:155], v[154:155], v[26:27], v[18:19]
    v_pk_fma_f32 v[156:157], v[156:157], v[28:29], v[20:21]
    v_pk_fma_f32 v[158:159], v[158:159], v[30:31], v[22:23]
    v_cvt_pk_bf16_f32 v76, v152, v153
    v_cvt_pk_bf16_f32 v77, v154, v155
    v_cvt_pk_bf16_f32 v78, v156, v157
    v_cvt_pk_bf16_f32 v79, v158, v159
    ds_write_b128 v5, v[76:79] offset:48
    v_pk_fma_f32 v[160:161], v[160:161], v[24:25], v[16:17]
    v_pk_fma_f32 v[162:163], v[162:163], v[26:27], v[18:19]
    v_pk_fma_f32 v[164:165], v[164:165], v[28:29], v[20:21]
    v_pk_fma_f32 v[166:167], v[166:167], v[30:31], v[22:23]
    v_cvt_pk_bf16_f32 v64, v160, v161
    v_cvt_pk_bf16_f32 v65, v162, v163
    v_cvt_pk_bf16_f32 v66, v164, v165
    v_cvt_pk_bf16_f32 v67, v166, v167
    ds_write_b128 v5, v[64:67] offset:64
    v_pk_fma_f32 v[168:169], v[168:169], v[24:25], v[16:17]
    v_pk_fma_f32 v[170:171], v[170:171], v[26:27], v[18:19]
    v_pk_fma_f32 v[172:173], v[172:173], v[28:29], v[20:21]
    v_pk_fma_f32 v[174:175], v[174:175], v[30:31], v[22:23]
    v_cvt_pk_bf16_f32 v68, v168, v169
    v_cvt_pk_bf16_f32 v69, v170, v171
    v_cvt_pk_bf16_f32 v70, v172, v173
    v_cvt_pk_bf16_f32 v71, v174, v175
    ds_write_b128 v5, v[68:71] offset:80
    v_pk_fma_f32 v[176:177], v[176:177], v[24:25], v[16:17]
    v_pk_fma_f32 v[178:179], v[178:179], v[26:27], v[18:19]
    v_pk_fma_f32 v[180:181], v[180:181], v[28:29], v[20:21]
    v_pk_fma_f32 v[182:183], v[182:183], v[30:31], v[22:23]
    v_cvt_pk_bf16_f32 v72, v176, v177
    v_cvt_pk_bf16_f32 v73, v178, v179
    v_cvt_pk_bf16_f32 v74, v180, v181
    v_cvt_pk_bf16_f32 v75, v182, v183
    ds_write_b128 v5, v[72:75] offset:96
    v_pk_fma_f32 v[184:185], v[184:185], v[24:25], v[16:17]
    v_pk_fma_f32 v[186:187], v[186:187], v[26:27], v[18:19]
    v_pk_fma_f32 v[188:189], v[188:189], v[28:29], v[20:21]
    v_pk_fma_f32 v[190:191], v[190:191], v[30:31], v[22:23]
    v_cvt_pk_bf16_f32 v76, v184, v185
    v_cvt_pk_bf16_f32 v77, v186, v187
    v_cvt_pk_bf16_f32 v78, v188, v189
    v_cvt_pk_bf16_f32 v79, v190, v191
    ds_write_b128 v5, v[76:79] offset:112
    s_cmp_ge_u32 s34, 2
    s_cbranch_scc1 L_rows2
    v_lshrrev_b32 v3, 4, v1
    v_and_b32 v4, 15, v1
    v_mul_u32_u24 v12, 528, v3
    v_lshl_add_u32 v12, v4, 4, v12
    s_lshl_b32 s38, s36, 8
    s_add_u32 s38, s38, s44
    v_add_u32 v12, s38, v12
    s_lshl_b32 s38, s33, 1
    s_add_u32 s38, s38, s34
    s_lshl_b32 s38, s38, 11
    s_add_u32 s38, s38, 131072
    s_cmp_lg_u32 s37, 0
    s_cbranch_scc1 L_vjob
    v_lshlrev_b32 v13, 4, v3
    v_add_u32 v13, 135168, v13
    ds_read_b128 a[64:67], v13 offset:0
    ds_read_b128 a[68:71], v13 offset:64
    ds_read_b128 a[72:75], v13 offset:128
    ds_read_b128 a[76:79], v13 offset:192
    ds_read_b128 a[80:83], v13 offset:256
    ds_read_b128 a[84:87], v13 offset:320
    ds_read_b128 a[88:91], v13 offset:384
    ds_read_b128 a[92:95], v13 offset:448
    ds_read_b128 a[96:99], v13 offset:512
    ds_read_b128 a[100:103], v13 offset:576
    ds_read_b128 a[104:107], v13 offset:640
    ds_read_b128 a[108:111], v13 offset:704
    s_waitcnt lgkmcnt(12)
    s_barrier
    ds_read_b128 a[112:115], v13 offset:768
    ds_read_b128 a[116:119], v13 offset:832
    ds_read_b128 a[120:123], v13 offset:896
    ds_read_b128 a[124:127], v13 offset:960
    v_and_b32 v3, 1, v3
    v_lshl_add_u32 v4, v3, 5, v4
    s_lshl_b32 s39, s36, 4
    v_add_lshl_u32 v4, v4, s39, 4
    s_waitcnt lgkmcnt(15)
    v_mfma_f32_16x16x32_bf16 v[80:83], a[128:131], a[64:67], 0
    ds_read_b128 a[0:3], v12 offset:0
    s_waitcnt lgkmcnt(15)
    v_mfma_f32_16x16x32_bf16 v[80:83], a[132:135], a[68:71], v[80:83]
    ds_read_b128 a[4:7], v12 offset:2112
    s_waitcnt lgkmcnt(15)
    v_mfma_f32_16x16x32_bf16 v[80:83], a[136:139], a[72:75], v[80:83]
    ds_read_b128 a[8:11], v12 offset:4224
    s_waitcnt lgkmcnt(15)
    v_mfma_f32_16x16x32_bf16 v[80:83], a[140:143], a[76:79], v[80:83]
    ds_read_b128 a[12:15], v12 offset:6336
    s_waitcnt lgkmcnt(15)
    v_mfma_f32_16x16x32_bf16 v[80:83], a[144:147], a[80:83], v[80:83]
    ds_read_b128 a[16:19], v12 offset:8448
    s_waitcnt lgkmcnt(15)
    v_mfma_f32_16x16x32_bf16 v[80:83], a[148:151], a[84:87], v[80:83]
    ds_read_b128 a[20:23], v12 offset:10560
    s_waitcnt lgkmcnt(15)
    v_mfma_f32_16x16x32_bf16 v[80:83], a[152:155], a[88:91], v[80:83]
    ds_read_b128 a[24:27], v12 offset:12672
    s_waitcnt lgkmcnt(15)
    v_mfma_f32_16x16x32_bf16 v[80:83], a[156:159], a[92:95], v[80:83]
    ds_read_b128 a[28:31], v12 offset:14784
    s_waitcnt lgkmcnt(15)
    v_mfma_f32_16x16x32_bf16 v[80:83], a[160:163], a[96:99], v[80:83]
    ds_read_b128 a[32:35], v12 offset:16896
    s_waitcnt lgkmcnt(15)
    v_mfma_f32_16x16x32_bf16 v[80:83], a[164:167], a[100:103], v[80:83]
    ds_read_b128 a[36:39], v12 offset:19008
    s_waitcnt lgkmcnt(15)
    v_mfma_f32_16x16x32_bf16 v[80:83], a[168:171], a[104:107], v[80:83]
    ds_read_b128 a[40:43], v12 offset:21120
    s_waitcnt lgkmcnt(15)
    v_mfma_f32_16x16x32_bf16 v[80:83], a[172:175], a[108:111], v[80:83]
    ds_read_b128 a[44:47], v12 offset:23232
    s_waitcnt lgkmcnt(15)
    v_mfma_f32_16x16x32_bf16 v[80:83], a[176:179], a[112:115], v[80:83]
    ds_read_b128 a[48:51], v12 offset:25344
    s_waitcnt lgkmcnt(15)
    v_mfma_f32_16x16x32_bf16 v[80:83], a[180:183], a[116:119], v[80:83]
    ds_read_b128 a[52:55], v12 offset:27456
    s_waitcnt lgkmcnt(15)
    v_mfma_f32_16x16x32_bf16 v[80:83], a[184:187], a[120:123], v[80:83]
    ds_read_b128 a[56:59], v12 offset:29568
    s_waitcnt lgkmcnt(15)
    v_mfma_f32_16x16x32_bf16 v[80:83], a[188:191], a[124:127], v[80:83]
    ds_read_b128 a[60:63], v12 offset:31680
    s_waitcnt lgkmcnt(15)
    v_mfma_f32_16x16x32_bf16 v[80:83], a[128:131], a[0:3], v[80:83]
    s_waitcnt lgkmcnt(14)
    v_mfma_f32_16x16x32_bf16 v[80:83], a[132:135], a[4:7], v[80:83]
    s_waitcnt lgkmcnt(13)
    v_mfma_f32_16x16x32_bf16 v[80:83], a[136:139], a[8:11], v[80:83]
    s_waitcnt lgkmcnt(12)
    v_mfma_f32_16x16x32_bf16 v[80:83], a[140:143], a[12:15], v[80:83]
    s_waitcnt lgkmcnt(11)
    v_mfma_f32_16x16x32_bf16 v[80:83], a[144:147], a[16:19], v[80:83]
    s_waitcnt lgkmcnt(10)
    v_mfma_f32_16x16x32_bf16 v[80:83], a[148:151], a[20:23], v[80:83]
    s_waitcnt lgkmcnt(9)
    v_mfma_f32_16x16x32_bf16 v[80:83], a[152:155], a[24:27], v[80:83]
    s_waitcnt lgkmcnt(8)
    v_mfma_f32_16x16x32_bf16 v[80:83], a[156:159], a[28:31], v[80:83]
    s_waitcnt lgkmcnt(7)
    v_mfma_f32_16x16x32_bf16 v[80:83], a[160:163], a[32:35], v[80:83]
    s_waitcnt lgkmcnt(6)
    v_mfma_f32_16x16x32_bf16 v[80:83], a[164:167], a[36:39], v[80:83]
    s_waitcnt lgkmcnt(5)
    v_mfma_f32_16x16x32_bf16 v[80:83], a[168:171], a[40:43], v[80:83]
    s_waitcnt lgkmcnt(4)
    v_mfma_f32_16x16x32_bf16 v[80:83], a[172:175], a[44:47], v[80:83]
    s_waitcnt lgkmcnt(3)
    v_mfma_f32_16x16x32_bf16 v[80:83], a[176:179], a[48:51], v[80:83]
    s_waitcnt lgkmcnt(2)
    v_mfma_f32_16x16x32_bf16 v[80:83], a[180:183], a[52:55], v[80:83]
    s_waitcnt lgkmcnt(1)
    v_mfma_f32_16x16x32_bf16 v[80:83], a[184:187], a[56:59], v[80:83]
    s_waitcnt lgkmcnt(0)
    v_mfma_f32_16x16x32_bf16 v[80:83], a[188:191], a[60:63], v[80:83]
    s_nop 7
    v_cvt_pk_bf16_f32 v84, v80, v81
    v_cvt_pk_bf16_f32 v86, v80, v81
    v_cvt_pk_bf16_f32 v85, v82, v83
    v_cvt_pk_bf16_f32 v87, v82, v83
    v_permlane32_swap_b32 v84, v86
    s_nop 0
    v_permlane32_swap_b32 v85, v87
    s_mov_b32 exec_hi, 0
    buffer_store_dwordx4 v[84:87], v4, s[8:11], s38 offen sc1
    s_mov_b32 exec_hi, -1
    s_branch L_rows2
L_vjob:
    s_waitcnt lgkmcnt(0)
    s_barrier
    ds_read_b128 a[0:3], v12 offset:0
    ds_read_b128 a[4:7], v12 offset:2112
    ds_read_b128 a[8:11], v12 offset:4224
    ds_read_b128 a[12:15], v12 offset:6336
    ds_read_b128 a[16:19], v12 offset:8448
    ds_read_b128 a[20:23], v12 offset:10560
    ds_read_b128 a[24:27], v12 offset:12672
    ds_read_b128 a[28:31], v12 offset:14784
    ds_read_b128 a[32:35], v12 offset:16896
    ds_read_b128 a[36:39], v12 offset:19008
    ds_read_b128 a[40:43], v12 offset:21120
    ds_read_b128 a[44:47], v12 offset:23232
    ds_read_b128 a[48:51], v12 offset:25344
    ds_read_b128 a[52:55], v12 offset:27456
    ds_read_b128 a[56:59], v12 offset:29568
    ds_read_b128 a[60:63], v12 offset:31680
    v_lshrrev_b32 v3, 1, v3
    v_lshl_add_u32 v4, v3, 4, v4
    s_lshl_b32 s39, s36, 5
    v_add_lshl_u32 v4, v4, s39, 4
    s_waitcnt lgkmcnt(15)
    v_mfma_f32_16x16x32_bf16 v[80:83], a[0:3], a[128:131], 0
    s_waitcnt lgkmcnt(14)
    v_mfma_f32_16x16x32_bf16 v[80:83], a[4:7], a[132:135], v[80:83]
    s_waitcnt lgkmcnt(13)
    v_mfma_f32_16x16x32_bf16 v[80:83], a[8:11], a[136:139], v[80:83]
    s_waitcnt lgkmcnt(12)
    v_mfma_f32_16x16x32_bf16 v[80:83], a[12:15], a[140:143], v[80:83]
    s_waitcnt lgkmcnt(11)
    v_mfma_f32_16x16x32_bf16 v[80:83], a[16:19], a[144:147], v[80:83]
    s_waitcnt lgkmcnt(10)
    v_mfma_f32_16x16x32_bf16 v[80:83], a[20:23], a[148:151], v[80:83]
    s_waitcnt lgkmcnt(9)
    v_mfma_f32_16x16x32_bf16 v[80:83], a[24:27], a[152:155], v[80:83]
    s_waitcnt lgkmcnt(8)
    v_mfma_f32_16x16x32_bf16 v[80:83], a[28:31], a[156:159], v[80:83]
    s_waitcnt lgkmcnt(7)
    v_mfma_f32_16x16x32_bf16 v[80:83], a[32:35], a[160:163], v[80:83]
    s_waitcnt lgkmcnt(6)
    v_mfma_f32_16x16x32_bf16 v[80:83], a[36:39], a[164:167], v[80:83]
    s_waitcnt lgkmcnt(5)
    v_mfma_f32_16x16x32_bf16 v[80:83], a[40:43], a[168:171], v[80:83]
    s_waitcnt lgkmcnt(4)
    v_mfma_f32_16x16x32_bf16 v[80:83], a[44:47], a[172:175], v[80:83]
    s_waitcnt lgkmcnt(3)
    v_mfma_f32_16x16x32_bf16 v[80:83], a[48:51], a[176:179], v[80:83]
    s_waitcnt lgkmcnt(2)
    v_mfma_f32_16x16x32_bf16 v[80:83], a[52:55], a[180:183], v[80:83]
    s_waitcnt lgkmcnt(1)
    v_mfma_f32_16x16x32_bf16 v[80:83], a[56:59], a[184:187], v[80:83]
    s_waitcnt lgkmcnt(0)
    v_mfma_f32_16x16x32_bf16 v[80:83], a[60:63], a[188:191], v[80:83]
    s_nop 7
    v_cvt_pk_bf16_f32 v84, v80, v81
    v_cvt_pk_bf16_f32 v86, v80, v81
    v_cvt_pk_bf16_f32 v85, v82, v83
    v_cvt_pk_bf16_f32 v87, v82, v83
    v_permlane16_swap_b32 v84, v86
    s_nop 0
    v_permlane16_swap_b32 v85, v87
    s_mov_b32 exec_lo, 0xffff
    s_mov_b32 exec_hi, 0xffff
    buffer_store_dwordx4 v[84:87], v4, s[8:11], s38 offen offset:1024 sc1
    s_mov_b64 exec, -1
L_rows2:
    v_pk_fma_f32 v[192:193], v[192:193], v[24:25], v[16:17]
    v_pk_fma_f32 v[194:195], v[194:195], v[26:27], v[18:19]
    v_pk_fma_f32 v[196:197], v[196:197], v[28:29], v[20:21]
    v_pk_fma_f32 v[198:199], v[198:199], v[30:31], v[22:23]
    v_cvt_pk_bf16_f32 v64, v192, v193
    v_cvt_pk_bf16_f32 v65, v194, v195
    v_cvt_pk_bf16_f32 v66, v196, v197
    v_cvt_pk_bf16_f32 v67, v198, v199
    ds_write_b128 v6, v[64:67] offset:0
    v_pk_fma_f32 v[200:201], v[200:201], v[24:25], v[16:17]
    v_pk_fma_f32 v[202:203], v[202:203], v[26:27], v[18:19]
    v_pk_fma_f32 v[204:205], v[204:205], v[28:29], v[20:21]
    v_pk_fma_f32 v[206:207], v[206:207], v[30:31], v[22:23]
    v_cvt_pk_bf16_f32 v68, v200, v201
    v_cvt_pk_bf16_f32 v69, v202, v203
    v_cvt_pk_bf16_f32 v70, v204, v205
    v_cvt_pk_bf16_f32 v71, v206, v207
    ds_write_b128 v6, v[68:71] offset:16
    v_pk_fma_f32 v[208:209], v[208:209], v[24:25], v[16:17]
    v_pk_fma_f32 v[210:211], v[210:211], v[26:27], v[18:19]
    v_pk_fma_f32 v[212:213], v[212:213], v[28:29], v[20:21]
    v_pk_fma_f32 v[214:215], v[214:215], v[30:31], v[22:23]
    v_cvt_pk_bf16_f32 v72, v208, v209
    v_cvt_pk_bf16_f32 v73, v210, v211
    v_cvt_pk_bf16_f32 v74, v212, v213
    v_cvt_pk_bf16_f32 v75, v214, v215
    ds_write_b128 v6, v[72:75] offset:32
    v_pk_fma_f32 v[216:217], v[216:217], v[24:25], v[16:17]
    v_pk_fma_f32 v[218:219], v[218:219], v[26:27], v[18:19]
    v_pk_fma_f32 v[220:221], v[220:221], v[28:29], v[20:21]
    v_pk_fma_f32 v[222:223], v[222:223], v[30:31], v[22:23]
    v_cvt_pk_bf16_f32 v76, v216, v217
    v_cvt_pk_bf16_f32 v77, v218, v219
    v_cvt_pk_bf16_f32 v78, v220, v221
    v_cvt_pk_bf16_f32 v79, v222, v223
    ds_write_b128 v6, v[76:79] offset:48
    v_pk_fma_f32 v[224:225], v[224:225], v[24:25], v[16:17]
    v_pk_fma_f32 v[226:227], v[226:227], v[26:27], v[18:19]
    v_pk_fma_f32 v[228:229], v[228:229], v[28:29], v[20:21]
    v_pk_fma_f32 v[230:231], v[230:231], v[30:31], v[22:23]
    v_cvt_pk_bf16_f32 v64, v224, v225
    v_cvt_pk_bf16_f32 v65, v226, v227
    v_cvt_pk_bf16_f32 v66, v228, v229
    v_cvt_pk_bf16_f32 v67, v230, v231
    ds_write_b128 v6, v[64:67] offset:64
    v_pk_fma_f32 v[232:233], v[232:233], v[24:25], v[16:17]
    v_pk_fma_f32 v[234:235], v[234:235], v[26:27], v[18:19]
    v_pk_fma_f32 v[236:237], v[236:237], v[28:29], v[20:21]
    v_pk_fma_f32 v[238:239], v[238:239], v[30:31], v[22:23]
    v_cvt_pk_bf16_f32 v68, v232, v233
    v_cvt_pk_bf16_f32 v69, v234, v235
    v_cvt_pk_bf16_f32 v70, v236, v237
    v_cvt_pk_bf16_f32 v71, v238, v239
    ds_write_b128 v6, v[68:71] offset:80
    v_pk_fma_f32 v[240:241], v[240:241], v[24:25], v[16:17]
    v_pk_fma_f32 v[242:243], v[242:243], v[26:27], v[18:19]
    v_pk_fma_f32 v[244:245], v[244:245], v[28:29], v[20:21]
    v_pk_fma_f32 v[246:247], v[246:247], v[30:31], v[22:23]
    v_cvt_pk_bf16_f32 v72, v240, v241
    v_cvt_pk_bf16_f32 v73, v242, v243
    v_cvt_pk_bf16_f32 v74, v244, v245
    v_cvt_pk_bf16_f32 v75, v246, v247
    ds_write_b128 v6, v[72:75] offset:96
    v_pk_fma_f32 v[248:249], v[248:249], v[24:25], v[16:17]
    v_pk_fma_f32 v[250:251], v[250:251], v[26:27], v[18:19]
    v_pk_fma_f32 v[252:253], v[252:253], v[28:29], v[20:21]
    v_pk_fma_f32 v[254:255], v[254:255], v[30:31], v[22:23]
    v_cvt_pk_bf16_f32 v76, v248, v249
    v_cvt_pk_bf16_f32 v77, v250, v251
    v_cvt_pk_bf16_f32 v78, v252, v253
    v_cvt_pk_bf16_f32 v79, v254, v255
    ds_write_b128 v6, v[76:79] offset:112
    v_mul_u32_u24 v3, 528, v11
    v_and_b32 v4, 31, v1
    v_lshl_add_u32 v3, v4, 4, v3
    s_mul_i32 s38, s36, 33792
    v_add_u32 v3, s38, v3
    v_lshrrev_b32 v4, 5, v1
    v_bfe_u32 v9, v1, 2, 2
    v_lshl_add_u32 v4, v4, 3, v9
    v_lshrrev_b32 v9, 1, v9
    v_xor_b32 v9, s37, v9
    v_lshl_add_u32 v4, v4, 1, v9
    v_bfe_u32 v9, v1, 4, 1
    v_lshl_add_u32 v4, v4, 1, v9
    v_and_b32 v9, 3, v1
    v_lshl_add_u32 v4, v4, 2, v9
    v_lshlrev_b32 v4, 3, v4
    v_add_u32 v4, 67584, v4
    s_cmp_ge_u32 s34, 2
    s_cbranch_scc1 L_nokvflag
    v_mov_b32 v8, s35
    s_lshl_b32 s38, s33, 1
    s_add_u32 s38, s38, s34
    s_lshl_b32 s38, s38, 7
    s_add_u32 s38, s38, 16384
    s_cmp_eq_u32 s32, 0
    s_cselect_b32 s14, s10, 0
    s_waitcnt vmcnt(0)
    s_waitcnt lgkmcnt(0)
    s_barrier
    buffer_store_dword v8, off, s[12:15], s38 sc1
    s_branch L_qgemm
L_nokvflag:
    s_cmp_lg_u32 s34, 2
    s_cbranch_scc1 L_wq_in
    s_waitcnt vmcnt(0)
L_wq_in:
    s_waitcnt lgkmcnt(0)
    s_barrier
L_qgemm:
    ds_read_b128 a[0:3], v3 offset:0
    ds_read_b64_tr_b16 a[32:33], v4 offset:0
    ds_read_b64_tr_b16 a[34:35], v4 offset:512
    ds_read_b128 a[4:7], v3 offset:1056
    ds_read_b64_tr_b16 a[36:37], v4 offset:2048
    ds_read_b64_tr_b16 a[38:39], v4 offset:2560
    ds_read_b128 a[8:11], v3 offset:2112
    ds_read_b64_tr_b16 a[40:41], v4 offset:4096
    ds_read_b64_tr_b16 a[42:43], v4 offset:4608
    ds_read_b128 a[12:15], v3 offset:3168
    ds_read_b64_tr_b16 a[44:45], v4 offset:6144
    ds_read_b64_tr_b16 a[46:47], v4 offset:6656
    s_waitcnt lgkmcnt(9)
    v_mfma_f32_32x32x16_bf16 v[16:31], a[32:35], a[0:3], 0
    s_cmp_eq_u32 s34, 3
    s_cselect_b32 s3, 5, s34
    ds_read_b128 a[16:19], v3 offset:4224
    ds_read_b64_tr_b16 a[48:49], v4 offset:8192
    ds_read_b64_tr_b16 a[50:51], v4 offset:8704
    s_waitcnt lgkmcnt(9)
    v_mfma_f32_32x32x16_bf16 v[16:31], a[36:39], a[4:7], v[16:31]
    s_cmp_eq_u32 s34, 5
    s_cselect_b32 s3, 3, s3
    ds_read_b128 a[20:23], v3 offset:5280
    ds_read_b64_tr_b16 a[52:53], v4 offset:10240
    ds_read_b64_tr_b16 a[54:55], v4 offset:10752
    s_waitcnt lgkmcnt(9)
    v_mfma_f32_32x32x16_bf16 v[16:31], a[40:43], a[8:11], v[16:31]
    s_mov_b32 s34, s3
    s_lshl_b32 s52, s33, 16
    ds_read_b128 a[24:27], v3 offset:6336
    ds_read_b64_tr_b16 a[56:57], v4 offset:12288
    ds_read_b64_tr_b16 a[58:59], v4 offset:12800
    s_waitcnt lgkmcnt(9)
    v_mfma_f32_32x32x16_bf16 v[16:31], a[44:47], a[12:15], v[16:31]
    s_lshl_b32 s3, s36, 15
    s_add_u32 s52, s52, s3
    ds_read_b128 a[28:31], v3 offset:7392
    ds_read_b64_tr_b16 a[60:61], v4 offset:14336
    ds_read_b64_tr_b16 a[62:63], v4 offset:14848
    s_waitcnt lgkmcnt(9)
    v_mfma_f32_32x32x16_bf16 v[16:31], a[48:51], a[16:19], v[16:31]
    s_lshl_b32 s3, s34, 7
    s_add_u32 s52, s52, s3
    ds_read_b128 a[0:3], v3 offset:8448
    ds_read_b64_tr_b16 a[32:33], v4 offset:16384
    ds_read_b64_tr_b16 a[34:35], v4 offset:16896
    s_waitcnt lgkmcnt(9)
    v_mfma_f32_32x32x16_bf16 v[16:31], a[52:55], a[20:23], v[16:31]
    s_lshl_b32 s3, s37, 6
    s_add_u32 s52, s52, s3
    ds_read_b128 a[4:7], v3 offset:9504
    ds_read_b64_tr_b16 a[36:37], v4 offset:18432
    ds_read_b64_tr_b16 a[38:39], v4 offset:18944
    s_waitcnt lgkmcnt(9)
    v_mfma_f32_32x32x16_bf16 v[16:31], a[56:59], a[24:27], v[16:31]
    s_lshl_b32 s45, s32, 3
    s_add_u32 s45, s45, s34
    ds_read_b128 a[8:11], v3 offset:10560
    ds_read_b64_tr_b16 a[40:41], v4 offset:20480
    ds_read_b64_tr_b16 a[42:43], v4 offset:20992
    s_waitcnt lgkmcnt(9)
    v_mfma_f32_32x32x16_bf16 v[16:31], a[60:63], a[28:31], v[16:31]
    s_lshl_b32 s47, s45, 15
    s_add_u32 s47, s47, 3145728
    ds_read_b128 a[12:15], v3 offset:11616
    ds_read_b64_tr_b16 a[44:45], v4 offset:22528
    ds_read_b64_tr_b16 a[46:47], v4 offset:23040
    s_waitcnt lgkmcnt(9)
    v_mfma_f32_32x32x16_bf16 v[16:31], a[32:35], a[0:3], v[16:31]
    s_cmp_lt_u32 s45, 22
    s_cselect_b32 s47, s47, 33554432
    ds_read_b128 a[16:19], v3 offset:12672
    ds_read_b64_tr_b16 a[48:49], v4 offset:24576
    ds_read_b64_tr_b16 a[50:51], v4 offset:25088
    s_waitcnt lgkmcnt(9)
    v_mfma_f32_32x32x16_bf16 v[16:31], a[36:39], a[4:7], v[16:31]
    s_lshl_b32 s46, s45, 15
    s_add_u32 s46, s46, 1048576
    ds_read_b128 a[20:23], v3 offset:13728
    ds_read_b64_tr_b16 a[52:53], v4 offset:26624
    ds_read_b64_tr_b16 a[54:55], v4 offset:27136
    s_waitcnt lgkmcnt(9)
    v_mfma_f32_32x32x16_bf16 v[16:31], a[40:43], a[8:11], v[16:31]
    s_lshl_b32 s48, s34, 7
    s_lshl_b32 s49, s32, 17
    ds_read_b128 a[24:27], v3 offset:14784
    ds_read_b64_tr_b16 a[56:57], v4 offset:28672
    ds_read_b64_tr_b16 a[58:59], v4 offset:29184
    s_waitcnt lgkmcnt(9)
    v_mfma_f32_32x32x16_bf16 v[16:31], a[44:47], a[12:15], v[16:31]
    s_add_u32 s48, s48, s49
    s_lshl_b32 s49, s32, 14
    ds_read_b128 a[28:31], v3 offset:15840
    ds_read_b64_tr_b16 a[60:61], v4 offset:30720
    ds_read_b64_tr_b16 a[62:63], v4 offset:31232
    s_waitcnt lgkmcnt(9)
    v_mfma_f32_32x32x16_bf16 v[16:31], a[48:51], a[16:19], v[16:31]
    s_mov_b32 s50, 24576
    s_lshl_b32 s51, s33, 5
    ds_read_b128 a[0:3], v3 offset:16896
    ds_read_b64_tr_b16 a[32:33], v4 offset:32768
    ds_read_b64_tr_b16 a[34:35], v4 offset:33280
    s_waitcnt lgkmcnt(9)
    v_mfma_f32_32x32x16_bf16 v[16:31], a[52:55], a[20:23], v[16:31]
    s_add_u32 s51, s51, 24576
    s_lshl_b32 s53, s34, 2
    ds_read_b128 a[4:7], v3 offset:17952
    ds_read_b64_tr_b16 a[36:37], v4 offset:34816
    ds_read_b64_tr_b16 a[38:39], v4 offset:35328
    s_waitcnt lgkmcnt(9)
    v_mfma_f32_32x32x16_bf16 v[16:31], a[56:59], a[24:27], v[16:31]
    s_add_u32 s53, s53, s51
    s_lshl_b32 s54, s32, 3
    ds_read_b128 a[8:11], v3 offset:19008
    ds_read_b64_tr_b16 a[40:41], v4 offset:36864
    ds_read_b64_tr_b16 a[42:43], v4 offset:37376
    s_waitcnt lgkmcnt(9)
    v_mfma_f32_32x32x16_bf16 v[16:31], a[60:63], a[28:31], v[16:31]
    s_add_u32 s54, s54, s34
    s_lshl_b32 s54, s54, 8
    ds_read_b128 a[12:15], v3 offset:20064
    ds_read_b64_tr_b16 a[44:45], v4 offset:38912
    ds_read_b64_tr_b16 a[46:47], v4 offset:39424
    s_waitcnt lgkmcnt(9)
    v_mfma_f32_32x32x16_bf16 v[16:31], a[32:35], a[0:3], v[16:31]
    s_add_u32 s67, s54, 262144
    s_lshl_b32 s54, s40, 5
    ds_read_b128 a[16:19], v3 offset:21120
    ds_read_b64_tr_b16 a[48:49], v4 offset:40960
    ds_read_b64_tr_b16 a[50:51], v4 offset:41472
    s_waitcnt lgkmcnt(9)
    v_mfma_f32_32x32x16_bf16 v[16:31], a[36:39], a[4:7], v[16:31]
    s_add_u32 s54, s54, s33
    s_lshl_b32 s54, s54, 2
    ds_read_b128 a[20:23], v3 offset:22176
    ds_read_b64_tr_b16 a[52:53], v4 offset:43008
    ds_read_b64_tr_b16 a[54:55], v4 offset:43520
    s_waitcnt lgkmcnt(9)
    v_mfma_f32_32x32x16_bf16 v[16:31], a[40:43], a[8:11], v[16:31]
    s_add_u32 s54, s54, 28672
    s_cmp_le_u32 s40, 4
    ds_read_b128 a[24:27], v3 offset:23232
    ds_read_b64_tr_b16 a[56:57], v4 offset:45056
    ds_read_b64_tr_b16 a[58:59], v4 offset:45568
    s_waitcnt lgkmcnt(9)
    v_mfma_f32_32x32x16_bf16 v[16:31], a[44:47], a[12:15], v[16:31]
    s_cselect_b32 s54, s54, 33554432
    s_cmp_eq_u32 s32, 2
    ds_read_b128 a[28:31], v3 offset:24288
    ds_read_b64_tr_b16 a[60:61], v4 offset:47104
    ds_read_b64_tr_b16 a[62:63], v4 offset:47616
    s_waitcnt lgkmcnt(9)
    v_mfma_f32_32x32x16_bf16 v[16:31], a[48:51], a[16:19], v[16:31]
    s_cselect_b32 s65, 1.0, 0
    s_lshl_b32 s43, s32, 8
    ds_read_b128 a[0:3], v3 offset:25344
    ds_read_b64_tr_b16 a[32:33], v4 offset:49152
    ds_read_b64_tr_b16 a[34:35], v4 offset:49664
    s_waitcnt lgkmcnt(9)
    v_mfma_f32_32x32x16_bf16 v[16:31], a[52:55], a[20:23], v[16:31]
    s_add_u32 s43, s43, 137216
    s_getreg_b32 s55, hwreg(HW_REG_XCC_ID, 0, 3)
    ds_read_b128 a[4:7], v3 offset:26400
    ds_read_b64_tr_b16 a[36:37], v4 offset:51200
    ds_read_b64_tr_b16 a[38:39], v4 offset:51712
    s_waitcnt lgkmcnt(9)
    v_mfma_f32_32x32x16_bf16 v[16:31], a[56:59], a[24:27], v[16:31]
    s_add_u32 s56, s55, s35
    s_cmp_eq_u32 s32, 0
    ds_read_b128 a[8:11], v3 offset:27456
    ds_read_b64_tr_b16 a[40:41], v4 offset:53248
    ds_read_b64_tr_b16 a[42:43], v4 offset:53760
    s_waitcnt lgkmcnt(9)
    v_mfma_f32_32x32x16_bf16 v[16:31], a[60:63], a[28:31], v[16:31]
    s_cselect_b32 s14, s10, 0
    s_lshl_b32 s62, s33, 16
    ds_read_b128 a[12:15], v3 offset:28512
    ds_read_b64_tr_b16 a[44:45], v4 offset:55296
    ds_read_b64_tr_b16 a[46:47], v4 offset:55808
    s_waitcnt lgkmcnt(9)
    v_mfma_f32_32x32x16_bf16 v[16:31], a[32:35], a[0:3], v[16:31]
    s_lshl_b32 s57, s45, 11
    s_add_u32 s57, s57, s62
    ds_read_b128 a[16:19], v3 offset:29568
    ds_read_b64_tr_b16 a[48:49], v4 offset:57344
    ds_read_b64_tr_b16 a[50:51], v4 offset:57856
    s_waitcnt lgkmcnt(9)
    v_mfma_f32_32x32x16_bf16 v[16:31], a[36:39], a[4:7], v[16:31]
    s_mov_b32 s68, s24
    s_mov_b32 s69, s25
    ds_read_b128 a[20:23], v3 offset:30624
    ds_read_b64_tr_b16 a[52:53], v4 offset:59392
    ds_read_b64_tr_b16 a[54:55], v4 offset:59904
    s_waitcnt lgkmcnt(9)
    v_mfma_f32_32x32x16_bf16 v[16:31], a[40:43], a[8:11], v[16:31]
    s_mov_b32 s70, 0
    s_mov_b32 s71, 0x20000
    ds_read_b128 a[24:27], v3 offset:31680
    ds_read_b64_tr_b16 a[56:57], v4 offset:61440
    ds_read_b64_tr_b16 a[58:59], v4 offset:61952
    s_waitcnt lgkmcnt(9)
    v_mfma_f32_32x32x16_bf16 v[16:31], a[44:47], a[12:15], v[16:31]
    s_mov_b32 s72, s24
    s_mov_b32 s73, s25
    ds_read_b128 a[28:31], v3 offset:32736
    ds_read_b64_tr_b16 a[60:61], v4 offset:63488
    ds_read_b64_tr_b16 a[62:63], v4 offset:64000
    s_waitcnt lgkmcnt(9)
    v_mfma_f32_32x32x16_bf16 v[16:31], a[48:51], a[16:19], v[16:31]
    s_mov_b32 s74, 0
    s_mov_b32 s75, 0x20000
    s_waitcnt lgkmcnt(6)
    v_mfma_f32_32x32x16_bf16 v[16:31], a[52:55], a[20:23], v[16:31]
    s_waitcnt lgkmcnt(3)
    v_mfma_f32_32x32x16_bf16 v[16:31], a[56:59], a[24:27], v[16:31]
    s_waitcnt lgkmcnt(0)
    v_mfma_f32_32x32x16_bf16 v[16:31], a[60:63], a[28:31], v[16:31]
    s_cmp_gt_u32 s40, 1
    s_cbranch_scc1 L_qdone
    s_waitcnt vmcnt(9)
    v_lshlrev_b32 v64, 16, v88
    v_and_b32 v65, 0xffff0000, v88
    v_mul_f32 v66, 0xbfb8aa3b, v64
    v_mul_f32 v67, 0xbfb8aa3b, v65
    v_exp_f32 v66, v66
    v_exp_f32 v67, v67
    v_mov_b32 v68, 0
    v_mov_b32 v69, 0
    v_mov_b32 v70, 0
    v_mov_b32 v71, 0
    v_mov_b32 v72, 0
    v_mov_b32 v73, 0
    v_mov_b32 v74, 0
    v_mov_b32 v75, 0
    v_add_f32 v66, 1.0, v66
    v_add_f32 v67, 1.0, v67
    v_rcp_f32 v66, v66
    v_rcp_f32 v67, v67
    s_mov_b32 s38, 0x05040100
    s_mov_b32 s39, 0x07060302
    v_mul_f32 v64, v64, v66
    v_mul_f32 v65, v65, v67
    v_cvt_pk_bf16_f32 v64, v64, v65
    s_waitcnt vmcnt(6)
    v_perm_b32 v76, v36, v32, s38
    v_perm_b32 v77, v36, v32, s39
    v_perm_b32 v78, v37, v33, s38
    v_perm_b32 v79, v37, v33, s39
    v_perm_b32 v80, v38, v34, s38
    v_perm_b32 v81, v38, v34, s39
    v_perm_b32 v82, v39, v35, s38
    v_perm_b32 v83, v39, v35, s39
    v_dot2c_f32_bf16_dpp v68, v64, v76 quad_perm:[0,0,0,0] row_mask:0xf bank_mask:0xf
    v_dot2c_f32_bf16_dpp v69, v64, v77 quad_perm:[0,0,0,0] row_mask:0xf bank_mask:0xf
    v_dot2c_f32_bf16_dpp v70, v64, v78 quad_perm:[0,0,0,0] row_mask:0xf bank_mask:0xf
    v_dot2c_f32_bf16_dpp v71, v64, v79 quad_perm:[0,0,0,0] row_mask:0xf bank_mask:0xf
    v_dot2c_f32_bf16_dpp v72, v64, v80 quad_perm:[0,0,0,0] row_mask:0xf bank_mask:0xf
    v_dot2c_f32_bf16_dpp v73, v64, v81 quad_perm:[0,0,0,0] row_mask:0xf bank_mask:0xf
    v_dot2c_f32_bf16_dpp v74, v64, v82 quad_perm:[0,0,0,0] row_mask:0xf bank_mask:0xf
    v_dot2c_f32_bf16_dpp v75, v64, v83 quad_perm:[0,0,0,0] row_mask:0xf bank_mask:0xf
    s_waitcnt vmcnt(4)
    v_perm_b32 v76, v44, v40, s38
    v_perm_b32 v77, v44, v40, s39
    v_perm_b32 v78, v45, v41, s38
    v_perm_b32 v79, v45, v41, s39
    v_perm_b32 v80, v46, v42, s38
    v_perm_b32 v81, v46, v42, s39
    v_perm_b32 v82, v47, v43, s38
    v_perm_b32 v83, v47, v43, s39
    v_dot2c_f32_bf16_dpp v68, v64, v76 quad_perm:[1,1,1,1] row_mask:0xf bank_mask:0xf
    v_dot2c_f32_bf16_dpp v69, v64, v77 quad_perm:[1,1,1,1] row_mask:0xf bank_mask:0xf
    v_dot2c_f32_bf16_dpp v70, v64, v78 quad_perm:[1,1,1,1] row_mask:0xf bank_mask:0xf
    v_dot2c_f32_bf16_dpp v71, v64, v79 quad_perm:[1,1,1,1] row_mask:0xf bank_mask:0xf
    v_dot2c_f32_bf16_dpp v72, v64, v80 quad_perm:[1,1,1,1] row_mask:0xf bank_mask:0xf
    v_dot2c_f32_bf16_dpp v73, v64, v81 quad_perm:[1,1,1,1] row_mask:0xf bank_mask:0xf
    v_dot2c_f32_bf16_dpp v74, v64, v82 quad_perm:[1,1,1,1] row_mask:0xf bank_mask:0xf
    v_dot2c_f32_bf16_dpp v75, v64, v83 quad_perm:[1,1,1,1] row_mask:0xf bank_mask:0xf
    s_waitcnt vmcnt(2)
    v_perm_b32 v76, v52, v48, s38
    v_perm_b32 v77, v52, v48, s39
    v_perm_b32 v78, v53, v49, s38
    v_perm_b32 v79, v53, v49, s39
    v_perm_b32 v80, v54, v50, s38
    v_perm_b32 v81, v54, v50, s39
    v_perm_b32 v82, v55, v51, s38
    v_perm_b32 v83, v55, v51, s39
    v_dot2c_f32_bf16_dpp v68, v64, v76 quad_perm:[2,2,2,2] row_mask:0xf bank_mask:0xf
    v_dot2c_f32_bf16_dpp v69, v64, v77 quad_perm:[2,2,2,2] row_mask:0xf bank_mask:0xf
    v_dot2c_f32_bf16_dpp v70, v64, v78 quad_perm:[2,2,2,2] row_mask:0xf bank_mask:0xf
    v_dot2c_f32_bf16_dpp v71, v64, v79 quad_perm:[2,2,2,2] row_mask:0xf bank_mask:0xf
    v_dot2c_f32_bf16_dpp v72, v64, v80 quad_perm:[2,2,2,2] row_mask:0xf bank_mask:0xf
    v_dot2c_f32_bf16_dpp v73, v64, v81 quad_perm:[2,2,2,2] row_mask:0xf bank_mask:0xf
    v_dot2c_f32_bf16_dpp v74, v64, v82 quad_perm:[2,2,2,2] row_mask:0xf bank_mask:0xf
    v_dot2c_f32_bf16_dpp v75, v64, v83 quad_perm:[2,2,2,2] row_mask:0xf bank_mask:0xf
    s_waitcnt vmcnt(0)
    v_perm_b32 v76, v60, v56, s38
    v_perm_b32 v77, v60, v56, s39
    v_perm_b32 v78, v61, v57, s38
    v_perm_b32 v79, v61, v57, s39
    v_perm_b32 v80, v62, v58, s38
    v_perm_b32 v81, v62, v58, s39
    v_perm_b32 v82, v63, v59, s38
    v_perm_b32 v83, v63, v59, s39
    v_dot2c_f32_bf16_dpp v68, v64, v76 quad_perm:[3,3,3,3] row_mask:0xf bank_mask:0xf
    v_dot2c_f32_bf16_dpp v69, v64, v77 quad_perm:[3,3,3,3] row_mask:0xf bank_mask:0xf
    v_dot2c_f32_bf16_dpp v70, v64, v78 quad_perm:[3,3,3,3] row_mask:0xf bank_mask:0xf
    v_dot2c_f32_bf16_dpp v71, v64, v79 quad_perm:[3,3,3,3] row_mask:0xf bank_mask:0xf
    v_dot2c_f32_bf16_dpp v72, v64, v80 quad_perm:[3,3,3,3] row_mask:0xf bank_mask:0xf
    v_dot2c_f32_bf16_dpp v73, v64, v81 quad_perm:[3,3,3,3] row_mask:0xf bank_mask:0xf
    v_dot2c_f32_bf16_dpp v74, v64, v82 quad_perm:[3,3,3,3] row_mask:0xf bank_mask:0xf
    v_dot2c_f32_bf16_dpp v75, v64, v83 quad_perm:[3,3,3,3] row_mask:0xf bank_mask:0xf
    s_lshl_b32 s38, s32, 11
    s_add_u32 s38, s38, 139264
    v_lshl_add_u32 v64, v1, 5, s38
    s_lshl_b32 s38, s32, 9
    v_lshl_add_u32 v65, v1, 3, s38
    ds_write_b128 v64, v[68:71]
    ds_write_b128 v64, v[72:75] offset:16
    v_add_u32 v64, 139264, v65
    s_add_u32 s41, s41, 262144
    s_waitcnt lgkmcnt(0)
    s_barrier
    ds_read_b64 v[68:69], v64 offset:0
    ds_read_b64 v[70:71], v64 offset:2048
    ds_read_b64 v[72:73], v64 offset:4096
    ds_read_b64 v[74:75], v64 offset:6144
    s_waitcnt lgkmcnt(2)
    v_pk_add_f32 v[68:69], v[68:69], v[70:71]
    s_waitcnt lgkmcnt(0)
    v_pk_add_f32 v[72:73], v[72:73], v[74:75]
    v_pk_add_f32 v[84:85], v[68:69], v[72:73]
    s_branch L_qdone2
L_qdone:
    s_cmp_gt_u32 s40, 4
    s_cbranch_scc1 L_qdone1
    s_mul_i32 s39, s32, 4608
    s_add_u32 s39, s39, 139264
    v_lshrrev_b32 v64, 4, v1
    v_mul_u32_u24 v64, 576, v64
    v_and_b32 v65, 15, v1
    v_lshlrev_b32 v65, 4, v65
    v_add3_u32 v64, v64, v65, s39
    v_bfe_u32 v65, v1, 2, 2
    v_lshl_add_u32 v65, v11, 2, v65
    v_mul_u32_u24 v65, 576, v65
    v_bfe_u32 v66, v1, 4, 1
    v_mul_u32_u24 v66, 288, v66
    v_add3_u32 v65, v65, v66, s39
    v_add_u32 v65, v65, v8
    s_waitcnt vmcnt(7)
    ds_write_b128 v64, v[32:35] offset:0
    s_waitcnt vmcnt(6)
    ds_write_b128 v64, v[36:39] offset:288
    s_waitcnt vmcnt(5)
    ds_write_b128 v64, v[40:43] offset:2304
    s_waitcnt vmcnt(4)
    ds_write_b128 v64, v[44:47] offset:2592
    ds_read_b64_tr_b16 v[128:129], v65 offset:0
    ds_read_b64_tr_b16 v[132:133], v65 offset:32
    ds_read_b64_tr_b16 v[136:137], v65 offset:64
    ds_read_b64_tr_b16 v[140:141], v65 offset:96
    ds_read_b64_tr_b16 v[144:145], v65 offset:128
    ds_read_b64_tr_b16 v[148:149], v65 offset:160
    ds_read_b64_tr_b16 v[152:153], v65 offset:192
    ds_read_b64_tr_b16 v[156:157], v65 offset:224
    s_waitcnt vmcnt(3)
    ds_write_b128 v64, v[48:51] offset:0
    s_waitcnt vmcnt(2)
    ds_write_b128 v64, v[52:55] offset:288
    s_waitcnt vmcnt(1)
    ds_write_b128 v64, v[56:59] offset:2304
    s_waitcnt vmcnt(0)
    ds_write_b128 v64, v[60:63] offset:2592
    ds_read_b64_tr_b16 v[130:131], v65 offset:0
    ds_read_b64_tr_b16 v[134:135], v65 offset:32
    ds_read_b64_tr_b16 v[138:139], v65 offset:64
    ds_read_b64_tr_b16 v[142:143], v65 offset:96
    ds_read_b64_tr_b16 v[146:147], v65 offset:128
    ds_read_b64_tr_b16 v[150:151], v65 offset:160
    ds_read_b64_tr_b16 v[154:155], v65 offset:192
    ds_read_b64_tr_b16 v[158:159], v65 offset:224
L_qdone1:
    s_barrier
L_qdone2:
    v_and_b32 v3, 15, v1
    v_lshlrev_b32 v105, 9, v3
    s_lshl_b32 s58, s32, 7
    s_add_u32 s58, s58, 16384
    buffer_load_dword v104, v105, s[8:11], s58 offen sc1
    v_and_b32 v0, 31, v1
    v_lshlrev_b32 v0, 10, v0
    v_lshrrev_b32 v106, 5, v1
    v_lshl_add_u32 v0, v106, 3, v0
    s_load_dwordx2 s[28:29], s[0:1], 32
    s_load_dwordx2 s[4:5], s[0:1], 64
    s_mov_b32 s30, 524288
    s_mov_b32 s6, 1409024
    s_mov_b32 s60, 0x3eb8aa3b
    s_lshl_b32 s44, s32, 11
    s_add_u32 s44, s44, 131072
    s_mul_i32 m0, s32, 2080
    v_pk_mul_f32 v[16:17], v[16:17], s[60:61] op_sel_hi:[1,0]
    v_pk_mul_f32 v[18:19], v[18:19], s[60:61] op_sel_hi:[1,0]
    v_pk_mul_f32 v[20:21], v[20:21], s[60:61] op_sel_hi:[1,0]
    v_pk_mul_f32 v[22:23], v[22:23], s[60:61] op_sel_hi:[1,0]
    v_pk_mul_f32 v[24:25], v[24:25], s[60:61] op_sel_hi:[1,0]
    v_pk_mul_f32 v[26:27], v[26:27], s[60:61] op_sel_hi:[1,0]
    v_pk_mul_f32 v[28:29], v[28:29], s[60:61] op_sel_hi:[1,0]
    v_pk_mul_f32 v[30:31], v[30:31], s[60:61] op_sel_hi:[1,0]
    v_cvt_pk_bf16_f32 v8, v16, v17
    v_cvt_pk_bf16_f32 v9, v18, v19
    v_cvt_pk_bf16_f32 v10, v20, v21
    v_cvt_pk_bf16_f32 v11, v22, v23
    v_cvt_pk_bf16_f32 v12, v24, v25
    v_cvt_pk_bf16_f32 v13, v26, v27
    v_cvt_pk_bf16_f32 v14, v28, v29
    v_cvt_pk_bf16_f32 v15, v30, v31
    v_mul_u32_u24 v3, 2080, v1
    v_mov_b32 v120, 0x3f803f80
    v_mov_b32 v124, 0
    v_mov_b32 v121, 0x3f803f80
    v_mov_b32 v125, 0
    v_mov_b32 v122, 0x3f803f80
    v_mov_b32 v126, 0
    v_mov_b32 v123, 0x3f803f80
    v_mov_b32 v127, 0
    ds_write_b128 v3, v[120:123] offset:2048
    ds_write_b128 v3, v[124:127] offset:2064
    v_mov_b32 v4, v2
    v_lshrrev_b32 v106, 5, v1
    v_lshlrev_b32 v106, 4, v106
    v_and_b32 v107, 15, v1
    v_add_lshl_u32 v106, v106, v107, 4
    v_add_u32 v5, 1024, v106
    v_add_u32 v6, 1536, v106
    v_and_b32 v108, 27, v1
    v_cmp_eq_u32 vcc, 16, v108
    v_mov_b32 v106, 2048
    v_mov_b32 v107, 2064
    v_cndmask_b32 v5, v5, v106, vcc
    v_cndmask_b32 v6, v6, v106, vcc
    v_cmp_lt_u32 vcc, 16, v108
    v_mov_b32 v7, 0xdddddddd
    s_nop 0
    v_cndmask_b32 v5, v5, v107, vcc
    v_cndmask_b32 v6, v6, v107, vcc
    s_waitcnt vmcnt(4)
    v_mov_b32 v48, 0
    v_mov_b32 v49, 0
    v_mov_b32 v50, 0
    v_mov_b32 v51, 0
    s_waitcnt vmcnt(3)
    v_mov_b32 v52, 0
    v_mov_b32 v53, 0
    v_mov_b32 v54, 0
    v_mov_b32 v55, 0
    s_waitcnt vmcnt(2)
    v_mov_b32 v56, 0
    v_mov_b32 v57, 0
    v_mov_b32 v58, 0
    v_mov_b32 v59, 0
    s_waitcnt vmcnt(1)
    v_mov_b32 v60, 0
    v_mov_b32 v61, 0
    v_mov_b32 v62, 0
    v_mov_b32 v63, 0
    v_mov_b32 v64, 0
    v_mov_b32 v65, 0
    v_mov_b32 v66, 0
    v_mov_b32 v67, 0
    v_mov_b32 v68, 0
    v_mov_b32 v69, 0
    v_mov_b32 v70, 0
    v_mov_b32 v71, 0
    v_mov_b32 v72, 0
    v_mov_b32 v73, 0
    v_mov_b32 v74, 0
    v_mov_b32 v75, 0
    v_mov_b32 v76, 0
    v_mov_b32 v77, 0
    v_mov_b32 v78, 0
    v_mov_b32 v79, 0
    s_waitcnt vmcnt(0)
    v_cmp_ne_u32 vcc, s35, v104
    s_nop 0
    s_cbranch_vccnz L_late_3
L_ok_4:
    buffer_load_dwordx4 v2, s[8:11], s44 offen sc1 lds
    buffer_load_dwordx4 v2, s[8:11], s44 offen offset:1024 sc1 lds
    s_add_u32 m0, m0, 8320
    s_add_u32 s44, s44, 8192
    buffer_load_dwordx4 v2, s[8:11], s44 offen sc1 lds
    buffer_load_dwordx4 v2, s[8:11], s44 offen offset:1024 sc1 lds
    s_add_u32 m0, m0, 8320
    s_add_u32 s44, s44, 8192
    buffer_load_dwordx4 v2, s[8:11], s44 offen sc1 lds
    buffer_load_dwordx4 v2, s[8:11], s44 offen offset:1024 sc1 lds
    s_add_u32 m0, m0, 8320
    s_add_u32 s44, s44, 8192
    buffer_load_dwordx4 v2, s[8:11], s44 offen sc1 lds
    buffer_load_dwordx4 v2, s[8:11], s44 offen offset:1024 sc1 lds
    v_lshrrev_b32 v124, 3, v1
    v_lshrrev_b32 v125, 2, v1
    v_and_b32 v125, 4, v125
    v_xor_b32 v125, v125, v1
    v_and_b32 v125, 7, v125
    v_lshlrev_b32 v125, 4, v125
    v_lshl_add_u32 v124, v124, 10, v125
    v_add_u32 v126, 7168, v124
    v_and_b32 v3, 7, v1
    v_lshlrev_b32 v3, 2, v3
    s_mov_b32 s3, s40
    s_mov_b32 s66, s41
    s_mov_b32 s38, s67
    s_add_u32 s39, s67, 8192
    s_add_u32 s40, s67, 16384
    s_add_u32 s41, s67, 24576
    v_lshrrev_b32 v110, 4, v1
    v_and_b32 v111, 15, v1
    v_lshlrev_b32 v111, 4, v111
    v_lshl_add_u32 v123, v110, 2, v111
    v_add_u32 v123, s43, v123
    v_lshl_add_u32 v110, v110, 15, v111
    v_mov_b32 v109, s56
    v_lshlrev_b32 v111, 3, v111
    s_cmp_gt_u32 s3, 4
    s_cbranch_scc1 L_side0
    s_cmp_gt_u32 s3, 1
    s_cbranch_scc1 L_side2
    s_lshl_b32 s3, s32, 9
    v_lshl_add_u32 v86, v1, 3, s3
    buffer_store_dwordx2 v[84:85], v86, s[8:11], s66 offen sc1
    s_waitcnt vmcnt(5)
    s_branch L_aligned
L_side2:
    s_waitcnt lgkmcnt(0)
    buffer_store_dwordx4 v[128:131], v2, s[8:11], s42 offen sc1
    s_add_u32 s42, s42, 32768
    buffer_store_dwordx4 v[132:135], v2, s[8:11], s42 offen sc1
    s_add_u32 s42, s42, 32768
    buffer_store_dwordx4 v[136:139], v2, s[8:11], s42 offen sc1
    s_add_u32 s42, s42, 32768
    buffer_store_dwordx4 v[140:143], v2, s[8:11], s42 offen sc1
    s_add_u32 s42, s42, 32768
    buffer_store_dwordx4 v[144:147], v2, s[8:11], s42 offen sc1
    s_add_u32 s42, s42, 32768
    buffer_store_dwordx4 v[148:151], v2, s[8:11], s42 offen sc1
    s_add_u32 s42, s42, 32768
    buffer_store_dwordx4 v[152:155], v2, s[8:11], s42 offen sc1
    s_add_u32 s42, s42, 32768
    buffer_store_dwordx4 v[156:159], v2, s[8:11], s42 offen sc1
    s_waitcnt vmcnt(12)
    s_branch L_aligned
L_side0:
    s_waitcnt vmcnt(4)
    s_branch L_aligned
L_late_3:
    s_mov_b32 s3, 0
L_lspin_5:
    buffer_load_dword v104, v105, s[8:11], s58 offen sc1
    s_waitcnt vmcnt(0)
    v_cmp_ne_u32 vcc, s35, v104
    s_nop 0
    s_cbranch_vccz L_ok_4
    s_add_u32 s3, s3, 1
    s_cmp_lt_u32 s3, 262144
    s_cbranch_scc1 L_lspin_5
    s_branch L_ok_4
L_late_6:
    s_mov_b32 s3, 0
L_lspin_8:
    buffer_load_dwordx4 v[104:107], v2, s[8:11], s50 offen sc1
    buffer_load_dword v108, v3, s[8:11], s51 offen sc1
    buffer_load_dwordx4 v[240:243], v122, s[8:11], s56 offen sc1
    s_waitcnt vmcnt(2)
    v_subrev_u32 v104, s35, v104
    v_subrev_u32 v105, s35, v105
    v_subrev_u32 v106, s35, v106
    v_subrev_u32 v107, s35, v107
    s_waitcnt vmcnt(1)
    v_subrev_u32 v108, s35, v108
    v_or3_b32 v104, v104, v105, v106
    v_or3_b32 v104, v104, v107, v108
    s_waitcnt vmcnt(0)
    v_xor_b32 v240, v109, v240
    v_xor_b32 v241, v109, v241
    v_xor_b32 v242, v109, v242
    v_xor_b32 v243, v109, v243
    v_or3_b32 v104, v104, v240, v241
    v_or3_b32 v104, v104, v242, v243
    v_cmp_lt_u32 vcc, 7, v104
    s_nop 0
    s_cbranch_vccz L_ok_7
    s_add_u32 s3, s3, 1
    s_cmp_lt_u32 s3, 262144
    s_cbranch_scc1 L_lspin_8
    s_branch L_ok_7
L_fallback:
    s_cmp_lg_u32 s40, 0
    s_cbranch_scc1 L_attn_done
    s_mov_b32 s40, 1
    v_mov_b32 v104, 0xff800000
    v_mov_b32 v105, 0xff800000
    s_mov_b32 s38, 131072
L_fb_max:
    buffer_load_dwordx4 v[80:83], v2, s[8:11], s38 offen sc1
    s_waitcnt vmcnt(0)
    v_mfma_f32_32x32x16_bf16 v[16:31], v[80:83], v[8:11], 0
    v_mfma_f32_32x32x16_bf16 v[32:47], v[80:83], v[12:15], 0
    s_nop 10
    v_max3_f32 v104, v104, v16, v17
    v_max3_f32 v104, v104, v18, v19
    v_max3_f32 v104, v104, v20, v21
    v_max3_f32 v104, v104, v22, v23
    v_max3_f32 v104, v104, v24, v25
    v_max3_f32 v104, v104, v26, v27
    v_max3_f32 v104, v104, v28, v29
    v_max3_f32 v104, v104, v30, v31
    v_max3_f32 v105, v105, v32, v33
    v_max3_f32 v105, v105, v34, v35
    v_max3_f32 v105, v105, v36, v37
    v_max3_f32 v105, v105, v38, v39
    v_max3_f32 v105, v105, v40, v41
    v_max3_f32 v105, v105, v42, v43
    v_max3_f32 v105, v105, v44, v45
    v_max3_f32 v105, v105, v46, v47
    s_add_u32 s38, s38, 2048
    s_cmp_lt_u32 s38, 262144
    s_cbranch_scc1 L_fb_max
    v_mov_b32 v106, v104
    s_nop 1
    v_permlane32_swap_b32 v106, v104
    v_max_f32 v104, v104, v106
    v_mov_b32 v106, v105
    s_nop 1
    v_permlane32_swap_b32 v106, v105
    v_max_f32 v105, v105, v106
    v_mov_b32 v48, 0
    v_mov_b32 v49, 0
    v_mov_b32 v50, 0
    v_mov_b32 v51, 0
    v_mov_b32 v52, 0
    v_mov_b32 v53, 0
    v_mov_b32 v54, 0
    v_mov_b32 v55, 0
    v_mov_b32 v56, 0
    v_mov_b32 v57, 0
    v_mov_b32 v58, 0
    v_mov_b32 v59, 0
    v_mov_b32 v60, 0
    v_mov_b32 v61, 0
    v_mov_b32 v62, 0
    v_mov_b32 v63, 0
    v_mov_b32 v64, 0
    v_mov_b32 v65, 0
    v_mov_b32 v66, 0
    v_mov_b32 v67, 0
    v_mov_b32 v68, 0
    v_mov_b32 v69, 0
    v_mov_b32 v70, 0
    v_mov_b32 v71, 0
    v_mov_b32 v72, 0
    v_mov_b32 v73, 0
    v_mov_b32 v74, 0
    v_mov_b32 v75, 0
    v_mov_b32 v76, 0
    v_mov_b32 v77, 0
    v_mov_b32 v78, 0
    v_mov_b32 v79, 0
    v_mov_b32 v88, 0x3f803f80
    v_mov_b32 v89, 0x3f803f80
    v_mov_b32 v90, 0x3f803f80
    v_mov_b32 v91, 0x3f803f80
    v_mov_b32 v92, 0x3f803f80
    v_mov_b32 v93, 0x3f803f80
    v_mov_b32 v94, 0x3f803f80
    v_mov_b32 v95, 0x3f803f80
    v_lshrrev_b32 v106, 5, v1
    v_lshlrev_b32 v106, 4, v106
    v_and_b32 v107, 15, v1
    v_add_lshl_u32 v106, v106, v107, 4
    s_mov_b32 s38, 131072
L_fb_sum:
    buffer_load_dwordx4 v[80:83], v2, s[8:11], s38 offen sc1
    s_mov_b32 exec_lo, 0xffff
    s_mov_b32 exec_hi, 0xffff
    buffer_load_dwordx4 v[88:91], v106, s[8:11], s38 offen offset:1024 sc1
    buffer_load_dwordx4 v[92:95], v106, s[8:11], s38 offen offset:1536 sc1
    s_mov_b64 exec, -1
    s_waitcnt vmcnt(2)
    v_mfma_f32_32x32x16_bf16 v[16:31], v[80:83], v[8:11], 0
    v_mfma_f32_32x32x16_bf16 v[32:47], v[80:83], v[12:15], 0
    s_nop 10
    v_sub_f32 v16, v16, v104
    v_sub_f32 v17, v17, v104
    v_sub_f32 v18, v18, v104
    v_sub_f32 v19, v19, v104
    v_sub_f32 v20, v20, v104
    v_sub_f32 v21, v21, v104
    v_sub_f32 v22, v22, v104
    v_sub_f32 v23, v23, v104
    v_sub_f32 v24, v24, v104
    v_sub_f32 v25, v25, v104
    v_sub_f32 v26, v26, v104
    v_sub_f32 v27, v27, v104
    v_sub_f32 v28, v28, v104
    v_sub_f32 v29, v29, v104
    v_sub_f32 v30, v30, v104
    v_sub_f32 v31, v31, v104
    v_exp_f32 v16, v16
    v_exp_f32 v17, v17
    v_exp_f32 v18, v18
    v_exp_f32 v19, v19
    v_exp_f32 v20, v20
    v_exp_f32 v21, v21
    v_exp_f32 v22, v22
    v_exp_f32 v23, v23
    v_exp_f32 v24, v24
    v_exp_f32 v25, v25
    v_exp_f32 v26, v26
    v_exp_f32 v27, v27
    v_exp_f32 v28, v28
    v_exp_f32 v29, v29
    v_exp_f32 v30, v30
    v_exp_f32 v31, v31
    s_waitcnt vmcnt(1)
    v_smfmac_f32_32x32x32_bf16 v[48:63], v[88:91], v[16:23], v7
    s_waitcnt vmcnt(0)
    v_smfmac_f32_32x32x32_bf16 v[48:63], v[92:95], v[24:31], v7
    v_sub_f32 v32, v32, v105
    v_sub_f32 v33, v33, v105
    v_sub_f32 v34, v34, v105
    v_sub_f32 v35, v35, v105
    v_sub_f32 v36, v36, v105
    v_sub_f32 v37, v37, v105
    v_sub_f32 v38, v38, v105
    v_sub_f32 v39, v39, v105
    v_sub_f32 v40, v40, v105
    v_sub_f32 v41, v41, v105
    v_sub_f32 v42, v42, v105
    v_sub_f32 v43, v43, v105
    v_sub_f32 v44, v44, v105
    v_sub_f32 v45, v45, v105
    v_sub_f32 v46, v46, v105
    v_sub_f32 v47, v47, v105
    v_exp_f32 v32, v32
    v_exp_f32 v33, v33
    v_exp_f32 v34, v34
    v_exp_f32 v35, v35
    v_exp_f32 v36, v36
    v_exp_f32 v37, v37
    v_exp_f32 v38, v38
    v_exp_f32 v39, v39
    v_exp_f32 v40, v40
    v_exp_f32 v41, v41
    v_exp_f32 v42, v42
    v_exp_f32 v43, v43
    v_exp_f32 v44, v44
    v_exp_f32 v45, v45
    v_exp_f32 v46, v46
    v_exp_f32 v47, v47
    v_smfmac_f32_32x32x32_bf16 v[64:79], v[88:91], v[32:39], v7
    s_nop 0
    v_smfmac_f32_32x32x32_bf16 v[64:79], v[92:95], v[40:47], v7
    s_add_u32 s38, s38, 2048
    s_cmp_lt_u32 s38, 262144
    s_cbranch_scc1 L_fb_sum
    s_nop 11
    s_branch L_attn_ok
    .p2align 12
L_aligned:
    s_waitcnt lgkmcnt(0)
    s_barrier
    ds_read_b128 v[80:83], v4
    ds_read_b128 v[88:91], v5
    ds_read_b128 v[92:95], v6
    ds_read_b128 v[84:87], v4 offset:2080
    buffer_store_dword v109, off, s[12:15], s53 sc1
    s_waitcnt lgkmcnt(3)
    v_mfma_f32_32x32x16_bf16 v[16:31], v[80:83], v[8:11], 0
    v_mfma_f32_32x32x16_bf16 v[32:47], v[80:83], v[12:15], 0
    v_mov_b32 v109, s35
    v_min_u32 v122, 624, v2
    s_mov_b32 s56, 28672
    s_lshr_b32 s3, s33, 3
    s_lshl_b32 s3, s3, 2
    s_add_u32 s3, s3, s32
    s_lshl_b32 s3, s3, 14
    s_lshl_b32 s64, s34, 7
    s_add_u32 s64, s64, s3
    v_lshlrev_b32 v127, 3, v111
    s_add_u32 s66, s64, 0x40000
    s_lshl_b32 s67, s2, 2
    s_add_u32 s67, s67, s32
    s_lshl_b32 s67, s67, 11
    s_getpc_b64 s[60:61]
L_pc2:
    s_lshl_b32 s3, s32, 11
    s_add_u32 s3, s3, L_post-L_pc2-8192
    s_add_u32 s58, s60, s3
    s_addc_u32 s59, s61, 0
    s_lshl_b32 s3, s32, 12
    s_min_u32 s3, s3, L_end-L_post-4096
    s_add_u32 s3, s3, L_post-L_pc2
    s_add_u32 s60, s60, s3
    s_addc_u32 s61, s61, 0
    v_exp_f32 v16, v16
    v_exp_f32 v17, v17
    s_waitcnt lgkmcnt(0)
    v_exp_f32 v18, v18
    v_exp_f32 v19, v19
    v_exp_f32 v20, v20
    s_add_u32 m0, m0, 8320
    ds_read_b128 v[96:99], v5 offset:2080
    v_exp_f32 v21, v21
    v_exp_f32 v22, v22
    v_exp_f32 v23, v23
    v_exp_f32 v24, v24
    v_exp_f32 v25, v25
    v_smfmac_f32_32x32x32_bf16 v[48:63], v[88:91], v[16:23], v7
    s_add_u32 s44, s44, 8192
    ds_read_b128 v[100:103], v6 offset:2080
    v_exp_f32 v26, v26
    v_exp_f32 v27, v27
    v_exp_f32 v28, v28
    v_exp_f32 v29, v29
    v_exp_f32 v30, v30
    v_exp_f32 v31, v31
    v_exp_f32 v32, v32
    v_exp_f32 v33, v33
    v_smfmac_f32_32x32x32_bf16 v[48:63], v[92:95], v[24:31], v7
    buffer_load_dwordx4 v2, s[8:11], s44 offen sc1 lds
    v_exp_f32 v34, v34
    v_exp_f32 v35, v35
    v_exp_f32 v36, v36
    v_mfma_f32_32x32x16_bf16 v[16:31], v[84:87], v[8:11], 0
    ds_read_b128 v[80:83], v4 offset:4160
    v_exp_f32 v37, v37
    v_exp_f32 v38, v38
    v_exp_f32 v39, v39
    v_exp_f32 v40, v40
    v_exp_f32 v41, v41
    v_smfmac_f32_32x32x32_bf16 v[64:79], v[88:91], v[32:39], v7
    v_exp_f32 v42, v42
    v_exp_f32 v43, v43
    v_exp_f32 v44, v44
    v_exp_f32 v45, v45
    v_exp_f32 v46, v46
    v_exp_f32 v47, v47
    v_exp_f32 v16, v16
    v_exp_f32 v17, v17
    v_smfmac_f32_32x32x32_bf16 v[64:79], v[92:95], v[40:47], v7
    s_waitcnt lgkmcnt(0)
    buffer_load_dwordx4 v2, s[8:11], s44 offen offset:1024 sc1 lds
    v_exp_f32 v18, v18
    v_exp_f32 v19, v19
    v_exp_f32 v20, v20
    v_mfma_f32_32x32x16_bf16 v[32:47], v[84:87], v[12:15], 0
    s_add_u32 m0, m0, 8320
    ds_read_b128 v[88:91], v5 offset:4160
    v_exp_f32 v21, v21
    v_exp_f32 v22, v22
    v_exp_f32 v23, v23
    v_exp_f32 v24, v24
    v_exp_f32 v25, v25
    v_smfmac_f32_32x32x32_bf16 v[48:63], v[96:99], v[16:23], v7
    s_add_u32 s44, s44, 8192
    ds_read_b128 v[92:95], v6 offset:4160
    v_exp_f32 v26, v26
    v_exp_f32 v27, v27
    v_exp_f32 v28, v28
    v_exp_f32 v29, v29
    v_exp_f32 v30, v30
    v_exp_f32 v31, v31
    v_exp_f32 v32, v32
    v_exp_f32 v33, v33
    v_smfmac_f32_32x32x32_bf16 v[48:63], v[100:103], v[24:31], v7
    buffer_load_dwordx4 v2, s[8:11], s44 offen sc1 lds
    v_exp_f32 v34, v34
    v_exp_f32 v35, v35
    v_exp_f32 v36, v36
    v_mfma_f32_32x32x16_bf16 v[16:31], v[80:83], v[8:11], 0
    ds_read_b128 v[84:87], v4 offset:6240
    v_exp_f32 v37, v37
    v_exp_f32 v38, v38
    v_exp_f32 v39, v39
    v_exp_f32 v40, v40
    v_exp_f32 v41, v41
    v_smfmac_f32_32x32x32_bf16 v[64:79], v[96:99], v[32:39], v7
    v_exp_f32 v42, v42
    v_exp_f32 v43, v43
    v_exp_f32 v44, v44
    v_exp_f32 v45, v45
    v_exp_f32 v46, v46
    v_exp_f32 v47, v47
    v_exp_f32 v16, v16
    v_exp_f32 v17, v17
    v_smfmac_f32_32x32x32_bf16 v[64:79], v[100:103], v[40:47], v7
    s_waitcnt lgkmcnt(0)
    buffer_load_dwordx4 v2, s[8:11], s44 offen offset:1024 sc1 lds
    v_exp_f32 v18, v18
    v_exp_f32 v19, v19
    v_exp_f32 v20, v20
    v_mfma_f32_32x32x16_bf16 v[32:47], v[80:83], v[12:15], 0
    s_add_u32 m0, m0, 8320
    ds_read_b128 v[96:99], v5 offset:6240
    v_exp_f32 v21, v21
    v_exp_f32 v22, v22
    v_exp_f32 v23, v23
    v_exp_f32 v24, v24
    v_exp_f32 v25, v25
    v_smfmac_f32_32x32x32_bf16 v[48:63], v[88:91], v[16:23], v7
    s_add_u32 s44, s44, 8192
    ds_read_b128 v[100:103], v6 offset:6240
    v_exp_f32 v26, v26
    v_exp_f32 v27, v27
    v_exp_f32 v28, v28
    v_exp_f32 v29, v29
    v_exp_f32 v30, v30
    v_exp_f32 v31, v31
    v_exp_f32 v32, v32
    v_exp_f32 v33, v33
    v_smfmac_f32_32x32x32_bf16 v[48:63], v[92:95], v[24:31], v7
    buffer_load_dwordx4 v2, s[8:11], s44 offen sc1 lds
    buffer_load_dwordx4 v2, s[8:11], s44 offen offset:1024 sc1 lds
    v_exp_f32 v34, v34
    v_exp_f32 v35, v35
    v_exp_f32 v36, v36
    v_mfma_f32_32x32x16_bf16 v[16:31], v[84:87], v[8:11], 0
    ds_read_b128 v[80:83], v4 offset:8320
    v_exp_f32 v37, v37
    v_exp_f32 v38, v38
    v_exp_f32 v39, v39
    v_exp_f32 v40, v40
    v_exp_f32 v41, v41
    v_smfmac_f32_32x32x32_bf16 v[64:79], v[88:91], v[32:39], v7
    v_exp_f32 v42, v42
    v_exp_f32 v43, v43
    v_exp_f32 v44, v44
    v_exp_f32 v45, v45
    v_exp_f32 v46, v46
    v_exp_f32 v47, v47
    v_exp_f32 v16, v16
    v_exp_f32 v17, v17
    v_smfmac_f32_32x32x32_bf16 v[64:79], v[92:95], v[40:47], v7
    s_waitcnt lgkmcnt(0)
    buffer_load_dwordx2 v[112:113], v0, s[20:23], s52 offen offset:0
    buffer_load_dwordx2 v[114:115], v0, s[20:23], s52 offen offset:16
    v_exp_f32 v18, v18
    v_exp_f32 v19, v19
    v_exp_f32 v20, v20
    v_mfma_f32_32x32x16_bf16 v[32:47], v[84:87], v[12:15], 0
    s_add_u32 m0, m0, 8320
    ds_read_b128 v[88:91], v5 offset:8320
    v_exp_f32 v21, v21
    v_exp_f32 v22, v22
    v_exp_f32 v23, v23
    v_exp_f32 v24, v24
    v_exp_f32 v25, v25
    v_smfmac_f32_32x32x32_bf16 v[48:63], v[96:99], v[16:23], v7
    s_add_u32 s44, s44, 8192
    ds_read_b128 v[92:95], v6 offset:8320
    v_exp_f32 v26, v26
    v_exp_f32 v27, v27
    v_exp_f32 v28, v28
    v_exp_f32 v29, v29
    v_exp_f32 v30, v30
    v_exp_f32 v31, v31
    v_exp_f32 v32, v32
    v_exp_f32 v33, v33
    v_smfmac_f32_32x32x32_bf16 v[48:63], v[100:103], v[24:31], v7
    buffer_load_dwordx4 v2, s[8:11], s44 offen sc1 lds
    buffer_load_dwordx4 v2, s[8:11], s44 offen offset:1024 sc1 lds
    v_exp_f32 v34, v34
    v_exp_f32 v35, v35
    v_exp_f32 v36, v36
    v_mfma_f32_32x32x16_bf16 v[16:31], v[80:83], v[8:11], 0
    ds_read_b128 v[84:87], v4 offset:10400
    v_exp_f32 v37, v37
    v_exp_f32 v38, v38
    v_exp_f32 v39, v39
    v_exp_f32 v40, v40
    v_exp_f32 v41, v41
    v_smfmac_f32_32x32x32_bf16 v[64:79], v[96:99], v[32:39], v7
    v_exp_f32 v42, v42
    v_exp_f32 v43, v43
    v_exp_f32 v44, v44
    v_exp_f32 v45, v45
    v_exp_f32 v46, v46
    v_exp_f32 v47, v47
    v_exp_f32 v16, v16
    v_exp_f32 v17, v17
    v_smfmac_f32_32x32x32_bf16 v[64:79], v[100:103], v[40:47], v7
    s_waitcnt lgkmcnt(0)
    s_waitcnt vmcnt(8)
    s_barrier
    buffer_store_dword v109, off, s[12:15], s54 sc1
    buffer_load_dwordx2 v[116:117], v0, s[20:23], s52 offen offset:32
    buffer_load_dwordx2 v[118:119], v0, s[20:23], s52 offen offset:48
    v_exp_f32 v18, v18
    v_exp_f32 v19, v19
    v_exp_f32 v20, v20
    v_mfma_f32_32x32x16_bf16 v[32:47], v[80:83], v[12:15], 0
    s_add_u32 m0, m0, 8320
    ds_read_b128 v[96:99], v5 offset:10400
    v_exp_f32 v21, v21
    v_exp_f32 v22, v22
    v_exp_f32 v23, v23
    v_exp_f32 v24, v24
    v_exp_f32 v25, v25
    v_smfmac_f32_32x32x32_bf16 v[48:63], v[88:91], v[16:23], v7
    s_add_u32 s44, s44, 8192
    ds_read_b128 v[100:103], v6 offset:10400
    v_exp_f32 v26, v26
    v_exp_f32 v27, v27
    v_exp_f32 v28, v28
    v_exp_f32 v29, v29
    v_exp_f32 v30, v30
    v_exp_f32 v31, v31
    v_exp_f32 v32, v32
    v_exp_f32 v33, v33
    v_smfmac_f32_32x32x32_bf16 v[48:63], v[92:95], v[24:31], v7
    buffer_load_dwordx4 v2, s[8:11], s44 offen sc1 lds
    v_exp_f32 v34, v34
    v_exp_f32 v35, v35
    v_exp_f32 v36, v36
    v_mfma_f32_32x32x16_bf16 v[16:31], v[84:87], v[8:11], 0
    ds_read_b128 v[80:83], v4 offset:12480
    v_exp_f32 v37, v37
    v_exp_f32 v38, v38
    v_exp_f32 v39, v39
    v_exp_f32 v40, v40
    v_exp_f32 v41, v41
    v_smfmac_f32_32x32x32_bf16 v[64:79], v[88:91], v[32:39], v7
    v_exp_f32 v42, v42
    v_exp_f32 v43, v43
    v_exp_f32 v44, v44
    v_exp_f32 v45, v45
    v_exp_f32 v46, v46
    v_exp_f32 v47, v47
    v_exp_f32 v16, v16
    v_exp_f32 v17, v17
    v_smfmac_f32_32x32x32_bf16 v[64:79], v[92:95], v[40:47], v7
    s_waitcnt lgkmcnt(0)
    buffer_load_dwordx4 v2, s[8:11], s44 offen offset:1024 sc1 lds
    v_exp_f32 v18, v18
    v_exp_f32 v19, v19
    v_exp_f32 v20, v20
    v_mfma_f32_32x32x16_bf16 v[32:47], v[84:87], v[12:15], 0
    s_add_u32 m0, m0, 8320
    ds_read_b128 v[88:91], v5 offset:12480
    v_exp_f32 v21, v21
    v_exp_f32 v22, v22
    v_exp_f32 v23, v23
    v_exp_f32 v24, v24
    v_exp_f32 v25, v25
    v_smfmac_f32_32x32x32_bf16 v[48:63], v[96:99], v[16:23], v7
    s_add_u32 s44, s44, 8192
    ds_read_b128 v[92:95], v6 offset:12480
    v_exp_f32 v26, v26
    v_exp_f32 v27, v27
    v_exp_f32 v28, v28
    v_exp_f32 v29, v29
    v_exp_f32 v30, v30
    v_exp_f32 v31, v31
    v_exp_f32 v32, v32
    v_exp_f32 v33, v33
    v_smfmac_f32_32x32x32_bf16 v[48:63], v[100:103], v[24:31], v7
    buffer_load_dwordx4 v2, s[8:11], s44 offen sc1 lds
    v_exp_f32 v34, v34
    v_exp_f32 v35, v35
    v_exp_f32 v36, v36
    v_mfma_f32_32x32x16_bf16 v[16:31], v[80:83], v[8:11], 0
    ds_read_b128 v[84:87], v4 offset:14560
    v_exp_f32 v37, v37
    v_exp_f32 v38, v38
    v_exp_f32 v39, v39
    v_exp_f32 v40, v40
    v_exp_f32 v41, v41
    v_smfmac_f32_32x32x32_bf16 v[64:79], v[96:99], v[32:39], v7
    v_exp_f32 v42, v42
    v_exp_f32 v43, v43
    v_exp_f32 v44, v44
    v_exp_f32 v45, v45
    v_exp_f32 v46, v46
    v_exp_f32 v47, v47
    v_exp_f32 v16, v16
    v_exp_f32 v17, v17
    v_smfmac_f32_32x32x32_bf16 v[64:79], v[100:103], v[40:47], v7
    s_waitcnt lgkmcnt(0)
    buffer_load_dwordx4 v2, s[8:11], s44 offen offset:1024 sc1 lds
    v_exp_f32 v18, v18
    v_exp_f32 v19, v19
    v_exp_f32 v20, v20
    v_mfma_f32_32x32x16_bf16 v[32:47], v[80:83], v[12:15], 0
    s_add_u32 m0, m0, 8320
    ds_read_b128 v[96:99], v5 offset:14560
    v_exp_f32 v21, v21
    v_exp_f32 v22, v22
    v_exp_f32 v23, v23
    v_exp_f32 v24, v24
    v_exp_f32 v25, v25
    v_smfmac_f32_32x32x32_bf16 v[48:63], v[88:91], v[16:23], v7
    s_add_u32 s44, s44, 8192
    ds_read_b128 v[100:103], v6 offset:14560
    v_exp_f32 v26, v26
    v_exp_f32 v27, v27
    v_exp_f32 v28, v28
    v_exp_f32 v29, v29
    v_exp_f32 v30, v30
    v_exp_f32 v31, v31
    v_exp_f32 v32, v32
    v_exp_f32 v33, v33
    v_smfmac_f32_32x32x32_bf16 v[48:63], v[92:95], v[24:31], v7
    buffer_load_dwordx4 v2, s[8:11], s44 offen sc1 lds
    v_exp_f32 v34, v34
    v_exp_f32 v35, v35
    v_exp_f32 v36, v36
    v_mfma_f32_32x32x16_bf16 v[16:31], v[84:87], v[8:11], 0
    ds_read_b128 v[80:83], v4 offset:16640
    v_exp_f32 v37, v37
    v_exp_f32 v38, v38
    v_exp_f32 v39, v39
    v_exp_f32 v40, v40
    v_exp_f32 v41, v41
    v_smfmac_f32_32x32x32_bf16 v[64:79], v[88:91], v[32:39], v7
    v_exp_f32 v42, v42
    v_exp_f32 v43, v43
    v_exp_f32 v44, v44
    v_exp_f32 v45, v45
    v_exp_f32 v46, v46
    v_exp_f32 v47, v47
    v_exp_f32 v16, v16
    v_exp_f32 v17, v17
    v_smfmac_f32_32x32x32_bf16 v[64:79], v[92:95], v[40:47], v7
    s_waitcnt lgkmcnt(0)
    buffer_load_dwordx4 v2, s[8:11], s44 offen offset:1024 sc1 lds
    v_exp_f32 v18, v18
    v_exp_f32 v19, v19
    v_exp_f32 v20, v20
    v_mfma_f32_32x32x16_bf16 v[32:47], v[84:87], v[12:15], 0
    s_add_u32 m0, m0, 8320
    ds_read_b128 v[88:91], v5 offset:16640
    v_exp_f32 v21, v21
    v_exp_f32 v22, v22
    v_exp_f32 v23, v23
    v_exp_f32 v24, v24
    v_exp_f32 v25, v25
    v_smfmac_f32_32x32x32_bf16 v[48:63], v[96:99], v[16:23], v7
    s_add_u32 s44, s44, 8192
    ds_read_b128 v[92:95], v6 offset:16640
    v_exp_f32 v26, v26
    v_exp_f32 v27, v27
    v_exp_f32 v28, v28
    v_exp_f32 v29, v29
    v_exp_f32 v30, v30
    v_exp_f32 v31, v31
    v_exp_f32 v32, v32
    v_exp_f32 v33, v33
    v_smfmac_f32_32x32x32_bf16 v[48:63], v[100:103], v[24:31], v7
    buffer_load_dwordx4 v2, s[8:11], s44 offen sc1 lds
    v_exp_f32 v34, v34
    v_exp_f32 v35, v35
    v_exp_f32 v36, v36
    v_mfma_f32_32x32x16_bf16 v[16:31], v[80:83], v[8:11], 0
    ds_read_b128 v[84:87], v4 offset:18720
    v_exp_f32 v37, v37
    v_exp_f32 v38, v38
    v_exp_f32 v39, v39
    v_exp_f32 v40, v40
    v_exp_f32 v41, v41
    v_smfmac_f32_32x32x32_bf16 v[64:79], v[96:99], v[32:39], v7
    v_exp_f32 v42, v42
    v_exp_f32 v43, v43
    v_exp_f32 v44, v44
    v_exp_f32 v45, v45
    v_exp_f32 v46, v46
    v_exp_f32 v47, v47
    v_exp_f32 v16, v16
    v_exp_f32 v17, v17
    v_smfmac_f32_32x32x32_bf16 v[64:79], v[100:103], v[40:47], v7
    s_waitcnt lgkmcnt(0)
    buffer_load_dwordx4 v2, s[8:11], s44 offen offset:1024 sc1 lds
    v_exp_f32 v18, v18
    v_exp_f32 v19, v19
    v_exp_f32 v20, v20
    v_mfma_f32_32x32x16_bf16 v[32:47], v[80:83], v[12:15], 0
    s_add_u32 m0, m0, 8320
    ds_read_b128 v[96:99], v5 offset:18720
    v_exp_f32 v21, v21
    v_exp_f32 v22, v22
    v_exp_f32 v23, v23
    v_exp_f32 v24, v24
    v_exp_f32 v25, v25
    v_smfmac_f32_32x32x32_bf16 v[48:63], v[88:91], v[16:23], v7
    s_add_u32 s44, s44, 8192
    ds_read_b128 v[100:103], v6 offset:18720
    v_exp_f32 v26, v26
    v_exp_f32 v27, v27
    v_exp_f32 v28, v28
    v_exp_f32 v29, v29
    v_exp_f32 v30, v30
    v_exp_f32 v31, v31
    v_exp_f32 v32, v32
    v_exp_f32 v33, v33
    v_smfmac_f32_32x32x32_bf16 v[48:63], v[92:95], v[24:31], v7
    buffer_load_dwordx4 v2, s[8:11], s44 offen sc1 lds
    buffer_load_dwordx4 v2, s[8:11], s44 offen offset:1024 sc1 lds
    v_exp_f32 v34, v34
    v_exp_f32 v35, v35
    v_exp_f32 v36, v36
    v_mfma_f32_32x32x16_bf16 v[16:31], v[84:87], v[8:11], 0
    ds_read_b128 v[80:83], v4 offset:20800
    v_exp_f32 v37, v37
    v_exp_f32 v38, v38
    v_exp_f32 v39, v39
    v_exp_f32 v40, v40
    v_exp_f32 v41, v41
    v_smfmac_f32_32x32x32_bf16 v[64:79], v[88:91], v[32:39], v7
    v_exp_f32 v42, v42
    v_exp_f32 v43, v43
    v_exp_f32 v44, v44
    v_exp_f32 v45, v45
    v_exp_f32 v46, v46
    v_exp_f32 v47, v47
    v_exp_f32 v16, v16
    v_exp_f32 v17, v17
    v_smfmac_f32_32x32x32_bf16 v[64:79], v[92:95], v[40:47], v7
    s_waitcnt lgkmcnt(0)
    buffer_load_dwordx4 v[104:107], v2, s[8:11], s50 offen sc1
    buffer_load_dword v108, v3, s[8:11], s51 offen sc1
    v_exp_f32 v18, v18
    v_exp_f32 v19, v19
    v_exp_f32 v20, v20
    v_mfma_f32_32x32x16_bf16 v[32:47], v[84:87], v[12:15], 0
    s_add_u32 m0, m0, 8320
    ds_read_b128 v[88:91], v5 offset:20800
    v_exp_f32 v21, v21
    v_exp_f32 v22, v22
    v_exp_f32 v23, v23
    v_exp_f32 v24, v24
    v_exp_f32 v25, v25
    v_smfmac_f32_32x32x32_bf16 v[48:63], v[96:99], v[16:23], v7
    s_add_u32 s44, s44, 8192
    ds_read_b128 v[92:95], v6 offset:20800
    v_exp_f32 v26, v26
    v_exp_f32 v27, v27
    v_exp_f32 v28, v28
    v_exp_f32 v29, v29
    v_exp_f32 v30, v30
    v_exp_f32 v31, v31
    v_exp_f32 v32, v32
    v_exp_f32 v33, v33
    v_smfmac_f32_32x32x32_bf16 v[48:63], v[100:103], v[24:31], v7
    buffer_load_dwordx4 v2, s[8:11], s44 offen sc1 lds
    buffer_load_dwordx4 v2, s[8:11], s44 offen offset:1024 sc1 lds
    v_exp_f32 v34, v34
    v_exp_f32 v35, v35
    v_exp_f32 v36, v36
    v_mfma_f32_32x32x16_bf16 v[16:31], v[80:83], v[8:11], 0
    ds_read_b128 v[84:87], v4 offset:22880
    v_exp_f32 v37, v37
    v_exp_f32 v38, v38
    v_exp_f32 v39, v39
    v_exp_f32 v40, v40
    v_exp_f32 v41, v41
    v_smfmac_f32_32x32x32_bf16 v[64:79], v[96:99], v[32:39], v7
    v_exp_f32 v42, v42
    v_exp_f32 v43, v43
    v_exp_f32 v44, v44
    v_exp_f32 v45, v45
    v_exp_f32 v46, v46
    v_exp_f32 v47, v47
    v_exp_f32 v16, v16
    v_exp_f32 v17, v17
    v_smfmac_f32_32x32x32_bf16 v[64:79], v[100:103], v[40:47], v7
    s_waitcnt lgkmcnt(0)
    buffer_load_dwordx4 v[240:243], v122, s[8:11], s56 offen sc1
    v_exp_f32 v18, v18
    v_exp_f32 v19, v19
    v_exp_f32 v20, v20
    v_mfma_f32_32x32x16_bf16 v[32:47], v[80:83], v[12:15], 0
    s_add_u32 m0, m0, 8320
    ds_read_b128 v[96:99], v5 offset:22880
    v_exp_f32 v21, v21
    v_exp_f32 v22, v22
    v_exp_f32 v23, v23
    v_exp_f32 v24, v24
    v_exp_f32 v25, v25
    v_smfmac_f32_32x32x32_bf16 v[48:63], v[88:91], v[16:23], v7
    s_add_u32 s44, s44, 8192
    ds_read_b128 v[100:103], v6 offset:22880
    v_exp_f32 v26, v26
    v_exp_f32 v27, v27
    v_exp_f32 v28, v28
    v_exp_f32 v29, v29
    v_exp_f32 v30, v30
    v_exp_f32 v31, v31
    v_exp_f32 v32, v32
    v_exp_f32 v33, v33
    v_smfmac_f32_32x32x32_bf16 v[48:63], v[92:95], v[24:31], v7
    buffer_load_dwordx4 v2, s[8:11], s44 offen sc1 lds
    v_exp_f32 v34, v34
    v_exp_f32 v35, v35
    v_exp_f32 v36, v36
    v_mfma_f32_32x32x16_bf16 v[16:31], v[84:87], v[8:11], 0
    ds_read_b128 v[80:83], v4 offset:24960
    v_exp_f32 v37, v37
    v_exp_f32 v38, v38
    v_exp_f32 v39, v39
    v_exp_f32 v40, v40
    v_exp_f32 v41, v41
    v_smfmac_f32_32x32x32_bf16 v[64:79], v[88:91], v[32:39], v7
    v_exp_f32 v42, v42
    v_exp_f32 v43, v43
    v_exp_f32 v44, v44
    v_exp_f32 v45, v45
    v_exp_f32 v46, v46
    v_exp_f32 v47, v47
    v_exp_f32 v16, v16
    v_exp_f32 v17, v17
    v_smfmac_f32_32x32x32_bf16 v[64:79], v[92:95], v[40:47], v7
    s_waitcnt lgkmcnt(0)
    buffer_load_dwordx4 v2, s[8:11], s44 offen offset:1024 sc1 lds
    v_exp_f32 v18, v18
    v_exp_f32 v19, v19
    v_exp_f32 v20, v20
    v_mfma_f32_32x32x16_bf16 v[32:47], v[84:87], v[12:15], 0
    s_add_u32 m0, m0, 8320
    ds_read_b128 v[88:91], v5 offset:24960
    v_exp_f32 v21, v21
    v_exp_f32 v22, v22
    v_exp_f32 v23, v23
    v_exp_f32 v24, v24
    v_exp_f32 v25, v25
    v_smfmac_f32_32x32x32_bf16 v[48:63], v[96:99], v[16:23], v7
    s_add_u32 s44, s44, 8192
    ds_read_b128 v[92:95], v6 offset:24960
    v_exp_f32 v26, v26
    v_exp_f32 v27, v27
    v_exp_f32 v28, v28
    v_exp_f32 v29, v29
    v_exp_f32 v30, v30
    v_exp_f32 v31, v31
    v_exp_f32 v32, v32
    v_exp_f32 v33, v33
    v_smfmac_f32_32x32x32_bf16 v[48:63], v[100:103], v[24:31], v7
    buffer_load_dwordx4 v2, s[8:11], s44 offen sc1 lds
    v_exp_f32 v34, v34
    v_exp_f32 v35, v35
    v_exp_f32 v36, v36
    v_mfma_f32_32x32x16_bf16 v[16:31], v[80:83], v[8:11], 0
    ds_read_b128 v[84:87], v4 offset:27040
    v_exp_f32 v37, v37
    v_exp_f32 v38, v38
    v_exp_f32 v39, v39
    v_exp_f32 v40, v40
    v_exp_f32 v41, v41
    v_smfmac_f32_32x32x32_bf16 v[64:79], v[96:99], v[32:39], v7
    v_exp_f32 v42, v42
    v_exp_f32 v43, v43
    v_exp_f32 v44, v44
    v_exp_f32 v45, v45
    v_exp_f32 v46, v46
    v_exp_f32 v47, v47
    v_exp_f32 v16, v16
    v_exp_f32 v17, v17
    v_smfmac_f32_32x32x32_bf16 v[64:79], v[100:103], v[40:47], v7
    s_waitcnt lgkmcnt(0)
    s_waitcnt vmcnt(7)
    v_subrev_u32 v104, s35, v104
    v_subrev_u32 v105, s35, v105
    v_subrev_u32 v106, s35, v106
    v_subrev_u32 v107, s35, v107
    s_waitcnt vmcnt(6)
    v_subrev_u32 v108, s35, v108
    v_or3_b32 v104, v104, v105, v106
    v_or3_b32 v104, v104, v107, v108
    s_waitcnt vmcnt(3)
    v_xor_b32 v240, v109, v240
    v_xor_b32 v241, v109, v241
    v_xor_b32 v242, v109, v242
    v_xor_b32 v243, v109, v243
    v_or3_b32 v104, v104, v240, v241
    v_or3_b32 v104, v104, v242, v243
    v_cmp_lt_u32 vcc, 7, v104
    s_nop 0
    s_cbranch_vccnz L_late_6
L_ok_7:
    v_cmp_ne_u32 vcc, s55, v108
    s_cmp_eq_u32 s2, 0
    s_cselect_b32 s14, 4, 0
    buffer_store_dword v109, off, s[12:15], 0 offset:0 sc1
    s_cmp_eq_u64 vcc, 0
    s_cselect_b32 s14, s10, 0
    s_cselect_b32 s18, 0, s10
    s_cselect_b32 s70, s26, 0
    s_cselect_b32 s74, 0, s26
    buffer_load_dwordx4 v2, s[8:11], s44 offen offset:1024 sc1 lds
    v_exp_f32 v18, v18
    v_exp_f32 v19, v19
    v_exp_f32 v20, v20
    v_mfma_f32_32x32x16_bf16 v[32:47], v[80:83], v[12:15], 0
    ds_read_b128 v[96:99], v5 offset:27040
    v_exp_f32 v21, v21
    v_exp_f32 v22, v22
    v_exp_f32 v23, v23
    v_exp_f32 v24, v24
    v_exp_f32 v25, v25
    v_smfmac_f32_32x32x32_bf16 v[48:63], v[88:91], v[16:23], v7
    ds_read_b128 v[100:103], v6 offset:27040
    v_exp_f32 v26, v26
    v_exp_f32 v27, v27
    v_exp_f32 v28, v28
    v_exp_f32 v29, v29
    v_exp_f32 v30, v30
    v_exp_f32 v31, v31
    v_exp_f32 v32, v32
    v_exp_f32 v33, v33
    v_smfmac_f32_32x32x32_bf16 v[48:63], v[92:95], v[24:31], v7
    buffer_load_dwordx4 v[128:131], v2, s[8:11], s46 offen offset:0 sc1
    buffer_load_dwordx4 v[132:135], v2, s[8:11], s46 offen offset:1024 sc1
    v_exp_f32 v34, v34
    v_exp_f32 v35, v35
    v_exp_f32 v36, v36
    v_mfma_f32_32x32x16_bf16 v[16:31], v[84:87], v[8:11], 0
    ds_read_b128 v[80:83], v4 offset:29120
    v_exp_f32 v37, v37
    v_exp_f32 v38, v38
    v_exp_f32 v39, v39
    v_exp_f32 v40, v40
    v_exp_f32 v41, v41
    v_smfmac_f32_32x32x32_bf16 v[64:79], v[88:91], v[32:39], v7
    v_exp_f32 v42, v42
    v_exp_f32 v43, v43
    v_exp_f32 v44, v44
    v_exp_f32 v45, v45
    v_exp_f32 v46, v46
    v_exp_f32 v47, v47
    v_exp_f32 v16, v16
    v_exp_f32 v17, v17
    v_smfmac_f32_32x32x32_bf16 v[64:79], v[92:95], v[40:47], v7
    s_waitcnt lgkmcnt(0)
    buffer_load_dwordx4 v[136:139], v2, s[8:11], s46 offen offset:2048 sc1
    buffer_load_dwordx4 v[140:143], v2, s[8:11], s46 offen offset:3072 sc1
    v_exp_f32 v18, v18
    v_exp_f32 v19, v19
    v_exp_f32 v20, v20
    v_mfma_f32_32x32x16_bf16 v[32:47], v[84:87], v[12:15], 0
    s_add_u32 s46, s46, 4096
    ds_read_b128 v[88:91], v5 offset:29120
    v_exp_f32 v21, v21
    v_exp_f32 v22, v22
    v_exp_f32 v23, v23
    v_exp_f32 v24, v24
    v_exp_f32 v25, v25
    v_smfmac_f32_32x32x32_bf16 v[48:63], v[96:99], v[16:23], v7
    ds_read_b128 v[92:95], v6 offset:29120
    v_exp_f32 v26, v26
    v_exp_f32 v27, v27
    v_exp_f32 v28, v28
    v_exp_f32 v29, v29
    v_exp_f32 v30, v30
    v_exp_f32 v31, v31
    v_exp_f32 v32, v32
    v_exp_f32 v33, v33
    v_smfmac_f32_32x32x32_bf16 v[48:63], v[100:103], v[24:31], v7
    buffer_load_dwordx4 v[144:147], v2, s[8:11], s46 offen offset:0 sc1
    buffer_load_dwordx4 v[148:151], v2, s[8:11], s46 offen offset:1024 sc1
    v_exp_f32 v34, v34
    v_exp_f32 v35, v35
    v_exp_f32 v36, v36
    v_mfma_f32_32x32x16_bf16 v[16:31], v[80:83], v[8:11], 0
    ds_read_b128 v[84:87], v4 offset:31200
    v_exp_f32 v37, v37
    v_exp_f32 v38, v38
    v_exp_f32 v39, v39
    v_exp_f32 v40, v40
    v_exp_f32 v41, v41
    v_smfmac_f32_32x32x32_bf16 v[64:79], v[96:99], v[32:39], v7
    v_exp_f32 v42, v42
    v_exp_f32 v43, v43
    v_exp_f32 v44, v44
    v_exp_f32 v45, v45
    v_exp_f32 v46, v46
    v_exp_f32 v47, v47
    v_exp_f32 v16, v16
    v_exp_f32 v17, v17
    v_smfmac_f32_32x32x32_bf16 v[64:79], v[100:103], v[40:47], v7
    s_waitcnt lgkmcnt(0)
    buffer_load_dwordx4 v[152:155], v2, s[8:11], s46 offen offset:2048 sc1
    buffer_load_dwordx4 v[156:159], v2, s[8:11], s46 offen offset:3072 sc1
    v_exp_f32 v18, v18
    v_exp_f32 v19, v19
    v_exp_f32 v20, v20
    v_mfma_f32_32x32x16_bf16 v[32:47], v[80:83], v[12:15], 0
    s_add_u32 s46, s46, 4096
    ds_read_b128 v[96:99], v5 offset:31200
    v_exp_f32 v21, v21
    v_exp_f32 v22, v22
    v_exp_f32 v23, v23
    v_exp_f32 v24, v24
    v_exp_f32 v25, v25
    v_smfmac_f32_32x32x32_bf16 v[48:63], v[88:91], v[16:23], v7
    ds_read_b128 v[100:103], v6 offset:31200
    v_exp_f32 v26, v26
    v_exp_f32 v27, v27
    v_exp_f32 v28, v28
    v_exp_f32 v29, v29
    v_exp_f32 v30, v30
    v_exp_f32 v31, v31
    v_exp_f32 v32, v32
    v_exp_f32 v33, v33
    v_smfmac_f32_32x32x32_bf16 v[48:63], v[92:95], v[24:31], v7
    buffer_load_dwordx4 v[160:163], v2, s[8:11], s46 offen offset:0 sc1
    buffer_load_dwordx4 v[164:167], v2, s[8:11], s46 offen offset:1024 sc1
    v_exp_f32 v34, v34
    v_exp_f32 v35, v35
    v_exp_f32 v36, v36
    v_mfma_f32_32x32x16_bf16 v[16:31], v[84:87], v[8:11], 0
    ds_read_b128 v[80:83], v4 offset:33280
    v_exp_f32 v37, v37
    v_exp_f32 v38, v38
    v_exp_f32 v39, v39
    v_exp_f32 v40, v40
    v_exp_f32 v41, v41
    v_smfmac_f32_32x32x32_bf16 v[64:79], v[88:91], v[32:39], v7
    v_exp_f32 v42, v42
    v_exp_f32 v43, v43
    v_exp_f32 v44, v44
    v_exp_f32 v45, v45
    v_exp_f32 v46, v46
    v_exp_f32 v47, v47
    v_exp_f32 v16, v16
    v_exp_f32 v17, v17
    v_smfmac_f32_32x32x32_bf16 v[64:79], v[92:95], v[40:47], v7
    s_waitcnt lgkmcnt(0)
    buffer_load_dwordx4 v[168:171], v2, s[8:11], s46 offen offset:2048 sc1
    buffer_load_dwordx4 v[172:175], v2, s[8:11], s46 offen offset:3072 sc1
    v_exp_f32 v18, v18
    v_exp_f32 v19, v19
    v_exp_f32 v20, v20
    v_mfma_f32_32x32x16_bf16 v[32:47], v[84:87], v[12:15], 0
    s_add_u32 s46, s46, 4096
    ds_read_b128 v[88:91], v5 offset:33280
    v_exp_f32 v21, v21
    v_exp_f32 v22, v22
    v_exp_f32 v23, v23
    v_exp_f32 v24, v24
    v_exp_f32 v25, v25
    v_smfmac_f32_32x32x32_bf16 v[48:63], v[96:99], v[16:23], v7
    ds_read_b128 v[92:95], v6 offset:33280
    v_exp_f32 v26, v26
    v_exp_f32 v27, v27
    v_exp_f32 v28, v28
    v_exp_f32 v29, v29
    v_exp_f32 v30, v30
    v_exp_f32 v31, v31
    v_exp_f32 v32, v32
    v_exp_f32 v33, v33
    v_smfmac_f32_32x32x32_bf16 v[48:63], v[100:103], v[24:31], v7
    buffer_load_dwordx4 v[176:179], v2, s[8:11], s46 offen offset:0 sc1
    buffer_load_dwordx4 v[180:183], v2, s[8:11], s46 offen offset:1024 sc1
    v_exp_f32 v34, v34
    v_exp_f32 v35, v35
    v_exp_f32 v36, v36
    v_mfma_f32_32x32x16_bf16 v[16:31], v[80:83], v[8:11], 0
    ds_read_b128 v[84:87], v4 offset:35360
    v_exp_f32 v37, v37
    v_exp_f32 v38, v38
    v_exp_f32 v39, v39
    v_exp_f32 v40, v40
    v_exp_f32 v41, v41
    v_smfmac_f32_32x32x32_bf16 v[64:79], v[96:99], v[32:39], v7
    v_exp_f32 v42, v42
    v_exp_f32 v43, v43
    v_exp_f32 v44, v44
    v_exp_f32 v45, v45
    v_exp_f32 v46, v46
    v_exp_f32 v47, v47
    v_exp_f32 v16, v16
    v_exp_f32 v17, v17
    v_smfmac_f32_32x32x32_bf16 v[64:79], v[100:103], v[40:47], v7
    s_waitcnt lgkmcnt(0)
    buffer_load_dwordx4 v[184:187], v2, s[8:11], s46 offen offset:2048 sc1
    buffer_load_dwordx4 v[188:191], v2, s[8:11], s46 offen offset:3072 sc1
    v_exp_f32 v18, v18
    v_exp_f32 v19, v19
    v_exp_f32 v20, v20
    v_mfma_f32_32x32x16_bf16 v[32:47], v[80:83], v[12:15], 0
    ds_read_b128 v[96:99], v5 offset:35360
    v_exp_f32 v21, v21
    v_exp_f32 v22, v22
    v_exp_f32 v23, v23
    v_exp_f32 v24, v24
    v_exp_f32 v25, v25
    v_smfmac_f32_32x32x32_bf16 v[48:63], v[88:91], v[16:23], v7
    ds_read_b128 v[100:103], v6 offset:35360
    v_exp_f32 v26, v26
    v_exp_f32 v27, v27
    v_exp_f32 v28, v28
    v_exp_f32 v29, v29
    v_exp_f32 v30, v30
    v_exp_f32 v31, v31
    v_exp_f32 v32, v32
    v_exp_f32 v33, v33
    v_smfmac_f32_32x32x32_bf16 v[48:63], v[92:95], v[24:31], v7
    buffer_load_dwordx4 v[240:243], v110, s[8:11], s38 offen sc1
    buffer_load_dwordx4 v[244:247], v110, s[8:11], s39 offen sc1
    v_exp_f32 v34, v34
    v_exp_f32 v35, v35
    v_exp_f32 v36, v36
    v_mfma_f32_32x32x16_bf16 v[16:31], v[84:87], v[8:11], 0
    ds_read_b128 v[80:83], v4 offset:37440
    v_exp_f32 v37, v37
    v_exp_f32 v38, v38
    v_exp_f32 v39, v39
    v_exp_f32 v40, v40
    v_exp_f32 v41, v41
    v_smfmac_f32_32x32x32_bf16 v[64:79], v[88:91], v[32:39], v7
    v_exp_f32 v42, v42
    v_exp_f32 v43, v43
    v_exp_f32 v44, v44
    v_exp_f32 v45, v45
    v_exp_f32 v46, v46
    v_exp_f32 v47, v47
    v_exp_f32 v16, v16
    v_exp_f32 v17, v17
    v_smfmac_f32_32x32x32_bf16 v[64:79], v[92:95], v[40:47], v7
    s_waitcnt lgkmcnt(0)
    buffer_load_dwordx4 v[248:251], v110, s[8:11], s40 offen sc1
    buffer_load_dwordx4 v[252:255], v110, s[8:11], s41 offen sc1
    v_exp_f32 v18, v18
    v_exp_f32 v19, v19
    v_exp_f32 v20, v20
    v_mfma_f32_32x32x16_bf16 v[32:47], v[84:87], v[12:15], 0
    s_add_u32 s46, s46, 4096
    ds_read_b128 v[88:91], v5 offset:37440
    v_exp_f32 v21, v21
    v_exp_f32 v22, v22
    v_exp_f32 v23, v23
    v_exp_f32 v24, v24
    v_exp_f32 v25, v25
    v_smfmac_f32_32x32x32_bf16 v[48:63], v[96:99], v[16:23], v7
    ds_read_b128 v[92:95], v6 offset:37440
    v_exp_f32 v26, v26
    v_exp_f32 v27, v27
    v_exp_f32 v28, v28
    v_exp_f32 v29, v29
    v_exp_f32 v30, v30
    v_exp_f32 v31, v31
    v_exp_f32 v32, v32
    v_exp_f32 v33, v33
    v_smfmac_f32_32x32x32_bf16 v[48:63], v[100:103], v[24:31], v7
    buffer_load_dwordx4 v[192:195], v2, s[8:11], s46 offen offset:0 sc1
    buffer_load_dwordx4 v[196:199], v2, s[8:11], s46 offen offset:1024 sc1
    v_exp_f32 v34, v34
    v_exp_f32 v35, v35
    v_exp_f32 v36, v36
    v_mfma_f32_32x32x16_bf16 v[16:31], v[80:83], v[8:11], 0
    ds_read_b128 v[84:87], v4 offset:39520
    v_exp_f32 v37, v37
    v_exp_f32 v38, v38
    v_exp_f32 v39, v39
    v_exp_f32 v40, v40
    v_exp_f32 v41, v41
    v_smfmac_f32_32x32x32_bf16 v[64:79], v[96:99], v[32:39], v7
    v_exp_f32 v42, v42
    v_exp_f32 v43, v43
    v_exp_f32 v44, v44
    v_exp_f32 v45, v45
    v_exp_f32 v46, v46
    v_exp_f32 v47, v47
    v_exp_f32 v16, v16
    v_exp_f32 v17, v17
    v_smfmac_f32_32x32x32_bf16 v[64:79], v[100:103], v[40:47], v7
    s_waitcnt lgkmcnt(0)
    s_waitcnt vmcnt(22)
    s_barrier
    buffer_load_dwordx4 v[200:203], v2, s[8:11], s46 offen offset:2048 sc1
    buffer_load_dwordx4 v[204:207], v2, s[8:11], s46 offen offset:3072 sc1
    v_exp_f32 v18, v18
    v_exp_f32 v19, v19
    v_exp_f32 v20, v20
    v_mfma_f32_32x32x16_bf16 v[32:47], v[80:83], v[12:15], 0
    s_add_u32 s46, s46, 4096
    ds_read_b128 v[96:99], v5 offset:39520
    v_exp_f32 v21, v21
    v_exp_f32 v22, v22
    v_exp_f32 v23, v23
    v_exp_f32 v24, v24
    v_exp_f32 v25, v25
    v_smfmac_f32_32x32x32_bf16 v[48:63], v[88:91], v[16:23], v7
    ds_read_b128 v[100:103], v6 offset:39520
    v_exp_f32 v26, v26
    v_exp_f32 v27, v27
    v_exp_f32 v28, v28
    v_exp_f32 v29, v29
    v_exp_f32 v30, v30
    v_exp_f32 v31, v31
    v_exp_f32 v32, v32
    v_exp_f32 v33, v33
    v_smfmac_f32_32x32x32_bf16 v[48:63], v[92:95], v[24:31], v7
    buffer_load_dwordx4 v[208:211], v2, s[8:11], s46 offen offset:0 sc1
    buffer_load_dwordx4 v[212:215], v2, s[8:11], s46 offen offset:1024 sc1
    v_exp_f32 v34, v34
    v_exp_f32 v35, v35
    v_exp_f32 v36, v36
    v_mfma_f32_32x32x16_bf16 v[16:31], v[84:87], v[8:11], 0
    ds_read_b128 v[80:83], v4 offset:41600
    v_exp_f32 v37, v37
    v_exp_f32 v38, v38
    v_exp_f32 v39, v39
    v_exp_f32 v40, v40
    v_exp_f32 v41, v41
    v_smfmac_f32_32x32x32_bf16 v[64:79], v[88:91], v[32:39], v7
    v_exp_f32 v42, v42
    v_exp_f32 v43, v43
    v_exp_f32 v44, v44
    v_exp_f32 v45, v45
    v_exp_f32 v46, v46
    v_exp_f32 v47, v47
    v_exp_f32 v16, v16
    v_exp_f32 v17, v17
    v_smfmac_f32_32x32x32_bf16 v[64:79], v[92:95], v[40:47], v7
    s_waitcnt lgkmcnt(0)
    buffer_load_dwordx4 v[216:219], v2, s[8:11], s46 offen offset:2048 sc1
    buffer_load_dwordx4 v[220:223], v2, s[8:11], s46 offen offset:3072 sc1
    v_exp_f32 v18, v18
    v_exp_f32 v19, v19
    v_exp_f32 v20, v20
    v_mfma_f32_32x32x16_bf16 v[32:47], v[84:87], v[12:15], 0
    s_add_u32 s46, s46, 4096
    ds_read_b128 v[88:91], v5 offset:41600
    v_exp_f32 v21, v21
    v_exp_f32 v22, v22
    v_exp_f32 v23, v23
    v_exp_f32 v24, v24
    v_exp_f32 v25, v25
    v_smfmac_f32_32x32x32_bf16 v[48:63], v[96:99], v[16:23], v7
    ds_read_b128 v[92:95], v6 offset:41600
    v_exp_f32 v26, v26
    v_exp_f32 v27, v27
    v_exp_f32 v28, v28
    v_exp_f32 v29, v29
    v_exp_f32 v30, v30
    v_exp_f32 v31, v31
    v_exp_f32 v32, v32
    v_exp_f32 v33, v33
    v_smfmac_f32_32x32x32_bf16 v[48:63], v[100:103], v[24:31], v7
    buffer_load_dwordx4 v[224:227], v2, s[8:11], s46 offen offset:0 sc1
    buffer_load_dwordx4 v[228:231], v2, s[8:11], s46 offen offset:1024 sc1
    v_exp_f32 v34, v34
    v_exp_f32 v35, v35
    v_exp_f32 v36, v36
    v_mfma_f32_32x32x16_bf16 v[16:31], v[80:83], v[8:11], 0
    ds_read_b128 v[84:87], v4 offset:43680
    v_exp_f32 v37, v37
    v_exp_f32 v38, v38
    v_exp_f32 v39, v39
    v_exp_f32 v40, v40
    v_exp_f32 v41, v41
    v_smfmac_f32_32x32x32_bf16 v[64:79], v[96:99], v[32:39], v7
    v_exp_f32 v42, v42
    v_exp_f32 v43, v43
    v_exp_f32 v44, v44
    v_exp_f32 v45, v45
    v_exp_f32 v46, v46
    v_exp_f32 v47, v47
    v_exp_f32 v16, v16
    v_exp_f32 v17, v17
    v_smfmac_f32_32x32x32_bf16 v[64:79], v[100:103], v[40:47], v7
    s_waitcnt lgkmcnt(0)
    buffer_load_dwordx4 v[232:235], v2, s[8:11], s46 offen offset:2048 sc1
    buffer_load_dwordx4 v[236:239], v2, s[8:11], s46 offen offset:3072 sc1
    v_exp_f32 v18, v18
    v_exp_f32 v19, v19
    v_exp_f32 v20, v20
    v_mfma_f32_32x32x16_bf16 v[32:47], v[80:83], v[12:15], 0
    s_add_u32 s46, s46, 1024000
    ds_read_b128 v[96:99], v5 offset:43680
    v_exp_f32 v21, v21
    v_exp_f32 v22, v22
    v_exp_f32 v23, v23
    v_exp_f32 v24, v24
    v_exp_f32 v25, v25
    v_smfmac_f32_32x32x32_bf16 v[48:63], v[88:91], v[16:23], v7
    ds_read_b128 v[100:103], v6 offset:43680
    v_exp_f32 v26, v26
    v_exp_f32 v27, v27
    v_exp_f32 v28, v28
    v_exp_f32 v29, v29
    v_exp_f32 v30, v30
    v_exp_f32 v31, v31
    v_exp_f32 v32, v32
    v_exp_f32 v33, v33
    v_smfmac_f32_32x32x32_bf16 v[48:63], v[92:95], v[24:31], v7
    buffer_load_dwordx4 a[0:3], v2, s[8:11], s46 offen offset:0 sc1
    buffer_load_dwordx4 a[4:7], v2, s[8:11], s46 offen offset:1024 sc1
    v_exp_f32 v34, v34
    v_exp_f32 v35, v35
    v_exp_f32 v36, v36
    v_mfma_f32_32x32x16_bf16 v[16:31], v[84:87], v[8:11], 0
    ds_read_b128 v[80:83], v4 offset:45760
    v_exp_f32 v37, v37
    v_exp_f32 v38, v38
    v_exp_f32 v39, v39
    v_exp_f32 v40, v40
    v_exp_f32 v41, v41
    v_smfmac_f32_32x32x32_bf16 v[64:79], v[88:91], v[32:39], v7
    v_exp_f32 v42, v42
    v_exp_f32 v43, v43
    v_exp_f32 v44, v44
    v_exp_f32 v45, v45
    v_exp_f32 v46, v46
    v_exp_f32 v47, v47
    v_exp_f32 v16, v16
    v_exp_f32 v17, v17
    v_smfmac_f32_32x32x32_bf16 v[64:79], v[92:95], v[40:47], v7
    s_waitcnt lgkmcnt(0)
    buffer_load_dwordx4 a[8:11], v2, s[8:11], s46 offen offset:2048 sc1
    buffer_load_dwordx4 a[12:15], v2, s[8:11], s46 offen offset:3072 sc1
    v_exp_f32 v18, v18
    v_exp_f32 v19, v19
    v_exp_f32 v20, v20
    v_mfma_f32_32x32x16_bf16 v[32:47], v[84:87], v[12:15], 0
    ds_read_b128 v[88:91], v5 offset:45760
    v_exp_f32 v21, v21
    v_exp_f32 v22, v22
    v_exp_f32 v23, v23
    v_exp_f32 v24, v24
    v_exp_f32 v25, v25
    v_smfmac_f32_32x32x32_bf16 v[48:63], v[96:99], v[16:23], v7
    ds_read_b128 v[92:95], v6 offset:45760
    v_exp_f32 v26, v26
    s_waitcnt vmcnt(18)
    v_pk_add_f32 v[240:241], v[240:241], v[244:245]
    v_pk_add_f32 v[242:243], v[242:243], v[246:247]
    s_waitcnt vmcnt(16)
    v_pk_add_f32 v[248:249], v[248:249], v[252:253]
    v_pk_add_f32 v[250:251], v[250:251], v[254:255]
    v_pk_add_f32 v[240:241], v[240:241], v[248:249]
    v_pk_add_f32 v[242:243], v[242:243], v[250:251]
    v_exp_f32 v27, v27
    v_exp_f32 v28, v28
    v_permlane32_swap_b32 v240, v242
    v_permlane32_swap_b32 v241, v243
    v_pk_add_f32 v[240:241], v[240:241], v[242:243]
    v_exp_f32 v29, v29
    v_exp_f32 v30, v30
    v_permlane16_swap_b32 v240, v241
    v_add_f32 v240, v240, v241
    v_cvt_pk_bf16_f32 v240, v240, v240
    v_and_b32 v240, 0xffff0000, v240
    v_add_f32 v240, s65, v240
    v_cvt_pk_bf16_f32 v240, v240, v240
    v_and_b32 v240, 0xffff0000, v240
    ds_write_b32 v123, v240
    v_exp_f32 v31, v31
    v_exp_f32 v32, v32
    v_exp_f32 v33, v33
    v_smfmac_f32_32x32x32_bf16 v[48:63], v[100:103], v[24:31], v7
    v_exp_f32 v34, v34
    v_exp_f32 v35, v35
    v_exp_f32 v36, v36
    v_mfma_f32_32x32x16_bf16 v[16:31], v[80:83], v[8:11], 0
    ds_read_b128 v[84:87], v4 offset:47840
    v_exp_f32 v37, v37
    v_exp_f32 v38, v38
    v_exp_f32 v39, v39
    v_exp_f32 v40, v40
    v_exp_f32 v41, v41
    v_smfmac_f32_32x32x32_bf16 v[64:79], v[96:99], v[32:39], v7
    v_exp_f32 v42, v42
    v_exp_f32 v43, v43
    v_exp_f32 v44, v44
    v_exp_f32 v45, v45
    v_exp_f32 v46, v46
    v_exp_f32 v47, v47
    v_exp_f32 v16, v16
    v_exp_f32 v17, v17
    v_smfmac_f32_32x32x32_bf16 v[64:79], v[100:103], v[40:47], v7
    s_waitcnt lgkmcnt(0)
    v_exp_f32 v18, v18
    v_exp_f32 v19, v19
    v_exp_f32 v20, v20
    v_mfma_f32_32x32x16_bf16 v[32:47], v[80:83], v[12:15], 0
    s_add_u32 s46, s46, 4096
    ds_read_b128 v[96:99], v5 offset:47840
    v_exp_f32 v21, v21
    v_exp_f32 v22, v22
    v_exp_f32 v23, v23
    v_exp_f32 v24, v24
    v_exp_f32 v25, v25
    v_smfmac_f32_32x32x32_bf16 v[48:63], v[88:91], v[16:23], v7
    ds_read_b128 v[100:103], v6 offset:47840
    v_exp_f32 v26, v26
    v_exp_f32 v27, v27
    v_exp_f32 v28, v28
    v_exp_f32 v29, v29
    v_exp_f32 v30, v30
    v_exp_f32 v31, v31
    v_exp_f32 v32, v32
    v_exp_f32 v33, v33
    v_smfmac_f32_32x32x32_bf16 v[48:63], v[92:95], v[24:31], v7
    buffer_load_dwordx4 a[16:19], v2, s[8:11], s46 offen offset:0 sc1
    buffer_load_dwordx4 a[20:23], v2, s[8:11], s46 offen offset:1024 sc1
    v_exp_f32 v34, v34
    v_exp_f32 v35, v35
    v_exp_f32 v36, v36
    v_mfma_f32_32x32x16_bf16 v[16:31], v[84:87], v[8:11], 0
    ds_read_b128 v[80:83], v4 offset:49920
    v_exp_f32 v37, v37
    v_exp_f32 v38, v38
    v_exp_f32 v39, v39
    v_exp_f32 v40, v40
    v_exp_f32 v41, v41
    v_smfmac_f32_32x32x32_bf16 v[64:79], v[88:91], v[32:39], v7
    v_exp_f32 v42, v42
    v_exp_f32 v43, v43
    v_exp_f32 v44, v44
    v_exp_f32 v45, v45
    v_exp_f32 v46, v46
    v_exp_f32 v47, v47
    v_exp_f32 v16, v16
    v_exp_f32 v17, v17
    v_smfmac_f32_32x32x32_bf16 v[64:79], v[92:95], v[40:47], v7
    s_waitcnt lgkmcnt(0)
    buffer_load_dwordx4 a[24:27], v2, s[8:11], s46 offen offset:2048 sc1
    buffer_load_dwordx4 a[28:31], v2, s[8:11], s46 offen offset:3072 sc1
    v_exp_f32 v18, v18
    v_exp_f32 v19, v19
    v_exp_f32 v20, v20
    v_mfma_f32_32x32x16_bf16 v[32:47], v[84:87], v[12:15], 0
    s_add_u32 s46, s46, 4096
    ds_read_b128 v[88:91], v5 offset:49920
    v_exp_f32 v21, v21
    v_exp_f32 v22, v22
    v_exp_f32 v23, v23
    v_exp_f32 v24, v24
    v_exp_f32 v25, v25
    v_smfmac_f32_32x32x32_bf16 v[48:63], v[96:99], v[16:23], v7
    ds_read_b128 v[92:95], v6 offset:49920
    v_exp_f32 v26, v26
    v_exp_f32 v27, v27
    v_exp_f32 v28, v28
    v_exp_f32 v29, v29
    v_exp_f32 v30, v30
    v_exp_f32 v31, v31
    v_exp_f32 v32, v32
    v_exp_f32 v33, v33
    v_smfmac_f32_32x32x32_bf16 v[48:63], v[100:103], v[24:31], v7
    buffer_load_dwordx4 a[32:35], v2, s[8:11], s46 offen offset:0 sc1
    buffer_load_dwordx4 a[36:39], v2, s[8:11], s46 offen offset:1024 sc1
    v_exp_f32 v34, v34
    v_exp_f32 v35, v35
    v_exp_f32 v36, v36
    v_mfma_f32_32x32x16_bf16 v[16:31], v[80:83], v[8:11], 0
    ds_read_b128 v[84:87], v4 offset:52000
    v_exp_f32 v37, v37
    v_exp_f32 v38, v38
    v_exp_f32 v39, v39
    v_exp_f32 v40, v40
    v_exp_f32 v41, v41
    v_smfmac_f32_32x32x32_bf16 v[64:79], v[96:99], v[32:39], v7
    v_exp_f32 v42, v42
    v_exp_f32 v43, v43
    v_exp_f32 v44, v44
    v_exp_f32 v45, v45
    v_exp_f32 v46, v46
    v_exp_f32 v47, v47
    v_exp_f32 v16, v16
    v_exp_f32 v17, v17
    v_smfmac_f32_32x32x32_bf16 v[64:79], v[100:103], v[40:47], v7
    s_waitcnt lgkmcnt(0)
    buffer_load_dwordx4 a[40:43], v2, s[8:11], s46 offen offset:2048 sc1
    buffer_load_dwordx4 a[44:47], v2, s[8:11], s46 offen offset:3072 sc1
    v_exp_f32 v18, v18
    v_exp_f32 v19, v19
    v_exp_f32 v20, v20
    v_mfma_f32_32x32x16_bf16 v[32:47], v[80:83], v[12:15], 0
    s_add_u32 s46, s46, 4096
    ds_read_b128 v[96:99], v5 offset:52000
    v_exp_f32 v21, v21
    v_exp_f32 v22, v22
    v_exp_f32 v23, v23
    v_exp_f32 v24, v24
    v_exp_f32 v25, v25
    v_smfmac_f32_32x32x32_bf16 v[48:63], v[88:91], v[16:23], v7
    ds_read_b128 v[100:103], v6 offset:52000
    v_exp_f32 v26, v26
    v_exp_f32 v27, v27
    v_exp_f32 v28, v28
    v_exp_f32 v29, v29
    v_exp_f32 v30, v30
    v_exp_f32 v31, v31
    v_exp_f32 v32, v32
    v_exp_f32 v33, v33
    v_smfmac_f32_32x32x32_bf16 v[48:63], v[92:95], v[24:31], v7
    buffer_load_dwordx4 a[48:51], v2, s[8:11], s46 offen offset:0 sc1
    buffer_load_dwordx4 a[52:55], v2, s[8:11], s46 offen offset:1024 sc1
    v_exp_f32 v34, v34
    v_exp_f32 v35, v35
    v_exp_f32 v36, v36
    v_mfma_f32_32x32x16_bf16 v[16:31], v[84:87], v[8:11], 0
    ds_read_b128 v[80:83], v4 offset:54080
    v_exp_f32 v37, v37
    v_exp_f32 v38, v38
    v_exp_f32 v39, v39
    v_exp_f32 v40, v40
    v_exp_f32 v41, v41
    v_smfmac_f32_32x32x32_bf16 v[64:79], v[88:91], v[32:39], v7
    v_exp_f32 v42, v42
    v_exp_f32 v43, v43
    v_exp_f32 v44, v44
    v_exp_f32 v45, v45
    v_exp_f32 v46, v46
    v_exp_f32 v47, v47
    v_exp_f32 v16, v16
    v_exp_f32 v17, v17
    v_smfmac_f32_32x32x32_bf16 v[64:79], v[92:95], v[40:47], v7
    s_waitcnt lgkmcnt(0)
    buffer_load_dwordx4 a[56:59], v2, s[8:11], s46 offen offset:2048 sc1
    buffer_load_dwordx4 a[60:63], v2, s[8:11], s46 offen offset:3072 sc1
    v_exp_f32 v18, v18
    v_exp_f32 v19, v19
    v_exp_f32 v20, v20
    v_mfma_f32_32x32x16_bf16 v[32:47], v[84:87], v[12:15], 0
    s_add_u32 s46, s46, 4096
    ds_read_b128 v[88:91], v5 offset:54080
    v_exp_f32 v21, v21
    v_exp_f32 v22, v22
    v_exp_f32 v23, v23
    v_exp_f32 v24, v24
    v_exp_f32 v25, v25
    v_smfmac_f32_32x32x32_bf16 v[48:63], v[96:99], v[16:23], v7
    ds_read_b128 v[92:95], v6 offset:54080
    v_exp_f32 v26, v26
    v_exp_f32 v27, v27
    v_exp_f32 v28, v28
    v_exp_f32 v29, v29
    v_exp_f32 v30, v30
    v_exp_f32 v31, v31
    v_exp_f32 v32, v32
    v_exp_f32 v33, v33
    v_smfmac_f32_32x32x32_bf16 v[48:63], v[100:103], v[24:31], v7
    buffer_load_dwordx4 a[64:67], v2, s[8:11], s46 offen offset:0 sc1
    buffer_load_dwordx4 a[68:71], v2, s[8:11], s46 offen offset:1024 sc1
    v_exp_f32 v34, v34
    v_exp_f32 v35, v35
    v_exp_f32 v36, v36
    v_mfma_f32_32x32x16_bf16 v[16:31], v[80:83], v[8:11], 0
    ds_read_b128 v[84:87], v4 offset:56160
    v_exp_f32 v37, v37
    v_exp_f32 v38, v38
    v_exp_f32 v39, v39
    v_exp_f32 v40, v40
    v_exp_f32 v41, v41
    v_smfmac_f32_32x32x32_bf16 v[64:79], v[96:99], v[32:39], v7
    v_exp_f32 v42, v42
    v_exp_f32 v43, v43
    v_exp_f32 v44, v44
    v_exp_f32 v45, v45
    v_exp_f32 v46, v46
    v_exp_f32 v47, v47
    v_exp_f32 v16, v16
    v_exp_f32 v17, v17
    v_smfmac_f32_32x32x32_bf16 v[64:79], v[100:103], v[40:47], v7
    s_waitcnt lgkmcnt(0)
    buffer_load_dwordx4 a[72:75], v2, s[8:11], s46 offen offset:2048 sc1
    buffer_load_dwordx4 a[76:79], v2, s[8:11], s46 offen offset:3072 sc1
    v_exp_f32 v18, v18
    v_exp_f32 v19, v19
    v_exp_f32 v20, v20
    v_mfma_f32_32x32x16_bf16 v[32:47], v[80:83], v[12:15], 0
    ds_read_b128 v[96:99], v5 offset:56160
    v_exp_f32 v21, v21
    v_exp_f32 v22, v22
    v_exp_f32 v23, v23
    v_exp_f32 v24, v24
    v_exp_f32 v25, v25
    v_smfmac_f32_32x32x32_bf16 v[48:63], v[88:91], v[16:23], v7
    ds_read_b128 v[100:103], v6 offset:56160
    v_exp_f32 v26, v26
    v_exp_f32 v27, v27
    v_exp_f32 v28, v28
    v_exp_f32 v29, v29
    v_exp_f32 v30, v30
    v_exp_f32 v31, v31
    v_exp_f32 v32, v32
    v_exp_f32 v33, v33
    v_smfmac_f32_32x32x32_bf16 v[48:63], v[92:95], v[24:31], v7
    v_exp_f32 v34, v34
    v_exp_f32 v35, v35
    v_exp_f32 v36, v36
    v_mfma_f32_32x32x16_bf16 v[16:31], v[84:87], v[8:11], 0
    ds_read_b128 v[80:83], v4 offset:58240
    v_exp_f32 v37, v37
    v_exp_f32 v38, v38
    v_exp_f32 v39, v39
    v_exp_f32 v40, v40
    v_exp_f32 v41, v41
    v_smfmac_f32_32x32x32_bf16 v[64:79], v[88:91], v[32:39], v7
    v_exp_f32 v42, v42
    v_exp_f32 v43, v43
    v_exp_f32 v44, v44
    v_exp_f32 v45, v45
    v_exp_f32 v46, v46
    v_exp_f32 v47, v47
    v_exp_f32 v16, v16
    v_exp_f32 v17, v17
    v_smfmac_f32_32x32x32_bf16 v[64:79], v[92:95], v[40:47], v7
    s_waitcnt lgkmcnt(0)
    v_exp_f32 v18, v18
    v_exp_f32 v19, v19
    v_exp_f32 v20, v20
    v_mfma_f32_32x32x16_bf16 v[32:47], v[84:87], v[12:15], 0
    s_add_u32 s46, s46, 4096
    ds_read_b128 v[88:91], v5 offset:58240
    v_exp_f32 v21, v21
    v_exp_f32 v22, v22
    v_exp_f32 v23, v23
    v_exp_f32 v24, v24
    v_exp_f32 v25, v25
    v_smfmac_f32_32x32x32_bf16 v[48:63], v[96:99], v[16:23], v7
    ds_read_b128 v[92:95], v6 offset:58240
    v_exp_f32 v26, v26
    v_exp_f32 v27, v27
    v_exp_f32 v28, v28
    v_exp_f32 v29, v29
    v_exp_f32 v30, v30
    v_exp_f32 v31, v31
    v_exp_f32 v32, v32
    v_exp_f32 v33, v33
    v_smfmac_f32_32x32x32_bf16 v[48:63], v[100:103], v[24:31], v7
    buffer_load_dwordx4 a[80:83], v2, s[8:11], s46 offen offset:0 sc1
    buffer_load_dwordx4 a[84:87], v2, s[8:11], s46 offen offset:1024 sc1
    v_exp_f32 v34, v34
    v_exp_f32 v35, v35
    v_exp_f32 v36, v36
    v_mfma_f32_32x32x16_bf16 v[16:31], v[80:83], v[8:11], 0
    ds_read_b128 v[84:87], v4 offset:60320
    v_exp_f32 v37, v37
    v_exp_f32 v38, v38
    v_exp_f32 v39, v39
    v_exp_f32 v40, v40
    v_exp_f32 v41, v41
    v_smfmac_f32_32x32x32_bf16 v[64:79], v[96:99], v[32:39], v7
    v_exp_f32 v42, v42
    v_exp_f32 v43, v43
    v_exp_f32 v44, v44
    v_exp_f32 v45, v45
    v_exp_f32 v46, v46
    v_exp_f32 v47, v47
    v_add_u32 v4, 58240, v4
    v_add_u32 v5, 58240, v5
    v_add_u32 v6, 58240, v6
    v_exp_f32 v16, v16
    v_exp_f32 v17, v17
    v_smfmac_f32_32x32x32_bf16 v[64:79], v[100:103], v[40:47], v7
    s_waitcnt lgkmcnt(0)
    buffer_load_dwordx4 a[88:91], v2, s[8:11], s46 offen offset:2048 sc1
    buffer_load_dwordx4 a[92:95], v2, s[8:11], s46 offen offset:3072 sc1
    v_exp_f32 v18, v18
    v_exp_f32 v19, v19
    v_exp_f32 v20, v20
    v_mfma_f32_32x32x16_bf16 v[32:47], v[80:83], v[12:15], 0
    s_add_u32 s46, s46, 4096
    ds_read_b128 v[96:99], v5 offset:2080
    v_exp_f32 v21, v21
    v_exp_f32 v22, v22
    v_exp_f32 v23, v23
    v_exp_f32 v24, v24
    v_exp_f32 v25, v25
    v_smfmac_f32_32x32x32_bf16 v[48:63], v[88:91], v[16:23], v7
    ds_read_b128 v[100:103], v6 offset:2080
    v_exp_f32 v26, v26
    v_exp_f32 v27, v27
    v_exp_f32 v28, v28
    v_exp_f32 v29, v29
    v_exp_f32 v30, v30
    v_exp_f32 v31, v31
    v_exp_f32 v32, v32
    v_exp_f32 v33, v33
    v_smfmac_f32_32x32x32_bf16 v[48:63], v[92:95], v[24:31], v7
    buffer_load_dwordx4 a[96:99], v2, s[8:11], s46 offen offset:0 sc1
    buffer_load_dwordx4 a[100:103], v2, s[8:11], s46 offen offset:1024 sc1
    v_exp_f32 v34, v34
    v_exp_f32 v35, v35
    v_exp_f32 v36, v36
    v_mfma_f32_32x32x16_bf16 v[16:31], v[84:87], v[8:11], 0
    ds_read_b128 v[80:83], v4 offset:4160
    v_exp_f32 v37, v37
    v_exp_f32 v38, v38
    v_exp_f32 v39, v39
    v_exp_f32 v40, v40
    v_exp_f32 v41, v41
    v_smfmac_f32_32x32x32_bf16 v[64:79], v[88:91], v[32:39], v7
    v_exp_f32 v42, v42
    v_exp_f32 v43, v43
    v_exp_f32 v44, v44
    v_exp_f32 v45, v45
    v_exp_f32 v46, v46
    v_exp_f32 v47, v47
    v_exp_f32 v16, v16
    v_exp_f32 v17, v17
    v_smfmac_f32_32x32x32_bf16 v[64:79], v[92:95], v[40:47], v7
    s_waitcnt lgkmcnt(0)
    buffer_load_dwordx4 a[104:107], v2, s[8:11], s46 offen offset:2048 sc1
    buffer_load_dwordx4 a[108:111], v2, s[8:11], s46 offen offset:3072 sc1
    v_exp_f32 v18, v18
    v_exp_f32 v19, v19
    v_exp_f32 v20, v20
    v_mfma_f32_32x32x16_bf16 v[32:47], v[84:87], v[12:15], 0
    s_add_u32 s46, s46, 4096
    ds_read_b128 v[88:91], v5 offset:4160
    v_exp_f32 v21, v21
    v_exp_f32 v22, v22
    v_exp_f32 v23, v23
    v_exp_f32 v24, v24
    v_exp_f32 v25, v25
    v_smfmac_f32_32x32x32_bf16 v[48:63], v[96:99], v[16:23], v7
    ds_read_b128 v[92:95], v6 offset:4160
    v_exp_f32 v26, v26
    v_exp_f32 v27, v27
    v_exp_f32 v28, v28
    v_exp_f32 v29, v29
    v_exp_f32 v30, v30
    v_exp_f32 v31, v31
    v_exp_f32 v32, v32
    v_exp_f32 v33, v33
    v_smfmac_f32_32x32x32_bf16 v[48:63], v[100:103], v[24:31], v7
    buffer_load_dwordx4 a[112:115], v2, s[8:11], s46 offen offset:0 sc1
    buffer_load_dwordx4 a[116:119], v2, s[8:11], s46 offen offset:1024 sc1
    buffer_load_dwordx4 a[120:123], v2, s[8:11], s46 offen offset:2048 sc1
    v_exp_f32 v34, v34
    v_exp_f32 v35, v35
    v_exp_f32 v36, v36
    v_mfma_f32_32x32x16_bf16 v[16:31], v[80:83], v[8:11], 0
    ds_read_b128 v[84:87], v4 offset:6240
    v_exp_f32 v37, v37
    v_exp_f32 v38, v38
    v_exp_f32 v39, v39
    v_exp_f32 v40, v40
    v_exp_f32 v41, v41
    v_smfmac_f32_32x32x32_bf16 v[64:79], v[96:99], v[32:39], v7
    v_exp_f32 v42, v42
    v_exp_f32 v43, v43
    v_exp_f32 v44, v44
    v_exp_f32 v45, v45
    v_exp_f32 v46, v46
    v_exp_f32 v47, v47
    v_exp_f32 v16, v16
    v_exp_f32 v17, v17
    v_smfmac_f32_32x32x32_bf16 v[64:79], v[100:103], v[40:47], v7
    s_waitcnt lgkmcnt(0)
    buffer_load_dwordx4 a[124:127], v2, s[8:11], s46 offen offset:3072 sc1
    global_load_dword v109, v111, s[58:59]
    v_exp_f32 v18, v18
    v_exp_f32 v19, v19
    v_exp_f32 v20, v20
    v_mfma_f32_32x32x16_bf16 v[32:47], v[80:83], v[12:15], 0
    s_sub_u32 s46, s46, 1048576
    ds_read_b128 v[96:99], v5 offset:6240
    v_exp_f32 v21, v21
    v_exp_f32 v22, v22
    v_exp_f32 v23, v23
    v_exp_f32 v24, v24
    v_exp_f32 v25, v25
    v_smfmac_f32_32x32x32_bf16 v[48:63], v[88:91], v[16:23], v7
    ds_read_b128 v[100:103], v6 offset:6240
    v_exp_f32 v26, v26
    v_exp_f32 v27, v27
    v_exp_f32 v28, v28
    v_exp_f32 v29, v29
    v_exp_f32 v30, v30
    v_exp_f32 v31, v31
    v_exp_f32 v32, v32
    v_exp_f32 v33, v33
    v_smfmac_f32_32x32x32_bf16 v[48:63], v[92:95], v[24:31], v7
    buffer_load_dwordx4 v[240:243], v2, s[8:11], s46 offen offset:0 sc1
    buffer_load_dwordx4 v[244:247], v2, s[8:11], s46 offen offset:1024 sc1
    v_exp_f32 v34, v34
    v_exp_f32 v35, v35
    v_exp_f32 v36, v36
    v_mfma_f32_32x32x16_bf16 v[16:31], v[84:87], v[8:11], 0
    ds_read_b128 v[80:83], v4 offset:8320
    v_exp_f32 v37, v37
    v_exp_f32 v38, v38
    v_exp_f32 v39, v39
    v_exp_f32 v40, v40
    v_exp_f32 v41, v41
    v_smfmac_f32_32x32x32_bf16 v[64:79], v[88:91], v[32:39], v7
    v_exp_f32 v42, v42
    v_exp_f32 v43, v43
    v_exp_f32 v44, v44
    v_exp_f32 v45, v45
    v_exp_f32 v46, v46
    v_exp_f32 v47, v47
    v_exp_f32 v16, v16
    v_exp_f32 v17, v17
    v_smfmac_f32_32x32x32_bf16 v[64:79], v[92:95], v[40:47], v7
    s_waitcnt lgkmcnt(0)
    buffer_load_dwordx4 v[248:251], v2, s[8:11], s46 offen offset:2048 sc1
    buffer_load_dwordx4 v[252:255], v2, s[8:11], s46 offen offset:3072 sc1
    v_exp_f32 v18, v18
    v_exp_f32 v19, v19
    v_exp_f32 v20, v20
    v_mfma_f32_32x32x16_bf16 v[32:47], v[84:87], v[12:15], 0
    ds_read_b128 v[88:91], v5 offset:8320
    v_exp_f32 v21, v21
    v_exp_f32 v22, v22
    v_exp_f32 v23, v23
    v_exp_f32 v24, v24
    v_exp_f32 v25, v25
    v_smfmac_f32_32x32x32_bf16 v[48:63], v[96:99], v[16:23], v7
    ds_read_b128 v[92:95], v6 offset:8320
    v_exp_f32 v26, v26
    v_exp_f32 v27, v27
    v_exp_f32 v28, v28
    v_exp_f32 v29, v29
    v_exp_f32 v30, v30
    v_exp_f32 v31, v31
    v_exp_f32 v32, v32
    v_exp_f32 v33, v33
    v_smfmac_f32_32x32x32_bf16 v[48:63], v[100:103], v[24:31], v7
    v_exp_f32 v34, v34
    v_exp_f32 v35, v35
    v_exp_f32 v36, v36
    v_mfma_f32_32x32x16_bf16 v[16:31], v[80:83], v[8:11], 0
    ds_read_b128 v[84:87], v4 offset:10400
    v_exp_f32 v37, v37
    v_exp_f32 v38, v38
    v_exp_f32 v39, v39
    v_exp_f32 v40, v40
    v_exp_f32 v41, v41
    v_smfmac_f32_32x32x32_bf16 v[64:79], v[96:99], v[32:39], v7
    v_exp_f32 v42, v42
    v_exp_f32 v43, v43
    v_exp_f32 v44, v44
    v_exp_f32 v45, v45
    v_exp_f32 v46, v46
    v_exp_f32 v47, v47
    v_exp_f32 v16, v16
    v_exp_f32 v17, v17
    v_smfmac_f32_32x32x32_bf16 v[64:79], v[100:103], v[40:47], v7
    s_waitcnt lgkmcnt(0)
    s_barrier
    v_exp_f32 v18, v18
    v_exp_f32 v19, v19
    v_exp_f32 v20, v20
    v_mfma_f32_32x32x16_bf16 v[32:47], v[80:83], v[12:15], 0
    s_add_u32 m0, s49, 0
    ds_read_b128 v[96:99], v5 offset:10400
    v_exp_f32 v21, v21
    v_exp_f32 v22, v22
    v_exp_f32 v23, v23
    v_exp_f32 v24, v24
    v_exp_f32 v25, v25
    v_smfmac_f32_32x32x32_bf16 v[48:63], v[88:91], v[16:23], v7
    ds_read_b128 v[100:103], v6 offset:10400
    v_exp_f32 v26, v26
    v_exp_f32 v27, v27
    v_exp_f32 v28, v28
    v_exp_f32 v29, v29
    v_exp_f32 v30, v30
    v_exp_f32 v31, v31
    v_exp_f32 v32, v32
    v_exp_f32 v33, v33
    v_smfmac_f32_32x32x32_bf16 v[48:63], v[92:95], v[24:31], v7
    buffer_load_dwordx4 a[128:131], v2, s[8:11], s47 offen offset:0 sc1
    buffer_load_dwordx4 a[132:135], v2, s[8:11], s47 offen offset:1024 sc1
    v_exp_f32 v34, v34
    v_exp_f32 v35, v35
    v_exp_f32 v36, v36
    v_mfma_f32_32x32x16_bf16 v[16:31], v[84:87], v[8:11], 0
    ds_read_b128 v[80:83], v4 offset:12480
    v_exp_f32 v37, v37
    v_exp_f32 v38, v38
    v_exp_f32 v39, v39
    v_exp_f32 v40, v40
    v_exp_f32 v41, v41
    v_smfmac_f32_32x32x32_bf16 v[64:79], v[88:91], v[32:39], v7
    v_exp_f32 v42, v42
    v_exp_f32 v43, v43
    v_exp_f32 v44, v44
    v_exp_f32 v45, v45
    v_exp_f32 v46, v46
    v_exp_f32 v47, v47
    v_exp_f32 v16, v16
    v_exp_f32 v17, v17
    v_smfmac_f32_32x32x32_bf16 v[64:79], v[92:95], v[40:47], v7
    s_waitcnt lgkmcnt(0)
    buffer_load_dwordx4 v124, s[28:31], s48 offen lds
    buffer_load_dwordx4 v126, s[28:31], s48 offen offset:1024 lds
    v_exp_f32 v18, v18
    v_exp_f32 v19, v19
    v_exp_f32 v20, v20
    v_mfma_f32_32x32x16_bf16 v[32:47], v[84:87], v[12:15], 0
    s_add_u32 m0, m0, 2048
    ds_read_b128 v[88:91], v5 offset:12480
    v_exp_f32 v21, v21
    v_exp_f32 v22, v22
    v_exp_f32 v23, v23
    v_exp_f32 v24, v24
    v_exp_f32 v25, v25
    v_smfmac_f32_32x32x32_bf16 v[48:63], v[96:99], v[16:23], v7
    s_add_u32 s48, s48, 16384
    ds_read_b128 v[92:95], v6 offset:12480
    v_exp_f32 v26, v26
    v_exp_f32 v27, v27
    v_exp_f32 v28, v28
    v_exp_f32 v29, v29
    v_exp_f32 v30, v30
    v_exp_f32 v31, v31
    v_exp_f32 v32, v32
    v_exp_f32 v33, v33
    v_smfmac_f32_32x32x32_bf16 v[48:63], v[100:103], v[24:31], v7
    buffer_load_dwordx4 a[136:139], v2, s[8:11], s47 offen offset:2048 sc1
    buffer_load_dwordx4 a[140:143], v2, s[8:11], s47 offen offset:3072 sc1
    v_exp_f32 v34, v34
    v_exp_f32 v35, v35
    v_exp_f32 v36, v36
    v_mfma_f32_32x32x16_bf16 v[16:31], v[80:83], v[8:11], 0
    ds_read_b128 v[84:87], v4 offset:14560
    v_exp_f32 v37, v37
    v_exp_f32 v38, v38
    v_exp_f32 v39, v39
    v_exp_f32 v40, v40
    v_exp_f32 v41, v41
    v_smfmac_f32_32x32x32_bf16 v[64:79], v[96:99], v[32:39], v7
    v_exp_f32 v42, v42
    v_exp_f32 v43, v43
    v_exp_f32 v44, v44
    v_exp_f32 v45, v45
    v_exp_f32 v46, v46
    v_exp_f32 v47, v47
    v_exp_f32 v16, v16
    v_exp_f32 v17, v17
    v_smfmac_f32_32x32x32_bf16 v[64:79], v[100:103], v[40:47], v7
    s_waitcnt lgkmcnt(0)
    buffer_load_dwordx4 v124, s[28:31], s48 offen lds
    buffer_load_dwordx4 v126, s[28:31], s48 offen offset:1024 lds
    v_exp_f32 v18, v18
    v_exp_f32 v19, v19
    v_exp_f32 v20, v20
    v_mfma_f32_32x32x16_bf16 v[32:47], v[80:83], v[12:15], 0
    s_add_u32 s47, s47, 4096
    ds_read_b128 v[96:99], v5 offset:14560
    v_exp_f32 v21, v21
    v_exp_f32 v22, v22
    v_exp_f32 v23, v23
    v_exp_f32 v24, v24
    v_exp_f32 v25, v25
    v_smfmac_f32_32x32x32_bf16 v[48:63], v[88:91], v[16:23], v7
    s_add_u32 m0, m0, 2048
    s_add_u32 s48, s48, 16384
    ds_read_b128 v[100:103], v6 offset:14560
    v_exp_f32 v26, v26
    v_exp_f32 v27, v27
    v_exp_f32 v28, v28
    v_exp_f32 v29, v29
    v_exp_f32 v30, v30
    v_exp_f32 v31, v31
    v_exp_f32 v32, v32
    v_exp_f32 v33, v33
    v_smfmac_f32_32x32x32_bf16 v[48:63], v[92:95], v[24:31], v7
    buffer_load_dwordx4 a[144:147], v2, s[8:11], s47 offen offset:0 sc1
    buffer_load_dwordx4 a[148:151], v2, s[8:11], s47 offen offset:1024 sc1
    v_exp_f32 v34, v34
    v_exp_f32 v35, v35
    v_exp_f32 v36, v36
    v_mfma_f32_32x32x16_bf16 v[16:31], v[84:87], v[8:11], 0
    ds_read_b128 v[80:83], v4 offset:16640
    v_exp_f32 v37, v37
    v_exp_f32 v38, v38
    v_exp_f32 v39, v39
    v_exp_f32 v40, v40
    v_exp_f32 v41, v41
    v_smfmac_f32_32x32x32_bf16 v[64:79], v[88:91], v[32:39], v7
    v_exp_f32 v42, v42
    v_exp_f32 v43, v43
    v_exp_f32 v44, v44
    v_exp_f32 v45, v45
    v_exp_f32 v46, v46
    v_exp_f32 v47, v47
    v_exp_f32 v16, v16
    v_exp_f32 v17, v17
    v_smfmac_f32_32x32x32_bf16 v[64:79], v[92:95], v[40:47], v7
    s_waitcnt lgkmcnt(0)
    buffer_load_dwordx4 v124, s[28:31], s48 offen lds
    buffer_load_dwordx4 v126, s[28:31], s48 offen offset:1024 lds
    v_exp_f32 v18, v18
    v_exp_f32 v19, v19
    v_exp_f32 v20, v20
    v_mfma_f32_32x32x16_bf16 v[32:47], v[84:87], v[12:15], 0
    s_add_u32 m0, m0, 2048
    ds_read_b128 v[88:91], v5 offset:16640
    v_exp_f32 v21, v21
    v_exp_f32 v22, v22
    v_exp_f32 v23, v23
    v_exp_f32 v24, v24
    v_exp_f32 v25, v25
    v_smfmac_f32_32x32x32_bf16 v[48:63], v[96:99], v[16:23], v7
    s_add_u32 s48, s48, 16384
    ds_read_b128 v[92:95], v6 offset:16640
    v_exp_f32 v26, v26
    v_exp_f32 v27, v27
    v_exp_f32 v28, v28
    v_exp_f32 v29, v29
    v_exp_f32 v30, v30
    v_exp_f32 v31, v31
    v_exp_f32 v32, v32
    v_exp_f32 v33, v33
    v_smfmac_f32_32x32x32_bf16 v[48:63], v[100:103], v[24:31], v7
    buffer_load_dwordx4 a[152:155], v2, s[8:11], s47 offen offset:2048 sc1
    buffer_load_dwordx4 a[156:159], v2, s[8:11], s47 offen offset:3072 sc1
    v_exp_f32 v34, v34
    v_exp_f32 v35, v35
    v_exp_f32 v36, v36
    v_mfma_f32_32x32x16_bf16 v[16:31], v[80:83], v[8:11], 0
    ds_read_b128 v[84:87], v4 offset:18720
    v_exp_f32 v37, v37
    v_exp_f32 v38, v38
    v_exp_f32 v39, v39
    v_exp_f32 v40, v40
    v_exp_f32 v41, v41
    v_smfmac_f32_32x32x32_bf16 v[64:79], v[96:99], v[32:39], v7
    v_exp_f32 v42, v42
    v_exp_f32 v43, v43
    v_exp_f32 v44, v44
    v_exp_f32 v45, v45
    v_exp_f32 v46, v46
    v_exp_f32 v47, v47
    v_exp_f32 v16, v16
    v_exp_f32 v17, v17
    v_smfmac_f32_32x32x32_bf16 v[64:79], v[100:103], v[40:47], v7
    s_waitcnt lgkmcnt(0)
    buffer_load_dwordx4 v124, s[28:31], s48 offen lds
    buffer_load_dwordx4 v126, s[28:31], s48 offen offset:1024 lds
    v_exp_f32 v18, v18
    v_exp_f32 v19, v19
    v_exp_f32 v20, v20
    v_mfma_f32_32x32x16_bf16 v[32:47], v[80:83], v[12:15], 0
    ds_read_b128 v[96:99], v5 offset:18720
    v_exp_f32 v21, v21
    v_exp_f32 v22, v22
    v_exp_f32 v23, v23
    v_exp_f32 v24, v24
    v_exp_f32 v25, v25
    v_smfmac_f32_32x32x32_bf16 v[48:63], v[88:91], v[16:23], v7
    ds_read_b128 v[100:103], v6 offset:18720
    v_exp_f32 v26, v26
    v_exp_f32 v27, v27
    v_exp_f32 v28, v28
    v_exp_f32 v29, v29
    v_exp_f32 v30, v30
    v_exp_f32 v31, v31
    v_exp_f32 v32, v32
    v_exp_f32 v33, v33
    v_smfmac_f32_32x32x32_bf16 v[48:63], v[92:95], v[24:31], v7
    v_exp_f32 v34, v34
    v_exp_f32 v35, v35
    v_exp_f32 v36, v36
    v_mfma_f32_32x32x16_bf16 v[16:31], v[84:87], v[8:11], 0
    ds_read_b128 v[80:83], v4 offset:20800
    v_exp_f32 v37, v37
    v_exp_f32 v38, v38
    v_exp_f32 v39, v39
    v_exp_f32 v40, v40
    v_exp_f32 v41, v41
    v_smfmac_f32_32x32x32_bf16 v[64:79], v[88:91], v[32:39], v7
    v_exp_f32 v42, v42
    v_exp_f32 v43, v43
    v_exp_f32 v44, v44
    v_exp_f32 v45, v45
    v_exp_f32 v46, v46
    v_exp_f32 v47, v47
    v_exp_f32 v16, v16
    v_exp_f32 v17, v17
    v_smfmac_f32_32x32x32_bf16 v[64:79], v[92:95], v[40:47], v7
    s_waitcnt lgkmcnt(0)
    v_exp_f32 v18, v18
    v_exp_f32 v19, v19
    v_exp_f32 v20, v20
    v_mfma_f32_32x32x16_bf16 v[32:47], v[84:87], v[12:15], 0
    s_add_u32 s47, s47, 4096
    ds_read_b128 v[88:91], v5 offset:20800
    v_exp_f32 v21, v21
    v_exp_f32 v22, v22
    v_exp_f32 v23, v23
    v_exp_f32 v24, v24
    v_exp_f32 v25, v25
    v_smfmac_f32_32x32x32_bf16 v[48:63], v[96:99], v[16:23], v7
    s_add_u32 m0, m0, 2048
    s_add_u32 s48, s48, 16384
    ds_read_b128 v[92:95], v6 offset:20800
    v_exp_f32 v26, v26
    v_exp_f32 v27, v27
    v_exp_f32 v28, v28
    v_exp_f32 v29, v29
    v_exp_f32 v30, v30
    v_exp_f32 v31, v31
    v_exp_f32 v32, v32
    v_exp_f32 v33, v33
    v_smfmac_f32_32x32x32_bf16 v[48:63], v[100:103], v[24:31], v7
    buffer_load_dwordx4 a[160:163], v2, s[8:11], s47 offen offset:0 sc1
    buffer_load_dwordx4 a[164:167], v2, s[8:11], s47 offen offset:1024 sc1
    v_exp_f32 v34, v34
    v_exp_f32 v35, v35
    v_exp_f32 v36, v36
    v_mfma_f32_32x32x16_bf16 v[16:31], v[80:83], v[8:11], 0
    ds_read_b128 v[84:87], v4 offset:22880
    v_exp_f32 v37, v37
    v_exp_f32 v38, v38
    v_exp_f32 v39, v39
    v_exp_f32 v40, v40
    v_exp_f32 v41, v41
    v_smfmac_f32_32x32x32_bf16 v[64:79], v[96:99], v[32:39], v7
    v_exp_f32 v42, v42
    v_exp_f32 v43, v43
    v_exp_f32 v44, v44
    v_exp_f32 v45, v45
    v_exp_f32 v46, v46
    v_exp_f32 v47, v47
    v_exp_f32 v16, v16
    v_exp_f32 v17, v17
    v_smfmac_f32_32x32x32_bf16 v[64:79], v[100:103], v[40:47], v7
    s_waitcnt lgkmcnt(0)
    buffer_load_dwordx4 v124, s[28:31], s48 offen lds
    buffer_load_dwordx4 v126, s[28:31], s48 offen offset:1024 lds
    v_exp_f32 v18, v18
    v_exp_f32 v19, v19
    v_exp_f32 v20, v20
    v_mfma_f32_32x32x16_bf16 v[32:47], v[80:83], v[12:15], 0
    s_add_u32 m0, m0, 2048
    ds_read_b128 v[96:99], v5 offset:22880
    v_exp_f32 v21, v21
    v_exp_f32 v22, v22
    v_exp_f32 v23, v23
    v_exp_f32 v24, v24
    v_exp_f32 v25, v25
    v_smfmac_f32_32x32x32_bf16 v[48:63], v[88:91], v[16:23], v7
    s_add_u32 s48, s48, 16384
    ds_read_b128 v[100:103], v6 offset:22880
    v_exp_f32 v26, v26
    v_exp_f32 v27, v27
    v_exp_f32 v28, v28
    v_exp_f32 v29, v29
    v_exp_f32 v30, v30
    v_exp_f32 v31, v31
    v_exp_f32 v32, v32
    v_exp_f32 v33, v33
    v_smfmac_f32_32x32x32_bf16 v[48:63], v[92:95], v[24:31], v7
    buffer_load_dwordx4 a[168:171], v2, s[8:11], s47 offen offset:2048 sc1
    buffer_load_dwordx4 a[172:175], v2, s[8:11], s47 offen offset:3072 sc1
    v_exp_f32 v34, v34
    v_exp_f32 v35, v35
    v_exp_f32 v36, v36
    v_mfma_f32_32x32x16_bf16 v[16:31], v[84:87], v[8:11], 0
    ds_read_b128 v[80:83], v4 offset:24960
    v_exp_f32 v37, v37
    v_exp_f32 v38, v38
    v_exp_f32 v39, v39
    v_exp_f32 v40, v40
    v_exp_f32 v41, v41
    v_smfmac_f32_32x32x32_bf16 v[64:79], v[88:91], v[32:39], v7
    v_exp_f32 v42, v42
    v_exp_f32 v43, v43
    v_exp_f32 v44, v44
    v_exp_f32 v45, v45
    v_exp_f32 v46, v46
    v_exp_f32 v47, v47
    v_exp_f32 v16, v16
    v_exp_f32 v17, v17
    v_smfmac_f32_32x32x32_bf16 v[64:79], v[92:95], v[40:47], v7
    s_waitcnt lgkmcnt(0)
    buffer_load_dwordx4 v124, s[28:31], s48 offen lds
    buffer_load_dwordx4 v126, s[28:31], s48 offen offset:1024 lds
    v_exp_f32 v18, v18
    v_exp_f32 v19, v19
    v_exp_f32 v20, v20
    v_mfma_f32_32x32x16_bf16 v[32:47], v[84:87], v[12:15], 0
    s_add_u32 s47, s47, 4096
    ds_read_b128 v[88:91], v5 offset:24960
    v_exp_f32 v21, v21
    v_exp_f32 v22, v22
    v_exp_f32 v23, v23
    v_exp_f32 v24, v24
    v_exp_f32 v25, v25
    v_smfmac_f32_32x32x32_bf16 v[48:63], v[96:99], v[16:23], v7
    s_add_u32 m0, m0, 2048
    s_add_u32 s48, s48, 16384
    ds_read_b128 v[92:95], v6 offset:24960
    v_exp_f32 v26, v26
    v_exp_f32 v27, v27
    v_exp_f32 v28, v28
    v_exp_f32 v29, v29
    v_exp_f32 v30, v30
    v_exp_f32 v31, v31
    v_exp_f32 v32, v32
    v_exp_f32 v33, v33
    v_smfmac_f32_32x32x32_bf16 v[48:63], v[100:103], v[24:31], v7
    buffer_load_dwordx4 a[176:179], v2, s[8:11], s47 offen offset:0 sc1
    buffer_load_dwordx4 a[180:183], v2, s[8:11], s47 offen offset:1024 sc1
    v_exp_f32 v34, v34
    v_exp_f32 v35, v35
    v_exp_f32 v36, v36
    v_mfma_f32_32x32x16_bf16 v[16:31], v[80:83], v[8:11], 0
    ds_read_b128 v[84:87], v4 offset:27040
    v_exp_f32 v37, v37
    v_exp_f32 v38, v38
    v_exp_f32 v39, v39
    v_exp_f32 v40, v40
    v_exp_f32 v41, v41
    v_smfmac_f32_32x32x32_bf16 v[64:79], v[96:99], v[32:39], v7
    v_exp_f32 v42, v42
    v_exp_f32 v43, v43
    v_exp_f32 v44, v44
    v_exp_f32 v45, v45
    v_exp_f32 v46, v46
    v_exp_f32 v47, v47
    v_exp_f32 v16, v16
    v_exp_f32 v17, v17
    v_smfmac_f32_32x32x32_bf16 v[64:79], v[100:103], v[40:47], v7
    s_waitcnt lgkmcnt(0)
    buffer_load_dwordx4 v124, s[28:31], s48 offen lds
    buffer_load_dwordx4 v126, s[28:31], s48 offen offset:1024 lds
    v_exp_f32 v18, v18
    v_exp_f32 v19, v19
    v_exp_f32 v20, v20
    v_mfma_f32_32x32x16_bf16 v[32:47], v[80:83], v[12:15], 0
    s_add_u32 m0, m0, 2048
    ds_read_b128 v[96:99], v5 offset:27040
    v_exp_f32 v21, v21
    v_exp_f32 v22, v22
    v_exp_f32 v23, v23
    v_exp_f32 v24, v24
    v_exp_f32 v25, v25
    v_smfmac_f32_32x32x32_bf16 v[48:63], v[88:91], v[16:23], v7
    s_add_u32 s48, s48, 16384
    ds_read_b128 v[100:103], v6 offset:27040
    v_exp_f32 v26, v26
    v_exp_f32 v27, v27
    v_exp_f32 v28, v28
    v_exp_f32 v29, v29
    v_exp_f32 v30, v30
    v_exp_f32 v31, v31
    v_exp_f32 v32, v32
    v_exp_f32 v33, v33
    v_smfmac_f32_32x32x32_bf16 v[48:63], v[92:95], v[24:31], v7
    buffer_load_dwordx4 a[184:187], v2, s[8:11], s47 offen offset:2048 sc1
    buffer_load_dwordx4 a[188:191], v2, s[8:11], s47 offen offset:3072 sc1
    v_exp_f32 v34, v34
    v_exp_f32 v35, v35
    v_exp_f32 v36, v36
    v_mfma_f32_32x32x16_bf16 v[16:31], v[84:87], v[8:11], 0
    ds_read_b128 v[80:83], v4 offset:29120
    v_exp_f32 v37, v37
    v_exp_f32 v38, v38
    v_exp_f32 v39, v39
    v_exp_f32 v40, v40
    v_exp_f32 v41, v41
    v_smfmac_f32_32x32x32_bf16 v[64:79], v[88:91], v[32:39], v7
    v_exp_f32 v42, v42
    v_exp_f32 v43, v43
    v_exp_f32 v44, v44
    v_exp_f32 v45, v45
    v_exp_f32 v46, v46
    v_exp_f32 v47, v47
    v_exp_f32 v16, v16
    v_exp_f32 v17, v17
    v_smfmac_f32_32x32x32_bf16 v[64:79], v[92:95], v[40:47], v7
    s_waitcnt lgkmcnt(0)
    buffer_load_dwordx4 v124, s[28:31], s48 offen lds
    buffer_load_dwordx4 v126, s[28:31], s48 offen offset:1024 lds
    v_exp_f32 v18, v18
    v_exp_f32 v19, v19
    v_exp_f32 v20, v20
    v_mfma_f32_32x32x16_bf16 v[32:47], v[84:87], v[12:15], 0
    ds_read_b128 v[88:91], v5 offset:29120
    v_exp_f32 v21, v21
    v_exp_f32 v22, v22
    v_exp_f32 v23, v23
    v_exp_f32 v24, v24
    v_exp_f32 v25, v25
    v_smfmac_f32_32x32x32_bf16 v[48:63], v[96:99], v[16:23], v7
    ds_read_b128 v[92:95], v6 offset:29120
    v_exp_f32 v26, v26
    v_exp_f32 v27, v27
    v_exp_f32 v28, v28
    v_exp_f32 v29, v29
    v_exp_f32 v30, v30
    v_exp_f32 v31, v31
    v_exp_f32 v32, v32
    v_exp_f32 v33, v33
    v_smfmac_f32_32x32x32_bf16 v[48:63], v[100:103], v[24:31], v7
    v_exp_f32 v34, v34
    v_exp_f32 v35, v35
    v_exp_f32 v36, v36
    v_mfma_f32_32x32x16_bf16 v[16:31], v[80:83], v[8:11], 0
    ds_read_b128 v[84:87], v4 offset:31200
    v_exp_f32 v37, v37
    v_exp_f32 v38, v38
    v_exp_f32 v39, v39
    v_exp_f32 v40, v40
    v_exp_f32 v41, v41
    v_smfmac_f32_32x32x32_bf16 v[64:79], v[96:99], v[32:39], v7
    v_exp_f32 v42, v42
    v_exp_f32 v43, v43
    v_exp_f32 v44, v44
    v_exp_f32 v45, v45
    v_exp_f32 v46, v46
    v_exp_f32 v47, v47
    v_exp_f32 v16, v16
    v_exp_f32 v17, v17
    v_smfmac_f32_32x32x32_bf16 v[64:79], v[100:103], v[40:47], v7
    s_waitcnt lgkmcnt(0)
    v_exp_f32 v18, v18
    v_exp_f32 v19, v19
    v_exp_f32 v20, v20
    v_mfma_f32_32x32x16_bf16 v[32:47], v[80:83], v[12:15], 0
    s_add_u32 s47, s47, 4096
    ds_read_b128 v[96:99], v5 offset:31200
    v_exp_f32 v21, v21
    v_exp_f32 v22, v22
    v_exp_f32 v23, v23
    v_exp_f32 v24, v24
    v_exp_f32 v25, v25
    v_smfmac_f32_32x32x32_bf16 v[48:63], v[88:91], v[16:23], v7
    ds_read_b128 v[100:103], v6 offset:31200
    v_exp_f32 v26, v26
    v_exp_f32 v27, v27
    v_exp_f32 v28, v28
    v_exp_f32 v29, v29
    v_exp_f32 v30, v30
    v_exp_f32 v31, v31
    v_exp_f32 v32, v32
    v_exp_f32 v33, v33
    v_smfmac_f32_32x32x32_bf16 v[48:63], v[92:95], v[24:31], v7
    buffer_load_dwordx4 a[192:195], v2, s[8:11], s47 offen offset:0 sc1
    buffer_load_dwordx4 a[196:199], v2, s[8:11], s47 offen offset:1024 sc1
    buffer_load_dwordx4 a[200:203], v2, s[8:11], s47 offen offset:2048 sc1
    v_exp_f32 v34, v34
    v_exp_f32 v35, v35
    v_exp_f32 v36, v36
    v_mfma_f32_32x32x16_bf16 v[16:31], v[84:87], v[8:11], 0
    ds_read_b128 v[80:83], v4 offset:33280
    v_exp_f32 v37, v37
    v_exp_f32 v38, v38
    v_exp_f32 v39, v39
    v_exp_f32 v40, v40
    v_exp_f32 v41, v41
    v_smfmac_f32_32x32x32_bf16 v[64:79], v[88:91], v[32:39], v7
    v_exp_f32 v42, v42
    v_exp_f32 v43, v43
    v_exp_f32 v44, v44
    v_exp_f32 v45, v45
    v_exp_f32 v46, v46
    v_exp_f32 v47, v47
    v_exp_f32 v16, v16
    v_exp_f32 v17, v17
    v_smfmac_f32_32x32x32_bf16 v[64:79], v[92:95], v[40:47], v7
    s_waitcnt lgkmcnt(0)
    buffer_load_dwordx4 a[204:207], v2, s[8:11], s47 offen offset:3072 sc1
    global_load_dword v125, v111, s[60:61]
    v_exp_f32 v18, v18
    v_exp_f32 v19, v19
    v_exp_f32 v20, v20
    v_mfma_f32_32x32x16_bf16 v[32:47], v[84:87], v[12:15], 0
    s_add_u32 s47, s47, 4096
    ds_read_b128 v[88:91], v5 offset:33280
    v_exp_f32 v21, v21
    v_exp_f32 v22, v22
    v_exp_f32 v23, v23
    v_exp_f32 v24, v24
    v_exp_f32 v25, v25
    v_smfmac_f32_32x32x32_bf16 v[48:63], v[96:99], v[16:23], v7
    ds_read_b128 v[92:95], v6 offset:33280
    v_exp_f32 v26, v26
    v_exp_f32 v27, v27
    v_exp_f32 v28, v28
    v_exp_f32 v29, v29
    v_exp_f32 v30, v30
    v_exp_f32 v31, v31
    v_exp_f32 v32, v32
    v_exp_f32 v33, v33
    v_smfmac_f32_32x32x32_bf16 v[48:63], v[100:103], v[24:31], v7
    buffer_load_dwordx4 a[208:211], v2, s[8:11], s47 offen offset:0 sc1
    buffer_load_dwordx4 a[212:215], v2, s[8:11], s47 offen offset:1024 sc1
    buffer_load_dwordx4 a[216:219], v2, s[8:11], s47 offen offset:2048 sc1
    v_exp_f32 v34, v34
    v_exp_f32 v35, v35
    v_exp_f32 v36, v36
    v_mfma_f32_32x32x16_bf16 v[16:31], v[80:83], v[8:11], 0
    ds_read_b128 v[84:87], v4 offset:35360
    v_exp_f32 v37, v37
    v_exp_f32 v38, v38
    v_exp_f32 v39, v39
    v_exp_f32 v40, v40
    v_exp_f32 v41, v41
    v_smfmac_f32_32x32x32_bf16 v[64:79], v[96:99], v[32:39], v7
    v_exp_f32 v42, v42
    v_exp_f32 v43, v43
    v_exp_f32 v44, v44
    v_exp_f32 v45, v45
    v_exp_f32 v46, v46
    v_exp_f32 v47, v47
    v_exp_f32 v16, v16
    v_exp_f32 v17, v17
    v_smfmac_f32_32x32x32_bf16 v[64:79], v[100:103], v[40:47], v7
    s_waitcnt lgkmcnt(0)
    buffer_load_dwordx4 a[220:223], v2, s[8:11], s47 offen offset:3072 sc1
    global_load_dword v110, v111, s[60:61] offset:2048
    v_exp_f32 v18, v18
    v_exp_f32 v19, v19
    v_exp_f32 v20, v20
    v_mfma_f32_32x32x16_bf16 v[32:47], v[80:83], v[12:15], 0
    s_add_u32 s47, s47, 4096
    ds_read_b128 v[96:99], v5 offset:35360
    v_exp_f32 v21, v21
    v_exp_f32 v22, v22
    v_exp_f32 v23, v23
    v_exp_f32 v24, v24
    v_exp_f32 v25, v25
    v_smfmac_f32_32x32x32_bf16 v[48:63], v[88:91], v[16:23], v7
    ds_read_b128 v[100:103], v6 offset:35360
    v_exp_f32 v26, v26
    v_exp_f32 v27, v27
    v_exp_f32 v28, v28
    v_exp_f32 v29, v29
    v_exp_f32 v30, v30
    v_exp_f32 v31, v31
    v_exp_f32 v32, v32
    v_exp_f32 v33, v33
    v_smfmac_f32_32x32x32_bf16 v[48:63], v[92:95], v[24:31], v7
    buffer_load_dwordx4 a[224:227], v2, s[8:11], s47 offen offset:0 sc1
    buffer_load_dwordx4 a[228:231], v2, s[8:11], s47 offen offset:1024 sc1
    v_exp_f32 v34, v34
    v_exp_f32 v35, v35
    v_exp_f32 v36, v36
    v_mfma_f32_32x32x16_bf16 v[16:31], v[84:87], v[8:11], 0
    ds_read_b128 v[80:83], v4 offset:37440
    v_exp_f32 v37, v37
    v_exp_f32 v38, v38
    v_exp_f32 v39, v39
    v_exp_f32 v40, v40
    v_exp_f32 v41, v41
    v_smfmac_f32_32x32x32_bf16 v[64:79], v[88:91], v[32:39], v7
    v_exp_f32 v42, v42
    v_exp_f32 v43, v43
    v_exp_f32 v44, v44
    v_exp_f32 v45, v45
    v_exp_f32 v46, v46
    v_exp_f32 v47, v47
    v_exp_f32 v16, v16
    v_exp_f32 v17, v17
    v_smfmac_f32_32x32x32_bf16 v[64:79], v[92:95], v[40:47], v7
    s_waitcnt lgkmcnt(0)
    buffer_load_dwordx4 a[232:235], v2, s[8:11], s47 offen offset:2048 sc1
    buffer_load_dwordx4 a[236:239], v2, s[8:11], s47 offen offset:3072 sc1
    v_exp_f32 v18, v18
    v_exp_f32 v19, v19
    v_exp_f32 v20, v20
    v_mfma_f32_32x32x16_bf16 v[32:47], v[84:87], v[12:15], 0
    s_add_u32 s47, s47, 4096
    ds_read_b128 v[88:91], v5 offset:37440
    v_exp_f32 v21, v21
    v_exp_f32 v22, v22
    v_exp_f32 v23, v23
    v_exp_f32 v24, v24
    v_exp_f32 v25, v25
    v_smfmac_f32_32x32x32_bf16 v[48:63], v[96:99], v[16:23], v7
    ds_read_b128 v[92:95], v6 offset:37440
    v_exp_f32 v26, v26
    v_exp_f32 v27, v27
    v_exp_f32 v28, v28
    v_exp_f32 v29, v29
    v_exp_f32 v30, v30
    v_exp_f32 v31, v31
    v_exp_f32 v32, v32
    v_exp_f32 v33, v33
    v_smfmac_f32_32x32x32_bf16 v[48:63], v[100:103], v[24:31], v7
    buffer_load_dwordx4 a[240:243], v2, s[8:11], s47 offen offset:0 sc1
    buffer_load_dwordx4 a[244:247], v2, s[8:11], s47 offen offset:1024 sc1
    v_exp_f32 v34, v34
    v_exp_f32 v35, v35
    v_exp_f32 v36, v36
    v_mfma_f32_32x32x16_bf16 v[16:31], v[80:83], v[8:11], 0
    ds_read_b128 v[84:87], v4 offset:39520
    v_exp_f32 v37, v37
    v_exp_f32 v38, v38
    v_exp_f32 v39, v39
    v_exp_f32 v40, v40
    v_exp_f32 v41, v41
    v_smfmac_f32_32x32x32_bf16 v[64:79], v[96:99], v[32:39], v7
    v_exp_f32 v42, v42
    v_exp_f32 v43, v43
    v_exp_f32 v44, v44
    v_exp_f32 v45, v45
    v_exp_f32 v46, v46
    v_exp_f32 v47, v47
    v_exp_f32 v16, v16
    v_exp_f32 v17, v17
    v_smfmac_f32_32x32x32_bf16 v[64:79], v[100:103], v[40:47], v7
    s_waitcnt lgkmcnt(0)
    buffer_load_dwordx4 a[248:251], v2, s[8:11], s47 offen offset:2048 sc1
    buffer_load_dwordx4 a[252:255], v2, s[8:11], s47 offen offset:3072 sc1
    v_exp_f32 v18, v18
    v_exp_f32 v19, v19
    v_exp_f32 v20, v20
    v_mfma_f32_32x32x16_bf16 v[32:47], v[80:83], v[12:15], 0
    ds_read_b128 v[96:99], v5 offset:39520
    v_exp_f32 v21, v21
    v_exp_f32 v22, v22
    v_exp_f32 v23, v23
    v_exp_f32 v24, v24
    v_exp_f32 v25, v25
    v_smfmac_f32_32x32x32_bf16 v[48:63], v[88:91], v[16:23], v7
    ds_read_b128 v[100:103], v6 offset:39520
    v_exp_f32 v26, v26
    v_exp_f32 v27, v27
    v_exp_f32 v28, v28
    v_exp_f32 v29, v29
    v_exp_f32 v30, v30
    v_exp_f32 v31, v31
    v_exp_f32 v32, v32
    v_exp_f32 v33, v33
    v_smfmac_f32_32x32x32_bf16 v[48:63], v[92:95], v[24:31], v7
    v_exp_f32 v34, v34
    v_exp_f32 v35, v35
    v_exp_f32 v36, v36
    v_mfma_f32_32x32x16_bf16 v[16:31], v[84:87], v[8:11], 0
    ds_read_b128 v[80:83], v4 offset:41600
    v_exp_f32 v37, v37
    v_exp_f32 v38, v38
    v_exp_f32 v39, v39
    v_exp_f32 v40, v40
    v_exp_f32 v41, v41
    v_smfmac_f32_32x32x32_bf16 v[64:79], v[88:91], v[32:39], v7
    v_exp_f32 v42, v42
    v_exp_f32 v43, v43
    v_exp_f32 v44, v44
    v_exp_f32 v45, v45
    v_exp_f32 v46, v46
    v_exp_f32 v47, v47
    v_exp_f32 v16, v16
    v_exp_f32 v17, v17
    v_smfmac_f32_32x32x32_bf16 v[64:79], v[92:95], v[40:47], v7
    s_waitcnt lgkmcnt(0)
    v_exp_f32 v18, v18
    v_exp_f32 v19, v19
    v_exp_f32 v20, v20
    v_mfma_f32_32x32x16_bf16 v[32:47], v[84:87], v[12:15], 0
    s_add_u32 s63, s57, 4194304
    ds_read_b128 v[88:91], v5 offset:41600
    v_exp_f32 v21, v21
    v_exp_f32 v22, v22
    v_exp_f32 v23, v23
    v_exp_f32 v24, v24
    v_exp_f32 v25, v25
    v_smfmac_f32_32x32x32_bf16 v[48:63], v[96:99], v[16:23], v7
    s_lshl_b32 s65, s33, 10
    s_add_u32 s65, s65, 32768
    ds_read_b128 v[92:95], v6 offset:41600
    v_exp_f32 v26, v26
    v_exp_f32 v27, v27
    v_exp_f32 v28, v28
    v_exp_f32 v29, v29
    v_exp_f32 v30, v30
    v_exp_f32 v31, v31
    v_exp_f32 v32, v32
    v_exp_f32 v33, v33
    v_smfmac_f32_32x32x32_bf16 v[48:63], v[100:103], v[24:31], v7
    buffer_load_dword v107, v111, s[4:7], s67 offen
    buffer_load_dword v104, v111, s[8:11], s65 offen sc1
    v_exp_f32 v34, v34
    v_exp_f32 v35, v35
    v_exp_f32 v36, v36
    v_mfma_f32_32x32x16_bf16 v[16:31], v[80:83], v[8:11], 0
    ds_read_b128 v[84:87], v4 offset:43680
    v_exp_f32 v37, v37
    v_exp_f32 v38, v38
    v_exp_f32 v39, v39
    v_exp_f32 v40, v40
    v_exp_f32 v41, v41
    v_smfmac_f32_32x32x32_bf16 v[64:79], v[96:99], v[32:39], v7
    v_exp_f32 v42, v42
    v_exp_f32 v43, v43
    v_exp_f32 v44, v44
    v_exp_f32 v45, v45
    v_exp_f32 v46, v46
    v_exp_f32 v47, v47
    v_exp_f32 v16, v16
    v_exp_f32 v17, v17
    v_smfmac_f32_32x32x32_bf16 v[64:79], v[100:103], v[40:47], v7
    s_waitcnt lgkmcnt(0)
    buffer_load_dword v105, v111, s[24:27], s57 offen sc1
    buffer_load_dword v106, v111, s[8:11], s63 offen sc1
    v_exp_f32 v18, v18
    v_exp_f32 v19, v19
    v_exp_f32 v20, v20
    v_mfma_f32_32x32x16_bf16 v[32:47], v[80:83], v[12:15], 0
    ds_read_b128 v[96:99], v5 offset:43680
    v_exp_f32 v21, v21
    v_exp_f32 v22, v22
    v_exp_f32 v23, v23
    v_exp_f32 v24, v24
    v_exp_f32 v25, v25
    v_smfmac_f32_32x32x32_bf16 v[48:63], v[88:91], v[16:23], v7
    ds_read_b128 v[100:103], v6 offset:43680
    v_exp_f32 v26, v26
    v_exp_f32 v27, v27
    v_exp_f32 v28, v28
    v_exp_f32 v29, v29
    v_exp_f32 v30, v30
    v_exp_f32 v31, v31
    v_exp_f32 v32, v32
    v_exp_f32 v33, v33
    v_smfmac_f32_32x32x32_bf16 v[48:63], v[92:95], v[24:31], v7
    v_exp_f32 v34, v34
    v_exp_f32 v35, v35
    v_exp_f32 v36, v36
    v_mfma_f32_32x32x16_bf16 v[16:31], v[84:87], v[8:11], 0
    ds_read_b128 v[80:83], v4 offset:45760
    v_exp_f32 v37, v37
    v_exp_f32 v38, v38
    v_exp_f32 v39, v39
    v_exp_f32 v40, v40
    v_exp_f32 v41, v41
    v_smfmac_f32_32x32x32_bf16 v[64:79], v[88:91], v[32:39], v7
    v_exp_f32 v42, v42
    v_exp_f32 v43, v43
    v_exp_f32 v44, v44
    v_exp_f32 v45, v45
    v_exp_f32 v46, v46
    v_exp_f32 v47, v47
    v_exp_f32 v16, v16
    v_exp_f32 v17, v17
    v_smfmac_f32_32x32x32_bf16 v[64:79], v[92:95], v[40:47], v7
    s_waitcnt lgkmcnt(0)
    v_exp_f32 v18, v18
    v_exp_f32 v19, v19
    v_exp_f32 v20, v20
    v_mfma_f32_32x32x16_bf16 v[32:47], v[84:87], v[12:15], 0
    ds_read_b128 v[88:91], v5 offset:45760
    v_exp_f32 v21, v21
    v_exp_f32 v22, v22
    v_exp_f32 v23, v23
    v_exp_f32 v24, v24
    v_exp_f32 v25, v25
    v_smfmac_f32_32x32x32_bf16 v[48:63], v[96:99], v[16:23], v7
    ds_read_b128 v[92:95], v6 offset:45760
    v_exp_f32 v26, v26
    v_exp_f32 v27, v27
    v_exp_f32 v28, v28
    v_exp_f32 v29, v29
    v_exp_f32 v30, v30
    v_exp_f32 v31, v31
    v_exp_f32 v32, v32
    v_exp_f32 v33, v33
    v_smfmac_f32_32x32x32_bf16 v[48:63], v[100:103], v[24:31], v7
    v_exp_f32 v34, v34
    v_exp_f32 v35, v35
    v_exp_f32 v36, v36
    v_mfma_f32_32x32x16_bf16 v[16:31], v[80:83], v[8:11], 0
    ds_read_b128 v[84:87], v4 offset:47840
    v_exp_f32 v37, v37
    v_exp_f32 v38, v38
    v_exp_f32 v39, v39
    v_exp_f32 v40, v40
    v_exp_f32 v41, v41
    v_smfmac_f32_32x32x32_bf16 v[64:79], v[96:99], v[32:39], v7
    v_exp_f32 v42, v42
    v_exp_f32 v43, v43
    v_exp_f32 v44, v44
    v_exp_f32 v45, v45
    v_exp_f32 v46, v46
    v_exp_f32 v47, v47
    v_exp_f32 v16, v16
    v_exp_f32 v17, v17
    v_smfmac_f32_32x32x32_bf16 v[64:79], v[100:103], v[40:47], v7
    s_waitcnt lgkmcnt(0)
    v_exp_f32 v18, v18
    v_exp_f32 v19, v19
    v_exp_f32 v20, v20
    v_mfma_f32_32x32x16_bf16 v[32:47], v[80:83], v[12:15], 0
    ds_read_b128 v[96:99], v5 offset:47840
    v_exp_f32 v21, v21
    v_exp_f32 v22, v22
    v_exp_f32 v23, v23
    v_exp_f32 v24, v24
    v_exp_f32 v25, v25
    v_smfmac_f32_32x32x32_bf16 v[48:63], v[88:91], v[16:23], v7
    ds_read_b128 v[100:103], v6 offset:47840
    v_exp_f32 v26, v26
    v_exp_f32 v27, v27
    v_exp_f32 v28, v28
    v_exp_f32 v29, v29
    v_exp_f32 v30, v30
    v_exp_f32 v31, v31
    v_exp_f32 v32, v32
    v_exp_f32 v33, v33
    v_smfmac_f32_32x32x32_bf16 v[48:63], v[92:95], v[24:31], v7
    v_exp_f32 v34, v34
    v_exp_f32 v35, v35
    v_exp_f32 v36, v36
    v_mfma_f32_32x32x16_bf16 v[16:31], v[84:87], v[8:11], 0
    ds_read_b128 v[80:83], v4 offset:49920
    v_exp_f32 v37, v37
    v_exp_f32 v38, v38
    v_exp_f32 v39, v39
    v_exp_f32 v40, v40
    v_exp_f32 v41, v41
    v_smfmac_f32_32x32x32_bf16 v[64:79], v[88:91], v[32:39], v7
    v_exp_f32 v42, v42
    v_exp_f32 v43, v43
    v_exp_f32 v44, v44
    v_exp_f32 v45, v45
    v_exp_f32 v46, v46
    v_exp_f32 v47, v47
    v_exp_f32 v16, v16
    v_exp_f32 v17, v17
    v_smfmac_f32_32x32x32_bf16 v[64:79], v[92:95], v[40:47], v7
    s_waitcnt lgkmcnt(0)
    v_exp_f32 v18, v18
    v_exp_f32 v19, v19
    v_exp_f32 v20, v20
    v_mfma_f32_32x32x16_bf16 v[32:47], v[84:87], v[12:15], 0
    ds_read_b128 v[88:91], v5 offset:49920
    v_exp_f32 v21, v21
    v_exp_f32 v22, v22
    v_exp_f32 v23, v23
    v_exp_f32 v24, v24
    v_exp_f32 v25, v25
    v_smfmac_f32_32x32x32_bf16 v[48:63], v[96:99], v[16:23], v7
    ds_read_b128 v[92:95], v6 offset:49920
    v_exp_f32 v26, v26
    v_exp_f32 v27, v27
    v_exp_f32 v28, v28
    v_exp_f32 v29, v29
    v_exp_f32 v30, v30
    v_exp_f32 v31, v31
    v_exp_f32 v32, v32
    v_exp_f32 v33, v33
    v_smfmac_f32_32x32x32_bf16 v[48:63], v[100:103], v[24:31], v7
    v_exp_f32 v34, v34
    v_exp_f32 v35, v35
    v_exp_f32 v36, v36
    v_mfma_f32_32x32x16_bf16 v[16:31], v[80:83], v[8:11], 0
    ds_read_b128 v[84:87], v4 offset:52000
    v_exp_f32 v37, v37
    v_exp_f32 v38, v38
    v_exp_f32 v39, v39
    v_exp_f32 v40, v40
    v_exp_f32 v41, v41
    v_smfmac_f32_32x32x32_bf16 v[64:79], v[96:99], v[32:39], v7
    v_exp_f32 v42, v42
    v_exp_f32 v43, v43
    v_exp_f32 v44, v44
    v_exp_f32 v45, v45
    v_exp_f32 v46, v46
    v_exp_f32 v47, v47
    v_exp_f32 v16, v16
    v_exp_f32 v17, v17
    v_smfmac_f32_32x32x32_bf16 v[64:79], v[100:103], v[40:47], v7
    s_waitcnt lgkmcnt(0)
    v_exp_f32 v18, v18
    v_exp_f32 v19, v19
    v_exp_f32 v20, v20
    v_mfma_f32_32x32x16_bf16 v[32:47], v[80:83], v[12:15], 0
    ds_read_b128 v[96:99], v5 offset:52000
    v_exp_f32 v21, v21
    v_exp_f32 v22, v22
    v_exp_f32 v23, v23
    v_exp_f32 v24, v24
    v_exp_f32 v25, v25
    v_smfmac_f32_32x32x32_bf16 v[48:63], v[88:91], v[16:23], v7
    ds_read_b128 v[100:103], v6 offset:52000
    v_exp_f32 v26, v26
    v_exp_f32 v27, v27
    v_exp_f32 v28, v28
    v_exp_f32 v29, v29
    v_exp_f32 v30, v30
    v_exp_f32 v31, v31
    v_exp_f32 v32, v32
    v_exp_f32 v33, v33
    v_smfmac_f32_32x32x32_bf16 v[48:63], v[92:95], v[24:31], v7
    v_exp_f32 v34, v34
    v_exp_f32 v35, v35
    v_exp_f32 v36, v36
    v_mfma_f32_32x32x16_bf16 v[16:31], v[84:87], v[8:11], 0
    ds_read_b128 v[80:83], v4 offset:54080
    v_exp_f32 v37, v37
    v_exp_f32 v38, v38
    v_exp_f32 v39, v39
    v_exp_f32 v40, v40
    v_exp_f32 v41, v41
    v_smfmac_f32_32x32x32_bf16 v[64:79], v[88:91], v[32:39], v7
    v_exp_f32 v42, v42
    v_exp_f32 v43, v43
    v_exp_f32 v44, v44
    v_exp_f32 v45, v45
    v_exp_f32 v46, v46
    v_exp_f32 v47, v47
    v_exp_f32 v16, v16
    v_exp_f32 v17, v17
    v_smfmac_f32_32x32x32_bf16 v[64:79], v[92:95], v[40:47], v7
    s_waitcnt lgkmcnt(0)
    v_exp_f32 v18, v18
    v_exp_f32 v19, v19
    v_exp_f32 v20, v20
    v_mfma_f32_32x32x16_bf16 v[32:47], v[84:87], v[12:15], 0
    ds_read_b128 v[88:91], v5 offset:54080
    v_exp_f32 v21, v21
    v_exp_f32 v22, v22
    v_exp_f32 v23, v23
    v_exp_f32 v24, v24
    v_exp_f32 v25, v25
    v_smfmac_f32_32x32x32_bf16 v[48:63], v[96:99], v[16:23], v7
    ds_read_b128 v[92:95], v6 offset:54080
    v_exp_f32 v26, v26
    v_exp_f32 v27, v27
    v_exp_f32 v28, v28
    v_exp_f32 v29, v29
    v_exp_f32 v30, v30
    v_exp_f32 v31, v31
    v_exp_f32 v32, v32
    v_exp_f32 v33, v33
    v_smfmac_f32_32x32x32_bf16 v[48:63], v[100:103], v[24:31], v7
    v_exp_f32 v34, v34
    v_exp_f32 v35, v35
    v_exp_f32 v36, v36
    v_mfma_f32_32x32x16_bf16 v[16:31], v[80:83], v[8:11], 0
    ds_read_b128 v[84:87], v4 offset:56160
    v_exp_f32 v37, v37
    v_exp_f32 v38, v38
    v_exp_f32 v39, v39
    v_exp_f32 v40, v40
    v_exp_f32 v41, v41
    v_smfmac_f32_32x32x32_bf16 v[64:79], v[96:99], v[32:39], v7
    v_exp_f32 v42, v42
    v_exp_f32 v43, v43
    v_exp_f32 v44, v44
    v_exp_f32 v45, v45
    v_exp_f32 v46, v46
    v_exp_f32 v47, v47
    v_exp_f32 v16, v16
    v_exp_f32 v17, v17
    v_smfmac_f32_32x32x32_bf16 v[64:79], v[100:103], v[40:47], v7
    s_waitcnt lgkmcnt(0)
    v_exp_f32 v18, v18
    v_exp_f32 v19, v19
    v_exp_f32 v20, v20
    v_mfma_f32_32x32x16_bf16 v[32:47], v[80:83], v[12:15], 0
    ds_read_b128 v[96:99], v5 offset:56160
    v_exp_f32 v21, v21
    v_exp_f32 v22, v22
    v_exp_f32 v23, v23
    v_exp_f32 v24, v24
    v_exp_f32 v25, v25
    v_smfmac_f32_32x32x32_bf16 v[48:63], v[88:91], v[16:23], v7
    ds_read_b128 v[100:103], v6 offset:56160
    v_exp_f32 v26, v26
    v_exp_f32 v27, v27
    v_exp_f32 v28, v28
    v_exp_f32 v29, v29
    v_exp_f32 v30, v30
    v_exp_f32 v31, v31
    v_exp_f32 v32, v32
    v_exp_f32 v33, v33
    v_smfmac_f32_32x32x32_bf16 v[48:63], v[92:95], v[24:31], v7
    v_exp_f32 v34, v34
    v_exp_f32 v35, v35
    v_exp_f32 v36, v36
    v_mfma_f32_32x32x16_bf16 v[16:31], v[84:87], v[8:11], 0
    ds_read_b128 v[80:83], v4 offset:58240
    v_exp_f32 v37, v37
    v_exp_f32 v38, v38
    v_exp_f32 v39, v39
    v_exp_f32 v40, v40
    v_exp_f32 v41, v41
    v_smfmac_f32_32x32x32_bf16 v[64:79], v[88:91], v[32:39], v7
    v_exp_f32 v42, v42
    v_exp_f32 v43, v43
    v_exp_f32 v44, v44
    v_exp_f32 v45, v45
    v_exp_f32 v46, v46
    v_exp_f32 v47, v47
    v_exp_f32 v16, v16
    v_exp_f32 v17, v17
    v_smfmac_f32_32x32x32_bf16 v[64:79], v[92:95], v[40:47], v7
    s_waitcnt lgkmcnt(0)
    v_exp_f32 v18, v18
    v_exp_f32 v19, v19
    v_exp_f32 v20, v20
    v_mfma_f32_32x32x16_bf16 v[32:47], v[84:87], v[12:15], 0
    ds_read_b128 v[88:91], v5 offset:58240
    v_exp_f32 v21, v21
    v_exp_f32 v22, v22
    v_exp_f32 v23, v23
    v_exp_f32 v24, v24
    v_exp_f32 v25, v25
    v_smfmac_f32_32x32x32_bf16 v[48:63], v[96:99], v[16:23], v7
    ds_read_b128 v[92:95], v6 offset:58240
    v_exp_f32 v26, v26
    v_exp_f32 v27, v27
    v_exp_f32 v28, v28
    v_exp_f32 v29, v29
    v_exp_f32 v30, v30
    v_exp_f32 v31, v31
    v_exp_f32 v32, v32
    v_exp_f32 v33, v33
    v_smfmac_f32_32x32x32_bf16 v[48:63], v[100:103], v[24:31], v7
    v_exp_f32 v34, v34
    v_exp_f32 v35, v35
    v_exp_f32 v36, v36
    v_mfma_f32_32x32x16_bf16 v[16:31], v[80:83], v[8:11], 0
    ds_read_b128 v[84:87], v4 offset:60320
    v_exp_f32 v37, v37
    v_exp_f32 v38, v38
    v_exp_f32 v39, v39
    v_exp_f32 v40, v40
    v_exp_f32 v41, v41
    v_smfmac_f32_32x32x32_bf16 v[64:79], v[96:99], v[32:39], v7
    v_exp_f32 v42, v42
    v_exp_f32 v43, v43
    v_exp_f32 v44, v44
    v_exp_f32 v45, v45
    v_exp_f32 v46, v46
    v_exp_f32 v47, v47
    v_add_u32 v4, 58240, v4
    v_add_u32 v5, 58240, v5
    v_add_u32 v6, 58240, v6
    v_exp_f32 v16, v16
    v_exp_f32 v17, v17
    v_smfmac_f32_32x32x32_bf16 v[64:79], v[100:103], v[40:47], v7
    s_waitcnt lgkmcnt(0)
    v_exp_f32 v18, v18
    v_exp_f32 v19, v19
    v_exp_f32 v20, v20
    v_mfma_f32_32x32x16_bf16 v[32:47], v[80:83], v[12:15], 0
    ds_read_b128 v[96:99], v5 offset:2080
    v_exp_f32 v21, v21
    v_exp_f32 v22, v22
    v_exp_f32 v23, v23
    v_exp_f32 v24, v24
    v_exp_f32 v25, v25
    v_smfmac_f32_32x32x32_bf16 v[48:63], v[88:91], v[16:23], v7
    ds_read_b128 v[100:103], v6 offset:2080
    v_exp_f32 v26, v26
    v_exp_f32 v27, v27
    v_exp_f32 v28, v28
    v_exp_f32 v29, v29
    v_exp_f32 v30, v30
    v_exp_f32 v31, v31
    v_exp_f32 v32, v32
    v_exp_f32 v33, v33
    v_smfmac_f32_32x32x32_bf16 v[48:63], v[92:95], v[24:31], v7
    v_exp_f32 v34, v34
    v_exp_f32 v35, v35
    v_exp_f32 v36, v36
    v_mfma_f32_32x32x16_bf16 v[16:31], v[84:87], v[8:11], 0
    ds_read_b128 v[80:83], v4 offset:4160
    v_exp_f32 v37, v37
    v_exp_f32 v38, v38
    v_exp_f32 v39, v39
    v_exp_f32 v40, v40
    v_exp_f32 v41, v41
    v_smfmac_f32_32x32x32_bf16 v[64:79], v[88:91], v[32:39], v7
    v_exp_f32 v42, v42
    v_exp_f32 v43, v43
    v_exp_f32 v44, v44
    v_exp_f32 v45, v45
    v_exp_f32 v46, v46
    v_exp_f32 v47, v47
    v_exp_f32 v16, v16
    v_exp_f32 v17, v17
    v_smfmac_f32_32x32x32_bf16 v[64:79], v[92:95], v[40:47], v7
    s_waitcnt lgkmcnt(0)
    v_exp_f32 v18, v18
    v_exp_f32 v19, v19
    v_exp_f32 v20, v20
    v_mfma_f32_32x32x16_bf16 v[32:47], v[84:87], v[12:15], 0
    ds_read_b128 v[88:91], v5 offset:4160
    v_exp_f32 v21, v21
    v_exp_f32 v22, v22
    v_exp_f32 v23, v23
    v_exp_f32 v24, v24
    v_exp_f32 v25, v25
    v_smfmac_f32_32x32x32_bf16 v[48:63], v[96:99], v[16:23], v7
    ds_read_b128 v[92:95], v6 offset:4160
    v_exp_f32 v26, v26
    v_exp_f32 v27, v27
    v_exp_f32 v28, v28
    v_exp_f32 v29, v29
    v_exp_f32 v30, v30
    v_exp_f32 v31, v31
    v_exp_f32 v32, v32
    v_exp_f32 v33, v33
    v_smfmac_f32_32x32x32_bf16 v[48:63], v[100:103], v[24:31], v7
    buffer_load_dword v120, v127, s[4:7], s64 offen
    v_exp_f32 v34, v34
    v_exp_f32 v35, v35
    v_exp_f32 v36, v36
    v_mfma_f32_32x32x16_bf16 v[16:31], v[80:83], v[8:11], 0
    ds_read_b128 v[84:87], v4 offset:6240
    v_exp_f32 v37, v37
    v_exp_f32 v38, v38
    v_exp_f32 v39, v39
    v_exp_f32 v40, v40
    v_exp_f32 v41, v41
    v_smfmac_f32_32x32x32_bf16 v[64:79], v[96:99], v[32:39], v7
    v_exp_f32 v42, v42
    v_exp_f32 v43, v43
    v_exp_f32 v44, v44
    v_exp_f32 v45, v45
    v_exp_f32 v46, v46
    v_exp_f32 v47, v47
    v_exp_f32 v16, v16
    v_exp_f32 v17, v17
    v_smfmac_f32_32x32x32_bf16 v[64:79], v[100:103], v[40:47], v7
    s_waitcnt lgkmcnt(0)
    s_waitcnt vmcnt(23)
    s_barrier
    buffer_load_dword v121, v127, s[4:7], s66 offen
    v_exp_f32 v18, v18
    v_exp_f32 v19, v19
    v_exp_f32 v20, v20
    v_mfma_f32_32x32x16_bf16 v[32:47], v[80:83], v[12:15], 0
    ds_read_b128 v[96:99], v5 offset:6240
    v_exp_f32 v21, v21
    v_exp_f32 v22, v22
    v_exp_f32 v23, v23
    v_exp_f32 v24, v24
    v_exp_f32 v25, v25
    v_smfmac_f32_32x32x32_bf16 v[48:63], v[88:91], v[16:23], v7
    ds_read_b128 v[100:103], v6 offset:6240
    v_exp_f32 v26, v26
    v_exp_f32 v27, v27
    v_exp_f32 v28, v28
    v_exp_f32 v29, v29
    v_exp_f32 v30, v30
    v_exp_f32 v31, v31
    v_exp_f32 v32, v32
    v_exp_f32 v33, v33
    v_smfmac_f32_32x32x32_bf16 v[48:63], v[92:95], v[24:31], v7
    v_exp_f32 v34, v34
    v_exp_f32 v35, v35
    v_exp_f32 v36, v36
    v_mfma_f32_32x32x16_bf16 v[16:31], v[84:87], v[8:11], 0
    ds_read_b128 v[80:83], v4 offset:8320
    v_exp_f32 v37, v37
    v_exp_f32 v38, v38
    v_exp_f32 v39, v39
    v_exp_f32 v40, v40
    v_exp_f32 v41, v41
    v_smfmac_f32_32x32x32_bf16 v[64:79], v[88:91], v[32:39], v7
    v_exp_f32 v42, v42
    v_exp_f32 v43, v43
    v_exp_f32 v44, v44
    v_exp_f32 v45, v45
    v_exp_f32 v46, v46
    v_exp_f32 v47, v47
    v_exp_f32 v16, v16
    v_exp_f32 v17, v17
    v_smfmac_f32_32x32x32_bf16 v[64:79], v[92:95], v[40:47], v7
    s_waitcnt lgkmcnt(0)
    v_exp_f32 v18, v18
    v_exp_f32 v19, v19
    v_exp_f32 v20, v20
    v_mfma_f32_32x32x16_bf16 v[32:47], v[84:87], v[12:15], 0
    ds_read_b128 v[88:91], v5 offset:8320
    v_exp_f32 v21, v21
    v_exp_f32 v22, v22
    v_exp_f32 v23, v23
    v_exp_f32 v24, v24
    v_exp_f32 v25, v25
    v_smfmac_f32_32x32x32_bf16 v[48:63], v[96:99], v[16:23], v7
    ds_read_b128 v[92:95], v6 offset:8320
    v_exp_f32 v26, v26
    v_exp_f32 v27, v27
    v_exp_f32 v28, v28
    v_exp_f32 v29, v29
    v_exp_f32 v30, v30
    v_exp_f32 v31, v31
    v_exp_f32 v32, v32
    v_exp_f32 v33, v33
    v_smfmac_f32_32x32x32_bf16 v[48:63], v[100:103], v[24:31], v7
    v_exp_f32 v34, v34
    v_exp_f32 v35, v35
    v_exp_f32 v36, v36
    v_mfma_f32_32x32x16_bf16 v[16:31], v[80:83], v[8:11], 0
    ds_read_b128 v[84:87], v4 offset:10400
    v_exp_f32 v37, v37
    v_exp_f32 v38, v38
    v_exp_f32 v39, v39
    v_exp_f32 v40, v40
    v_exp_f32 v41, v41
    v_smfmac_f32_32x32x32_bf16 v[64:79], v[96:99], v[32:39], v7
    v_exp_f32 v42, v42
    v_exp_f32 v43, v43
    v_exp_f32 v44, v44
    v_exp_f32 v45, v45
    v_exp_f32 v46, v46
    v_exp_f32 v47, v47
    v_exp_f32 v16, v16
    v_exp_f32 v17, v17
    v_smfmac_f32_32x32x32_bf16 v[64:79], v[100:103], v[40:47], v7
    s_waitcnt lgkmcnt(0)
    v_exp_f32 v18, v18
    v_exp_f32 v19, v19
    v_exp_f32 v20, v20
    v_mfma_f32_32x32x16_bf16 v[32:47], v[80:83], v[12:15], 0
    ds_read_b128 v[96:99], v5 offset:10400
    v_exp_f32 v21, v21
    v_exp_f32 v22, v22
    v_exp_f32 v23, v23
    v_exp_f32 v24, v24
    v_exp_f32 v25, v25
    v_smfmac_f32_32x32x32_bf16 v[48:63], v[88:91], v[16:23], v7
    ds_read_b128 v[100:103], v6 offset:10400
    v_exp_f32 v26, v26
    v_exp_f32 v27, v27
    v_exp_f32 v28, v28
    v_exp_f32 v29, v29
    v_exp_f32 v30, v30
    v_exp_f32 v31, v31
    v_exp_f32 v32, v32
    v_exp_f32 v33, v33
    v_smfmac_f32_32x32x32_bf16 v[48:63], v[92:95], v[24:31], v7
    v_exp_f32 v34, v34
    v_exp_f32 v35, v35
    v_exp_f32 v36, v36
    v_mfma_f32_32x32x16_bf16 v[16:31], v[84:87], v[8:11], 0
    ds_read_b128 v[80:83], v4 offset:12480
    v_exp_f32 v37, v37
    v_exp_f32 v38, v38
    v_exp_f32 v39, v39
    v_exp_f32 v40, v40
    v_exp_f32 v41, v41
    v_smfmac_f32_32x32x32_bf16 v[64:79], v[88:91], v[32:39], v7
    v_exp_f32 v42, v42
    v_exp_f32 v43, v43
    v_exp_f32 v44, v44
    v_exp_f32 v45, v45
    v_exp_f32 v46, v46
    v_exp_f32 v47, v47
    v_exp_f32 v16, v16
    v_exp_f32 v17, v17
    v_smfmac_f32_32x32x32_bf16 v[64:79], v[92:95], v[40:47], v7
    s_waitcnt lgkmcnt(0)
    v_exp_f32 v18, v18
    v_exp_f32 v19, v19
    v_exp_f32 v20, v20
    v_mfma_f32_32x32x16_bf16 v[32:47], v[84:87], v[12:15], 0
    ds_read_b128 v[88:91], v5 offset:12480
    v_exp_f32 v21, v21
    v_exp_f32 v22, v22
    v_exp_f32 v23, v23
    v_exp_f32 v24, v24
    v_exp_f32 v25, v25
    v_smfmac_f32_32x32x32_bf16 v[48:63], v[96:99], v[16:23], v7
    ds_read_b128 v[92:95], v6 offset:12480
    v_exp_f32 v26, v26
    v_exp_f32 v27, v27
    v_exp_f32 v28, v28
    v_exp_f32 v29, v29
    v_exp_f32 v30, v30
    v_exp_f32 v31, v31
    v_exp_f32 v32, v32
    v_exp_f32 v33, v33
    v_smfmac_f32_32x32x32_bf16 v[48:63], v[100:103], v[24:31], v7
    v_exp_f32 v34, v34
    v_exp_f32 v35, v35
    v_exp_f32 v36, v36
    v_mfma_f32_32x32x16_bf16 v[16:31], v[80:83], v[8:11], 0
    ds_read_b128 v[84:87], v4 offset:14560
    v_exp_f32 v37, v37
    v_exp_f32 v38, v38
    v_exp_f32 v39, v39
    v_exp_f32 v40, v40
    v_exp_f32 v41, v41
    v_smfmac_f32_32x32x32_bf16 v[64:79], v[96:99], v[32:39], v7
    v_exp_f32 v42, v42
    v_exp_f32 v43, v43
    v_exp_f32 v44, v44
    v_exp_f32 v45, v45
    v_exp_f32 v46, v46
    v_exp_f32 v47, v47
    v_exp_f32 v16, v16
    v_exp_f32 v17, v17
    v_smfmac_f32_32x32x32_bf16 v[64:79], v[100:103], v[40:47], v7
    s_waitcnt lgkmcnt(0)
    v_exp_f32 v18, v18
    v_exp_f32 v19, v19
    v_exp_f32 v20, v20
    v_mfma_f32_32x32x16_bf16 v[32:47], v[80:83], v[12:15], 0
    ds_read_b128 v[96:99], v5 offset:14560
    v_exp_f32 v21, v21
    v_exp_f32 v22, v22
    v_exp_f32 v23, v23
    v_exp_f32 v24, v24
    v_exp_f32 v25, v25
    v_smfmac_f32_32x32x32_bf16 v[48:63], v[88:91], v[16:23], v7
    ds_read_b128 v[100:103], v6 offset:14560
    v_exp_f32 v26, v26
    v_exp_f32 v27, v27
    v_exp_f32 v28, v28
    v_exp_f32 v29, v29
    v_exp_f32 v30, v30
    v_exp_f32 v31, v31
    v_exp_f32 v32, v32
    v_exp_f32 v33, v33
    v_smfmac_f32_32x32x32_bf16 v[48:63], v[92:95], v[24:31], v7
    v_exp_f32 v34, v34
    v_exp_f32 v35, v35
    v_exp_f32 v36, v36
    v_mfma_f32_32x32x16_bf16 v[16:31], v[84:87], v[8:11], 0
    v_exp_f32 v37, v37
    v_exp_f32 v38, v38
    v_exp_f32 v39, v39
    v_exp_f32 v40, v40
    v_exp_f32 v41, v41
    v_smfmac_f32_32x32x32_bf16 v[64:79], v[88:91], v[32:39], v7
    v_exp_f32 v42, v42
    v_exp_f32 v43, v43
    v_exp_f32 v44, v44
    v_exp_f32 v45, v45
    v_exp_f32 v46, v46
    v_exp_f32 v47, v47
    v_exp_f32 v16, v16
    v_exp_f32 v17, v17
    v_smfmac_f32_32x32x32_bf16 v[64:79], v[92:95], v[40:47], v7
    s_waitcnt lgkmcnt(0)
    v_exp_f32 v18, v18
    v_exp_f32 v19, v19
    v_exp_f32 v20, v20
    v_mfma_f32_32x32x16_bf16 v[32:47], v[84:87], v[12:15], 0
    v_exp_f32 v21, v21
    v_exp_f32 v22, v22
    v_exp_f32 v23, v23
    v_exp_f32 v24, v24
    v_exp_f32 v25, v25
    v_smfmac_f32_32x32x32_bf16 v[48:63], v[96:99], v[16:23], v7
    v_exp_f32 v26, v26
    v_exp_f32 v27, v27
    v_exp_f32 v28, v28
    v_exp_f32 v29, v29
    v_exp_f32 v30, v30
    v_exp_f32 v31, v31
    v_exp_f32 v32, v32
    v_exp_f32 v33, v33
    v_smfmac_f32_32x32x32_bf16 v[48:63], v[100:103], v[24:31], v7
    v_exp_f32 v34, v34
    v_exp_f32 v35, v35
    v_exp_f32 v36, v36
    v_exp_f32 v37, v37
    v_exp_f32 v38, v38
    v_exp_f32 v39, v39
    v_exp_f32 v40, v40
    v_exp_f32 v41, v41
    v_smfmac_f32_32x32x32_bf16 v[64:79], v[96:99], v[32:39], v7
    v_exp_f32 v42, v42
    v_exp_f32 v43, v43
    v_exp_f32 v44, v44
    v_exp_f32 v45, v45
    v_exp_f32 v46, v46
    v_exp_f32 v47, v47
    s_lshl_b32 s46, s33, 10
    s_lshl_b32 s47, s34, 2
    v_smfmac_f32_32x32x32_bf16 v[64:79], v[100:103], v[40:47], v7
L_post:
    s_add_u32 s46, s46, 32768
    s_add_u32 s47, s47, s32
    s_lshl_b32 s47, s47, 2
    s_add_u32 s47, s47, s46
    s_lshl_b32 s48, s36, 5
    s_lshl_b32 s49, s34, 2
    s_add_u32 s48, s48, s49
    s_lshl_b32 s49, s37, 1
    s_add_u32 s48, s48, s49
    s_lshl_b32 s48, s48, 10
    s_add_u32 s49, s48, s62
    s_mov_b32 s40, 0
L_attn_ok:
    v_rcp_f32 v58, v56
    s_mov_b32 s50, 0x7b800000
    v_pk_mul_f32 v[48:49], v[48:49], v[58:59] op_sel_hi:[1,0]
    v_pk_mul_f32 v[50:51], v[50:51], v[58:59] op_sel_hi:[1,0]
    v_pk_mul_f32 v[52:53], v[52:53], v[58:59] op_sel_hi:[1,0]
    v_pk_mul_f32 v[54:55], v[54:55], v[58:59] op_sel_hi:[1,0]
    s_waitcnt vmcnt(1)
    v_cvt_pk_bf16_f32 v120, v48, v49
    s_waitcnt vmcnt(0)
    v_cvt_pk_bf16_f32 v121, v50, v51
    v_cvt_pk_bf16_f32 v122, v52, v53
    v_cvt_pk_bf16_f32 v123, v54, v55
    buffer_store_dwordx4 v[120:123], v2, s[68:71], s49 offen offset:0
    buffer_store_dwordx4 v[120:123], v2, s[72:75], s49 offen offset:0 sc1
    v_rcp_f32 v74, v72
    s_mov_b32 s51, 0x12800000
    v_pk_mul_f32 v[64:65], v[64:65], v[74:75] op_sel_hi:[1,0]
    v_pk_mul_f32 v[66:67], v[66:67], v[74:75] op_sel_hi:[1,0]
    v_pk_mul_f32 v[68:69], v[68:69], v[74:75] op_sel_hi:[1,0]
    v_pk_mul_f32 v[70:71], v[70:71], v[74:75] op_sel_hi:[1,0]
    v_cvt_pk_bf16_f32 v124, v64, v65
    v_cvt_pk_bf16_f32 v125, v66, v67
    v_cvt_pk_bf16_f32 v126, v68, v69
    v_cvt_pk_bf16_f32 v127, v70, v71
    buffer_store_dwordx4 v[124:127], v2, s[68:71], s49 offen offset:1024
    buffer_store_dwordx4 v[124:127], v2, s[72:75], s49 offen offset:1024 sc1
    v_add_f32 v104, abs(v48), v56
    v_add_f32 v104, abs(v49), v104
    v_add_f32 v104, abs(v50), v104
    v_add_f32 v104, abs(v51), v104
    v_add_f32 v104, abs(v52), v104
    v_add_f32 v104, abs(v53), v104
    v_add_f32 v104, abs(v54), v104
    v_add_f32 v104, abs(v55), v104
    v_add_f32 v105, abs(v64), v72
    v_add_f32 v105, abs(v65), v105
    v_add_f32 v105, abs(v66), v105
    v_add_f32 v105, abs(v67), v105
    v_add_f32 v105, abs(v68), v105
    v_add_f32 v105, abs(v69), v105
    v_add_f32 v105, abs(v70), v105
    v_add_f32 v105, abs(v71), v105
    v_add_f32 v104, v104, v105
    v_min_f32 v105, v56, v72
    v_cmp_nge_f32 vcc, s50, v104
    v_cmp_nle_f32 s[38:39], s51, v105
    s_nop 0
    s_or_b64 vcc, vcc, s[38:39]
    s_cbranch_vccnz L_fallback
L_attn_done:
    v_mov_b32 v7, s35
    s_lshl_b32 s38, s37, 15
    v_lshrrev_b32 v4, 5, v1
    v_bfe_u32 v5, v1, 2, 2
    v_lshl_add_u32 v4, v4, 2, v5
    v_lshrrev_b32 v5, 1, v5
    v_xor_b32 v5, s37, v5
    v_lshl_add_u32 v4, v4, 1, v5
    v_bfe_u32 v5, v1, 4, 1
    v_lshl_add_u32 v4, v4, 1, v5
    v_and_b32 v5, 3, v1
    v_lshl_add_u32 v4, v4, 2, v5
    v_lshlrev_b32 v4, 3, v4
    v_add_u32 v4, s38, v4
    v_xor_b32 v5, 64, v4
    v_lshrrev_b32 v6, 5, v1
    v_lshlrev_b32 v6, 4, v6
    s_lshl_b32 s38, s37, 7
    s_add_u32 s38, s38, 137216
    v_add_u32 v6, s38, v6
    v_lshlrev_b32 v104, 1, v3
    s_lshl_b32 s38, s37, 4
    s_add_u32 s38, s38, s36
    s_lshl_b32 s38, s38, 2
    s_add_u32 s38, s38, s46
    s_lshl_b32 s39, s36, 15
    s_lshl_b32 s40, s37, 14
    s_add_u32 s39, s39, s40
    s_add_u32 s39, s39, s62
    ds_read_b64_tr_b16 v[8:9], v4 offset:0
    ds_read_b64_tr_b16 v[10:11], v4 offset:1024
    ds_read_b64_tr_b16 v[12:13], v5 offset:0
    ds_read_b64_tr_b16 v[14:15], v5 offset:1024
    ds_read_b64_tr_b16 v[120:121], v4 offset:2048
    ds_read_b64_tr_b16 v[122:123], v4 offset:3072
    ds_read_b64_tr_b16 v[124:125], v5 offset:2048
    ds_read_b64_tr_b16 v[126:127], v5 offset:3072
    s_waitcnt vmcnt(0)
    buffer_store_dword v7, off, s[12:15], s47 offset:0
    buffer_store_dword v7, off, s[16:19], s47 offset:0 sc1
    s_mov_b32 s3, 0
L_spin_9:
    buffer_load_dword v105, v104, s[8:11], s38 offen sc1
    s_waitcnt vmcnt(0)
    v_cmp_ne_u32 vcc, v7, v105
    s_nop 0
    s_cbranch_vccz L_spun_10
    s_add_u32 s3, s3, 1
    s_cmp_lt_u32 s3, 262144
    s_cbranch_scc1 L_spin_9
L_spun_10:
    buffer_load_dwordx4 v[16:19], v2, s[24:27], s39 offen offset:0 sc1
    buffer_load_dwordx4 v[20:23], v2, s[24:27], s39 offen offset:1024 sc1
    buffer_load_dwordx4 v[24:27], v2, s[24:27], s39 offen offset:2048 sc1
    buffer_load_dwordx4 v[28:31], v2, s[24:27], s39 offen offset:3072 sc1
    s_add_u32 s39, s39, 4096
    buffer_load_dwordx4 v[32:35], v2, s[24:27], s39 offen offset:0 sc1
    buffer_load_dwordx4 v[36:39], v2, s[24:27], s39 offen offset:1024 sc1
    buffer_load_dwordx4 v[40:43], v2, s[24:27], s39 offen offset:2048 sc1
    buffer_load_dwordx4 v[44:47], v2, s[24:27], s39 offen offset:3072 sc1
    s_add_u32 s39, s39, 4096
    s_waitcnt vmcnt(7) lgkmcnt(6)
    v_mfma_f32_32x32x16_bf16 v[80:95], v[8:11], v[16:19], 0
    buffer_load_dwordx4 v[48:51], v2, s[24:27], s39 offen offset:0 sc1
    ds_read_b64_tr_b16 v[8:9], v4 offset:4096
    ds_read_b64_tr_b16 v[10:11], v4 offset:5120
    s_waitcnt lgkmcnt(6)
    v_mfma_f32_32x32x16_bf16 v[96:111], v[12:15], v[16:19], 0
    ds_read_b64_tr_b16 v[12:13], v5 offset:4096
    ds_read_b64_tr_b16 v[14:15], v5 offset:5120
    s_waitcnt vmcnt(7) lgkmcnt(6)
    v_mfma_f32_32x32x16_bf16 v[80:95], v[120:123], v[20:23], v[80:95]
    buffer_load_dwordx4 v[52:55], v2, s[24:27], s39 offen offset:1024 sc1
    ds_read_b64_tr_b16 v[120:121], v4 offset:6144
    ds_read_b64_tr_b16 v[122:123], v4 offset:7168
    s_waitcnt lgkmcnt(6)
    v_mfma_f32_32x32x16_bf16 v[96:111], v[124:127], v[20:23], v[96:111]
    ds_read_b64_tr_b16 v[124:125], v5 offset:6144
    ds_read_b64_tr_b16 v[126:127], v5 offset:7168
    s_waitcnt vmcnt(7) lgkmcnt(6)
    v_mfma_f32_32x32x16_bf16 v[80:95], v[8:11], v[24:27], v[80:95]
    buffer_load_dwordx4 v[56:59], v2, s[24:27], s39 offen offset:2048 sc1
    ds_read_b64_tr_b16 v[8:9], v4 offset:8192
    ds_read_b64_tr_b16 v[10:11], v4 offset:9216
    s_waitcnt lgkmcnt(6)
    v_mfma_f32_32x32x16_bf16 v[96:111], v[12:15], v[24:27], v[96:111]
    ds_read_b64_tr_b16 v[12:13], v5 offset:8192
    ds_read_b64_tr_b16 v[14:15], v5 offset:9216
    s_waitcnt vmcnt(7) lgkmcnt(6)
    v_mfma_f32_32x32x16_bf16 v[80:95], v[120:123], v[28:31], v[80:95]
    buffer_load_dwordx4 v[60:63], v2, s[24:27], s39 offen offset:3072 sc1
    s_add_u32 s39, s39, 4096
    ds_read_b64_tr_b16 v[120:121], v4 offset:10240
    ds_read_b64_tr_b16 v[122:123], v4 offset:11264
    s_waitcnt lgkmcnt(6)
    v_mfma_f32_32x32x16_bf16 v[96:111], v[124:127], v[28:31], v[96:111]
    ds_read_b64_tr_b16 v[124:125], v5 offset:10240
    ds_read_b64_tr_b16 v[126:127], v5 offset:11264
    s_waitcnt vmcnt(7) lgkmcnt(6)
    v_mfma_f32_32x32x16_bf16 v[80:95], v[8:11], v[32:35], v[80:95]
    buffer_load_dwordx4 v[64:67], v2, s[24:27], s39 offen offset:0 sc1
    ds_read_b64_tr_b16 v[8:9], v4 offset:12288
    ds_read_b64_tr_b16 v[10:11], v4 offset:13312
    s_waitcnt lgkmcnt(6)
    v_mfma_f32_32x32x16_bf16 v[96:111], v[12:15], v[32:35], v[96:111]
    ds_read_b64_tr_b16 v[12:13], v5 offset:12288
    ds_read_b64_tr_b16 v[14:15], v5 offset:13312
    s_waitcnt vmcnt(7) lgkmcnt(6)
    v_mfma_f32_32x32x16_bf16 v[80:95], v[120:123], v[36:39], v[80:95]
    buffer_load_dwordx4 v[68:71], v2, s[24:27], s39 offen offset:1024 sc1
    ds_read_b64_tr_b16 v[120:121], v4 offset:14336
    ds_read_b64_tr_b16 v[122:123], v4 offset:15360
    s_waitcnt lgkmcnt(6)
    v_mfma_f32_32x32x16_bf16 v[96:111], v[124:127], v[36:39], v[96:111]
    ds_read_b64_tr_b16 v[124:125], v5 offset:14336
    ds_read_b64_tr_b16 v[126:127], v5 offset:15360
    s_waitcnt vmcnt(7) lgkmcnt(6)
    v_mfma_f32_32x32x16_bf16 v[80:95], v[8:11], v[40:43], v[80:95]
    buffer_load_dwordx4 v[72:75], v2, s[24:27], s39 offen offset:2048 sc1
    ds_read_b64_tr_b16 v[8:9], v4 offset:16384
    ds_read_b64_tr_b16 v[10:11], v4 offset:17408
    s_waitcnt lgkmcnt(6)
    v_mfma_f32_32x32x16_bf16 v[96:111], v[12:15], v[40:43], v[96:111]
    ds_read_b64_tr_b16 v[12:13], v5 offset:16384
    ds_read_b64_tr_b16 v[14:15], v5 offset:17408
    s_waitcnt vmcnt(7) lgkmcnt(6)
    v_mfma_f32_32x32x16_bf16 v[80:95], v[120:123], v[44:47], v[80:95]
    buffer_load_dwordx4 v[76:79], v2, s[24:27], s39 offen offset:3072 sc1
    ds_read_b64_tr_b16 v[120:121], v4 offset:18432
    ds_read_b64_tr_b16 v[122:123], v4 offset:19456
    s_waitcnt lgkmcnt(6)
    v_mfma_f32_32x32x16_bf16 v[96:111], v[124:127], v[44:47], v[96:111]
    ds_read_b64_tr_b16 v[124:125], v5 offset:18432
    ds_read_b64_tr_b16 v[126:127], v5 offset:19456
    s_waitcnt vmcnt(7) lgkmcnt(6)
    v_mfma_f32_32x32x16_bf16 v[80:95], v[8:11], v[48:51], v[80:95]
    ds_read_b64_tr_b16 v[8:9], v4 offset:20480
    ds_read_b64_tr_b16 v[10:11], v4 offset:21504
    s_waitcnt lgkmcnt(6)
    v_mfma_f32_32x32x16_bf16 v[96:111], v[12:15], v[48:51], v[96:111]
    ds_read_b64_tr_b16 v[12:13], v5 offset:20480
    ds_read_b64_tr_b16 v[14:15], v5 offset:21504
    s_waitcnt vmcnt(6) lgkmcnt(6)
    v_mfma_f32_32x32x16_bf16 v[80:95], v[120:123], v[52:55], v[80:95]
    ds_read_b64_tr_b16 v[120:121], v4 offset:22528
    ds_read_b64_tr_b16 v[122:123], v4 offset:23552
    s_waitcnt lgkmcnt(6)
    v_mfma_f32_32x32x16_bf16 v[96:111], v[124:127], v[52:55], v[96:111]
    ds_read_b64_tr_b16 v[124:125], v5 offset:22528
    ds_read_b64_tr_b16 v[126:127], v5 offset:23552
    s_waitcnt vmcnt(5) lgkmcnt(6)
    v_mfma_f32_32x32x16_bf16 v[80:95], v[8:11], v[56:59], v[80:95]
    ds_read_b64_tr_b16 v[8:9], v5 offset:24576
    ds_read_b64_tr_b16 v[10:11], v5 offset:25600
    s_waitcnt lgkmcnt(6)
    v_mfma_f32_32x32x16_bf16 v[96:111], v[12:15], v[56:59], v[96:111]
    ds_read_b64_tr_b16 v[12:13], v5 offset:26624
    ds_read_b64_tr_b16 v[14:15], v5 offset:27648
    s_waitcnt vmcnt(4) lgkmcnt(6)
    v_mfma_f32_32x32x16_bf16 v[80:95], v[120:123], v[60:63], v[80:95]
    ds_read_b64_tr_b16 v[120:121], v5 offset:28672
    ds_read_b64_tr_b16 v[122:123], v5 offset:29696
    s_waitcnt lgkmcnt(6)
    v_mfma_f32_32x32x16_bf16 v[96:111], v[124:127], v[60:63], v[96:111]
    ds_read_b64_tr_b16 v[124:125], v5 offset:30720
    ds_read_b64_tr_b16 v[126:127], v5 offset:31744
    s_waitcnt vmcnt(3) lgkmcnt(6)
    v_mfma_f32_32x32x16_bf16 v[96:111], v[8:11], v[64:67], v[96:111]
    ds_read_b64_tr_b16 v[8:9], v4 offset:24576
    ds_read_b64_tr_b16 v[10:11], v4 offset:25600
    s_waitcnt vmcnt(2) lgkmcnt(6)
    v_mfma_f32_32x32x16_bf16 v[96:111], v[12:15], v[68:71], v[96:111]
    ds_read_b64_tr_b16 v[12:13], v4 offset:26624
    ds_read_b64_tr_b16 v[14:15], v4 offset:27648
    s_waitcnt vmcnt(1) lgkmcnt(6)
    v_mfma_f32_32x32x16_bf16 v[96:111], v[120:123], v[72:75], v[96:111]
    ds_read_b64_tr_b16 v[120:121], v4 offset:28672
    ds_read_b64_tr_b16 v[122:123], v4 offset:29696
    s_waitcnt vmcnt(0) lgkmcnt(6)
    v_mfma_f32_32x32x16_bf16 v[96:111], v[124:127], v[76:79], v[96:111]
    ds_read_b64_tr_b16 v[124:125], v4 offset:30720
    ds_read_b64_tr_b16 v[126:127], v4 offset:31744
    s_xor_b32 s38, s32, 2
    s_lshl_b32 s38, s38, 12
    s_add_u32 s38, s38, 139264
    v_add_u32 v4, s38, v2
    s_waitcnt lgkmcnt(6)
    v_mfma_f32_32x32x16_bf16 v[80:95], v[8:11], v[64:67], v[80:95]
    ds_read_b128 v[16:19], v6 offset:0
    ds_read_b128 v[20:23], v6 offset:32
    ds_read_b128 v[24:27], v6 offset:64
    ds_read_b128 v[28:31], v6 offset:96
    s_waitcnt lgkmcnt(8)
    v_mfma_f32_32x32x16_bf16 v[80:95], v[12:15], v[68:71], v[80:95]
    ds_write_b128 v4, v[96:99] offset:0
    s_waitcnt lgkmcnt(7)
    v_mfma_f32_32x32x16_bf16 v[80:95], v[120:123], v[72:75], v[80:95]
    ds_write_b128 v4, v[100:103] offset:1024
    s_waitcnt lgkmcnt(6)
    v_mfma_f32_32x32x16_bf16 v[80:95], v[124:127], v[76:79], v[80:95]
    ds_write_b128 v4, v[104:107] offset:2048
    ds_write_b128 v4, v[108:111] offset:3072
    s_lshl_b32 s38, s32, 12
    s_add_u32 s38, s38, 139264
    v_add_u32 v5, s38, v2
    v_lshlrev_b32 v64, 16, v112
    v_and_b32 v65, 0xffff0000, v112
    v_lshlrev_b32 v66, 16, v113
    v_and_b32 v67, 0xffff0000, v113
    v_lshlrev_b32 v68, 16, v114
    v_and_b32 v69, 0xffff0000, v114
    v_lshlrev_b32 v70, 16, v115
    v_and_b32 v71, 0xffff0000, v115
    v_lshlrev_b32 v72, 16, v116
    v_and_b32 v73, 0xffff0000, v116
    v_lshlrev_b32 v74, 16, v117
    v_and_b32 v75, 0xffff0000, v117
    v_lshlrev_b32 v76, 16, v118
    v_and_b32 v77, 0xffff0000, v118
    v_lshlrev_b32 v78, 16, v119
    v_and_b32 v79, 0xffff0000, v119
    s_waitcnt lgkmcnt(0)
    s_barrier
    ds_read_b128 v[96:99], v5 offset:0
    ds_read_b128 v[100:103], v5 offset:1024
    ds_read_b128 v[104:107], v5 offset:2048
    ds_read_b128 v[108:111], v5 offset:3072
    v_pk_fma_f32 v[64:65], v[80:81], v[16:17], v[64:65]
    v_pk_fma_f32 v[66:67], v[82:83], v[18:19], v[66:67]
    v_pk_fma_f32 v[68:69], v[84:85], v[20:21], v[68:69]
    v_pk_fma_f32 v[70:71], v[86:87], v[22:23], v[70:71]
    v_pk_fma_f32 v[72:73], v[88:89], v[24:25], v[72:73]
    v_pk_fma_f32 v[74:75], v[90:91], v[26:27], v[74:75]
    v_pk_fma_f32 v[76:77], v[92:93], v[28:29], v[76:77]
    v_pk_fma_f32 v[78:79], v[94:95], v[30:31], v[78:79]
    s_lshl_b32 s38, s36, 15
    s_add_u32 s38, s38, s62
    s_add_u32 s38, s38, 4194304
    s_lshl_b32 s39, s34, 10
    s_lshl_b32 s40, s37, 3
    s_add_u32 s39, s39, s40
    s_add_u32 s39, s39, s38
    s_add_u32 s40, s38, 4096
    s_waitcnt lgkmcnt(3)
    v_pk_fma_f32 v[80:81], v[96:97], v[16:17], v[64:65]
    v_pk_mul_f32 v[10:11], v[80:81], v[80:81]
    v_pk_fma_f32 v[82:83], v[98:99], v[18:19], v[66:67]
    v_pk_add_f32 v[8:9], v[80:81], v[82:83]
    v_pk_fma_f32 v[10:11], v[82:83], v[82:83], v[10:11]
    s_waitcnt lgkmcnt(2)
    v_pk_fma_f32 v[84:85], v[100:101], v[20:21], v[68:69]
    v_pk_add_f32 v[8:9], v[8:9], v[84:85]
    v_pk_fma_f32 v[10:11], v[84:85], v[84:85], v[10:11]
    v_pk_fma_f32 v[86:87], v[102:103], v[22:23], v[70:71]
    v_pk_add_f32 v[8:9], v[8:9], v[86:87]
    v_pk_fma_f32 v[10:11], v[86:87], v[86:87], v[10:11]
    s_waitcnt lgkmcnt(1)
    v_pk_fma_f32 v[88:89], v[104:105], v[24:25], v[72:73]
    v_pk_add_f32 v[8:9], v[8:9], v[88:89]
    v_pk_fma_f32 v[10:11], v[88:89], v[88:89], v[10:11]
    v_pk_fma_f32 v[90:91], v[106:107], v[26:27], v[74:75]
    v_pk_add_f32 v[8:9], v[8:9], v[90:91]
    v_pk_fma_f32 v[10:11], v[90:91], v[90:91], v[10:11]
    s_waitcnt lgkmcnt(0)
    v_pk_fma_f32 v[92:93], v[108:109], v[28:29], v[76:77]
    v_pk_add_f32 v[8:9], v[8:9], v[92:93]
    v_pk_fma_f32 v[10:11], v[92:93], v[92:93], v[10:11]
    v_pk_fma_f32 v[94:95], v[110:111], v[30:31], v[78:79]
    v_pk_add_f32 v[8:9], v[8:9], v[94:95]
    v_pk_fma_f32 v[10:11], v[94:95], v[94:95], v[10:11]
    v_add_f32 v8, v8, v9
    v_add_f32 v10, v10, v11
    v_mov_b32 v9, s35
    s_nop 0
    v_permlane32_swap_b32 v8, v10
    v_add_f32 v8, v8, v10
    buffer_store_dwordx2 v[8:9], v2, s[12:15], s39 offen
    buffer_store_dwordx2 v[8:9], v2, s[16:19], s39 offen  sc1
    v_mov_b32 v7, s35
    ds_read_b128 v[32:35], v6 offset:256
    ds_read_b128 v[36:39], v6 offset:288
    ds_read_b128 v[40:43], v6 offset:320
    ds_read_b128 v[44:47], v6 offset:352
    ds_read_b128 v[48:51], v6 offset:512
    ds_read_b128 v[52:55], v6 offset:544
    ds_read_b128 v[56:59], v6 offset:576
    ds_read_b128 v[60:63], v6 offset:608
    s_lshl_b32 s55, s32, 14
    s_lshl_b32 s54, s34, 7
    s_add_u32 s54, s54, s55
    s_add_u32 s41, s62, 4194304
    s_lshl_b32 s56, s36, 5
    s_add_u32 s56, s56, s32
    s_lshl_b32 s56, s56, 10
    s_add_u32 s56, s56, s41
    s_xor_b32 s57, s56, 32768
    s_lshl_b32 s58, s45, 10
    s_add_u32 s58, s58, s41
    s_add_u32 s59, s58, 32768
    s_sub_u32 s63, s58, 4194304
    s_sub_u32 s64, s59, 4194304
    s_lshl_b32 s60, s45, 2
    s_add_u32 s60, s60, s46
    s_lshl_b32 s61, s32, 2
    s_add_u32 s61, s61, s46
    s_mov_b32 s3, 0
L_spin_11:
    buffer_load_dwordx4 v[96:99], v2, s[8:11], s38 offen offset:0 sc1
    buffer_load_dwordx4 v[100:103], v2, s[8:11], s38 offen offset:1024 sc1
    buffer_load_dwordx4 v[104:107], v2, s[8:11], s38 offen offset:2048 sc1
    buffer_load_dwordx4 v[108:111], v2, s[8:11], s38 offen offset:3072 sc1
    buffer_load_dwordx4 v[112:115], v2, s[8:11], s40 offen offset:0 sc1
    buffer_load_dwordx4 v[116:119], v2, s[8:11], s40 offen offset:1024 sc1
    buffer_load_dwordx4 v[120:123], v2, s[8:11], s40 offen offset:2048 sc1
    buffer_load_dwordx4 v[124:127], v2, s[8:11], s40 offen offset:3072 sc1
    s_waitcnt vmcnt(7)
    v_min_u32 v10, v97, v99
    v_max_u32 v11, v97, v99
    v_add_f32 v12, v96, v98
    s_waitcnt vmcnt(6)
    v_min3_u32 v10, v10, v101, v103
    v_max3_u32 v11, v11, v101, v103
    v_add_f32 v12, v12, v100
    v_add_f32 v12, v12, v102
    s_waitcnt vmcnt(5)
    v_min3_u32 v10, v10, v105, v107
    v_max3_u32 v11, v11, v105, v107
    v_add_f32 v12, v12, v104
    v_add_f32 v12, v12, v106
    s_waitcnt vmcnt(4)
    v_min3_u32 v10, v10, v109, v111
    v_max3_u32 v11, v11, v109, v111
    v_add_f32 v12, v12, v108
    v_add_f32 v12, v12, v110
    s_waitcnt vmcnt(3)
    v_min3_u32 v10, v10, v113, v115
    v_max3_u32 v11, v11, v113, v115
    v_add_f32 v12, v12, v112
    v_add_f32 v12, v12, v114
    s_waitcnt vmcnt(2)
    v_min3_u32 v10, v10, v117, v119
    v_max3_u32 v11, v11, v117, v119
    v_add_f32 v12, v12, v116
    v_add_f32 v12, v12, v118
    s_waitcnt vmcnt(1)
    v_min3_u32 v10, v10, v121, v123
    v_max3_u32 v11, v11, v121, v123
    v_add_f32 v12, v12, v120
    v_add_f32 v12, v12, v122
    s_waitcnt vmcnt(0)
    v_min3_u32 v10, v10, v125, v127
    v_max3_u32 v11, v11, v125, v127
    v_add_f32 v12, v12, v124
    v_add_f32 v12, v12, v126
    v_xor_b32 v10, v7, v10
    v_xor_b32 v11, v7, v11
    v_or_b32 v10, v10, v11
    v_cmp_ne_u32 vcc, 0, v10
    s_nop 0
    s_cbranch_vccz L_spun_12
    s_add_u32 s3, s3, 1
    s_cmp_lt_u32 s3, 262144
    s_cbranch_scc1 L_spin_11
L_spun_12:
    v_mul_f32 v12, 0x3b000000, v12
    v_mov_b32 v13, v12
    s_lshl_b32 s38, s32, 5
    s_nop 0
    v_permlane32_swap_b32 v12, v13
    v_fma_f32 v13, -v12, v12, v13
    v_max_f32 v13, 0, v13
    v_add_f32 v13, 0x3727c5ac, v13
    v_rsq_f32 v14, v13
    s_add_u32 s38, s38, s46
    v_mul_f32 v15, -v12, v14
    v_pk_fma_f32 v[64:65], v[80:81], v[14:15], v[14:15] op_sel:[0,0,1] op_sel_hi:[1,0,1]
    v_pk_fma_f32 v[66:67], v[82:83], v[14:15], v[14:15] op_sel:[0,0,1] op_sel_hi:[1,0,1]
    v_pk_fma_f32 v[68:69], v[84:85], v[14:15], v[14:15] op_sel:[0,0,1] op_sel_hi:[1,0,1]
    v_pk_fma_f32 v[70:71], v[86:87], v[14:15], v[14:15] op_sel:[0,0,1] op_sel_hi:[1,0,1]
    s_waitcnt lgkmcnt(3)
    v_pk_fma_f32 v[64:65], v[64:65], v[48:49], v[32:33]
    v_pk_fma_f32 v[66:67], v[66:67], v[50:51], v[34:35]
    s_waitcnt lgkmcnt(2)
    v_pk_fma_f32 v[68:69], v[68:69], v[52:53], v[36:37]
    v_pk_fma_f32 v[70:71], v[70:71], v[54:55], v[38:39]
    v_cvt_pk_bf16_f32 v16, v64, v65
    v_cvt_pk_bf16_f32 v17, v66, v67
    v_cvt_pk_bf16_f32 v18, v68, v69
    v_cvt_pk_bf16_f32 v19, v70, v71
    buffer_store_dwordx4 v[16:19], v2, s[68:71], s49 offen offset:0
    buffer_store_dwordx4 v[16:19], v2, s[72:75], s49 offen offset:0 sc1
    v_pk_fma_f32 v[72:73], v[88:89], v[14:15], v[14:15] op_sel:[0,0,1] op_sel_hi:[1,0,1]
    v_pk_fma_f32 v[74:75], v[90:91], v[14:15], v[14:15] op_sel:[0,0,1] op_sel_hi:[1,0,1]
    v_pk_fma_f32 v[76:77], v[92:93], v[14:15], v[14:15] op_sel:[0,0,1] op_sel_hi:[1,0,1]
    v_pk_fma_f32 v[78:79], v[94:95], v[14:15], v[14:15] op_sel:[0,0,1] op_sel_hi:[1,0,1]
    s_waitcnt lgkmcnt(1)
    v_pk_fma_f32 v[72:73], v[72:73], v[56:57], v[40:41]
    v_pk_fma_f32 v[74:75], v[74:75], v[58:59], v[42:43]
    s_waitcnt lgkmcnt(0)
    v_pk_fma_f32 v[76:77], v[76:77], v[60:61], v[44:45]
    v_pk_fma_f32 v[78:79], v[78:79], v[62:63], v[46:47]
    v_cvt_pk_bf16_f32 v20, v72, v73
    v_cvt_pk_bf16_f32 v21, v74, v75
    v_cvt_pk_bf16_f32 v22, v76, v77
    v_cvt_pk_bf16_f32 v23, v78, v79
    buffer_store_dwordx4 v[20:23], v2, s[68:71], s49 offen offset:1024
    buffer_store_dwordx4 v[20:23], v2, s[72:75], s49 offen offset:1024 sc1
    s_lshl_b32 s40, s32, 13
    s_add_u32 s39, s40, s62
    s_add_u32 m0, s40, 65536
    v_add_u32 v4, 65536, v2
    s_waitcnt vmcnt(0)
    buffer_store_dword v7, off, s[12:15], s47 offset:128
    buffer_store_dword v7, off, s[16:19], s47 offset:128 sc1
    s_mov_b32 s3, 0
L_spin_13:
    buffer_load_dword v8, v3, s[8:11], s38 offen offset:128 sc1
    s_waitcnt vmcnt(0)
    v_cmp_ne_u32 vcc, v7, v8
    s_nop 0
    s_cbranch_vccz L_spun_14
    s_add_u32 s3, s3, 1
    s_cmp_lt_u32 s3, 262144
    s_cbranch_scc1 L_spin_13
L_spun_14:
    buffer_load_dwordx4 v2, s[24:27], s39 offen offset:0 sc1 lds
    buffer_load_dwordx4 v2, s[24:27], s39 offen offset:1024 sc1 lds
    buffer_load_dwordx4 v2, s[24:27], s39 offen offset:2048 sc1 lds
    buffer_load_dwordx4 v2, s[24:27], s39 offen offset:3072 sc1 lds
    s_xor_b32 m0, m0, 32768
    s_xor_b32 s39, s39, 32768
    buffer_load_dwordx4 v2, s[24:27], s39 offen offset:0 sc1 lds
    buffer_load_dwordx4 v2, s[24:27], s39 offen offset:1024 sc1 lds
    buffer_load_dwordx4 v2, s[24:27], s39 offen offset:2048 sc1 lds
    buffer_load_dwordx4 v2, s[24:27], s39 offen offset:3072 sc1 lds
    s_xor_b32 m0, m0, 4096
    s_xor_b32 s39, s39, 4096
    buffer_load_dwordx4 v2, s[24:27], s39 offen offset:0 sc1 lds
    buffer_load_dwordx4 v2, s[24:27], s39 offen offset:1024 sc1 lds
    v_lshlrev_b32 v3, 2, v3
    v_lshrrev_b32 v12, 3, v1
    v_lshrrev_b32 v13, 2, v1
    v_and_b32 v13, 4, v13
    v_xor_b32 v13, v13, v1
    v_and_b32 v13, 7, v13
    v_lshlrev_b32 v13, 4, v13
    v_lshl_add_u32 v12, v12, 10, v13
    v_lshrrev_b32 v13, 5, v1
    v_bfe_u32 v14, v1, 2, 2
    v_lshl_add_u32 v13, v13, 2, v14
    v_lshrrev_b32 v14, 1, v14
    v_xor_b32 v14, s37, v14
    v_lshl_add_u32 v13, v13, 1, v14
    v_bfe_u32 v14, v1, 4, 1
    v_lshl_add_u32 v13, v13, 1, v14
    v_and_b32 v14, 3, v1
    v_lshl_add_u32 v13, v13, 2, v14
    v_lshlrev_b32 v13, 3, v13
    v_add_u32 v13, s55, v13
    v_xor_b32 v14, 64, v13
    v_and_b32 v15, 31, v1
    v_lshlrev_b32 v15, 2, v15
    v_lshrrev_b32 v1, 5, v1
    v_lshl_add_u32 v0, v1, 3, v0
    v_add_u32 v1, 7168, v12
    s_waitcnt vmcnt(2)
    s_barrier
    ds_read_b128 v[96:99], v4 offset:0
    ds_read_b128 v[100:103], v4 offset:32768
    ds_read_b128 v[104:107], v4 offset:1024
    ds_read_b128 v[108:111], v4 offset:33792
    ds_read_b128 v[112:115], v4 offset:2048
    ds_read_b128 v[116:119], v4 offset:34816
    s_waitcnt lgkmcnt(5)
    v_mfma_f32_32x32x16_bf16 v[16:31], v[128:131], v[96:99], 0
    ds_read_b128 v[120:123], v4 offset:3072
    buffer_load_dwordx4 v2, s[24:27], s39 offen offset:2048 sc1 lds
    s_waitcnt lgkmcnt(5)
    v_mfma_f32_32x32x16_bf16 v[32:47], v[128:131], v[100:103], 0
    ds_read_b128 v[124:127], v4 offset:35840
    s_waitcnt lgkmcnt(5)
    v_mfma_f32_32x32x16_bf16 v[16:31], v[132:135], v[104:107], v[16:31]
    ds_read_b128 v[96:99], v4 offset:8192
    buffer_load_dwordx4 v2, s[24:27], s39 offen offset:3072 sc1 lds
    s_xor_b32 m0, m0, 32768
    s_xor_b32 s39, s39, 32768
    s_waitcnt lgkmcnt(5)
    v_mfma_f32_32x32x16_bf16 v[32:47], v[132:135], v[108:111], v[32:47]
    ds_read_b128 v[100:103], v4 offset:40960
    s_waitcnt lgkmcnt(5)
    v_mfma_f32_32x32x16_bf16 v[16:31], v[136:139], v[112:115], v[16:31]
    ds_read_b128 v[104:107], v4 offset:9216
    buffer_load_dwordx4 v2, s[24:27], s39 offen offset:0 sc1 lds
    s_waitcnt lgkmcnt(5)
    v_mfma_f32_32x32x16_bf16 v[32:47], v[136:139], v[116:119], v[32:47]
    ds_read_b128 v[108:111], v4 offset:41984
    s_waitcnt lgkmcnt(5)
    v_mfma_f32_32x32x16_bf16 v[16:31], v[140:143], v[120:123], v[16:31]
    ds_read_b128 v[112:115], v4 offset:10240
    buffer_load_dwordx4 v2, s[24:27], s39 offen offset:1024 sc1 lds
    s_waitcnt lgkmcnt(5)
    v_mfma_f32_32x32x16_bf16 v[32:47], v[140:143], v[124:127], v[32:47]
    ds_read_b128 v[116:119], v4 offset:43008
    s_waitcnt lgkmcnt(5)
    v_mfma_f32_32x32x16_bf16 v[16:31], v[160:163], v[96:99], v[16:31]
    ds_read_b128 v[120:123], v4 offset:11264
    buffer_load_dwordx4 v2, s[24:27], s39 offen offset:2048 sc1 lds
    s_waitcnt lgkmcnt(5)
    v_mfma_f32_32x32x16_bf16 v[32:47], v[160:163], v[100:103], v[32:47]
    ds_read_b128 v[124:127], v4 offset:44032
    s_waitcnt lgkmcnt(5)
    v_mfma_f32_32x32x16_bf16 v[16:31], v[164:167], v[104:107], v[16:31]
    ds_read_b128 v[96:99], v4 offset:16384
    buffer_load_dwordx4 v2, s[24:27], s39 offen offset:3072 sc1 lds
    s_add_u32 m0, s55, 0
    s_waitcnt lgkmcnt(5)
    v_mfma_f32_32x32x16_bf16 v[32:47], v[164:167], v[108:111], v[32:47]
    ds_read_b128 v[100:103], v4 offset:49152
    s_waitcnt lgkmcnt(5)
    v_mfma_f32_32x32x16_bf16 v[16:31], v[168:171], v[112:115], v[16:31]
    ds_read_b128 v[104:107], v4 offset:17408
    s_waitcnt lgkmcnt(5)
    v_mfma_f32_32x32x16_bf16 v[32:47], v[168:171], v[116:119], v[32:47]
    ds_read_b128 v[108:111], v4 offset:50176
    buffer_load_dwordx4 v12, s[4:7], s54 offen offset:0 lds
    s_waitcnt lgkmcnt(5)
    v_mfma_f32_32x32x16_bf16 v[16:31], v[172:175], v[120:123], v[16:31]
    ds_read_b128 v[112:115], v4 offset:18432
    s_waitcnt lgkmcnt(5)
    v_mfma_f32_32x32x16_bf16 v[32:47], v[172:175], v[124:127], v[32:47]
    ds_read_b128 v[116:119], v4 offset:51200
    buffer_load_dwordx4 v1, s[4:7], s54 offen offset:1024 lds
    s_add_u32 m0, s55, 2048
    s_add_u32 s54, s54, 65536
    s_waitcnt lgkmcnt(5)
    v_mfma_f32_32x32x16_bf16 v[16:31], v[192:195], v[96:99], v[16:31]
    ds_read_b128 v[120:123], v4 offset:19456
    s_waitcnt lgkmcnt(5)
    v_mfma_f32_32x32x16_bf16 v[32:47], v[192:195], v[100:103], v[32:47]
    ds_read_b128 v[124:127], v4 offset:52224
    buffer_load_dwordx4 v12, s[4:7], s54 offen offset:0 lds
    s_waitcnt lgkmcnt(5)
    v_mfma_f32_32x32x16_bf16 v[16:31], v[196:199], v[104:107], v[16:31]
    ds_read_b128 v[96:99], v4 offset:24576
    s_waitcnt lgkmcnt(5)
    v_mfma_f32_32x32x16_bf16 v[32:47], v[196:199], v[108:111], v[32:47]
    ds_read_b128 v[100:103], v4 offset:57344
    s_waitcnt lgkmcnt(5)
    v_mfma_f32_32x32x16_bf16 v[16:31], v[200:203], v[112:115], v[16:31]
    ds_read_b128 v[104:107], v4 offset:25600
    buffer_load_dwordx4 v1, s[4:7], s54 offen offset:1024 lds
    s_add_u32 m0, s55, 4096
    s_add_u32 s54, s54, 65536
    s_waitcnt lgkmcnt(5)
    v_mfma_f32_32x32x16_bf16 v[32:47], v[200:203], v[116:119], v[32:47]
    ds_read_b128 v[108:111], v4 offset:58368
    s_waitcnt lgkmcnt(5)
    v_mfma_f32_32x32x16_bf16 v[16:31], v[204:207], v[120:123], v[16:31]
    ds_read_b128 v[112:115], v4 offset:26624
    buffer_load_dwordx4 v12, s[4:7], s54 offen offset:0 lds
    s_waitcnt lgkmcnt(5)
    v_mfma_f32_32x32x16_bf16 v[32:47], v[204:207], v[124:127], v[32:47]
    ds_read_b128 v[116:119], v4 offset:59392
    s_waitcnt lgkmcnt(5)
    v_mfma_f32_32x32x16_bf16 v[16:31], v[224:227], v[96:99], v[16:31]
    ds_read_b128 v[120:123], v4 offset:27648
    buffer_load_dwordx4 v1, s[4:7], s54 offen offset:1024 lds
    s_add_u32 m0, s55, 6144
    s_add_u32 s54, s54, 65536
    s_waitcnt lgkmcnt(5)
    v_mfma_f32_32x32x16_bf16 v[32:47], v[224:227], v[100:103], v[32:47]
    ds_read_b128 v[124:127], v4 offset:60416
    s_waitcnt lgkmcnt(5)
    v_mfma_f32_32x32x16_bf16 v[16:31], v[228:231], v[104:107], v[16:31]
    s_waitcnt vmcnt(6)
    s_barrier
    ds_read_b128 v[96:99], v4 offset:4096
    s_waitcnt lgkmcnt(5)
    v_mfma_f32_32x32x16_bf16 v[32:47], v[228:231], v[108:111], v[32:47]
    ds_read_b128 v[100:103], v4 offset:36864
    buffer_load_dwordx4 v12, s[4:7], s54 offen offset:0 lds
    s_waitcnt lgkmcnt(5)
    v_mfma_f32_32x32x16_bf16 v[16:31], v[232:235], v[112:115], v[16:31]
    ds_read_b128 v[104:107], v4 offset:5120
    s_waitcnt lgkmcnt(5)
    v_mfma_f32_32x32x16_bf16 v[32:47], v[232:235], v[116:119], v[32:47]
    ds_read_b128 v[108:111], v4 offset:37888
    buffer_load_dwordx4 v1, s[4:7], s54 offen offset:1024 lds
    s_add_u32 m0, s55, 8192
    s_add_u32 s54, s54, 65536
    s_waitcnt lgkmcnt(5)
    v_mfma_f32_32x32x16_bf16 v[16:31], v[236:239], v[120:123], v[16:31]
    ds_read_b128 v[112:115], v4 offset:6144
    s_waitcnt lgkmcnt(5)
    v_mfma_f32_32x32x16_bf16 v[32:47], v[236:239], v[124:127], v[32:47]
    ds_read_b128 v[116:119], v4 offset:38912
    buffer_load_dwordx4 v12, s[4:7], s54 offen offset:0 lds
    s_waitcnt lgkmcnt(5)
    v_mfma_f32_32x32x16_bf16 v[16:31], v[144:147], v[96:99], v[16:31]
    ds_read_b128 v[120:123], v4 offset:7168
    s_waitcnt lgkmcnt(5)
    v_mfma_f32_32x32x16_bf16 v[32:47], v[144:147], v[100:103], v[32:47]
    ds_read_b128 v[124:127], v4 offset:39936
    s_waitcnt lgkmcnt(5)
    v_mfma_f32_32x32x16_bf16 v[16:31], v[148:151], v[104:107], v[16:31]
    ds_read_b128 v[96:99], v4 offset:12288
    buffer_load_dwordx4 v1, s[4:7], s54 offen offset:1024 lds
    s_add_u32 m0, s55, 10240
    s_add_u32 s54, s54, 65536
    s_waitcnt lgkmcnt(5)
    v_mfma_f32_32x32x16_bf16 v[32:47], v[148:151], v[108:111], v[32:47]
    ds_read_b128 v[100:103], v4 offset:45056
    s_waitcnt lgkmcnt(5)
    v_mfma_f32_32x32x16_bf16 v[16:31], v[152:155], v[112:115], v[16:31]
    ds_read_b128 v[104:107], v4 offset:13312
    buffer_load_dwordx4 v12, s[4:7], s54 offen offset:0 lds
    s_waitcnt lgkmcnt(5)
    v_mfma_f32_32x32x16_bf16 v[32:47], v[152:155], v[116:119], v[32:47]
    ds_read_b128 v[108:111], v4 offset:46080
    s_waitcnt lgkmcnt(5)
    v_mfma_f32_32x32x16_bf16 v[16:31], v[156:159], v[120:123], v[16:31]
    ds_read_b128 v[112:115], v4 offset:14336
    buffer_load_dwordx4 v1, s[4:7], s54 offen offset:1024 lds
    s_add_u32 m0, s55, 12288
    s_add_u32 s54, s54, 65536
    s_waitcnt lgkmcnt(5)
    v_mfma_f32_32x32x16_bf16 v[32:47], v[156:159], v[124:127], v[32:47]
    ds_read_b128 v[116:119], v4 offset:47104
    s_waitcnt vmcnt(10)
    ds_read_b64_tr_b16 v[128:129], v13 offset:0
    ds_read_b64_tr_b16 v[130:131], v13 offset:1024
    s_waitcnt lgkmcnt(7)
    v_mfma_f32_32x32x16_bf16 v[16:31], v[176:179], v[96:99], v[16:31]
    ds_read_b128 v[120:123], v4 offset:15360
    ds_read_b64_tr_b16 v[132:133], v14 offset:0
    ds_read_b64_tr_b16 v[134:135], v14 offset:1024
    s_waitcnt lgkmcnt(9)
    v_mfma_f32_32x32x16_bf16 v[32:47], v[176:179], v[100:103], v[32:47]
    ds_read_b128 v[124:127], v4 offset:48128
    buffer_load_dwordx4 v12, s[4:7], s54 offen offset:0 lds
    s_waitcnt lgkmcnt(9)
    v_mfma_f32_32x32x16_bf16 v[16:31], v[180:183], v[104:107], v[16:31]
    ds_read_b128 v[96:99], v4 offset:20480
    s_waitcnt lgkmcnt(9)
    v_mfma_f32_32x32x16_bf16 v[32:47], v[180:183], v[108:111], v[32:47]
    ds_read_b128 v[100:103], v4 offset:53248
    buffer_load_dwordx4 v1, s[4:7], s54 offen offset:1024 lds
    s_add_u32 m0, s55, 14336
    s_add_u32 s54, s54, 65536
    s_waitcnt lgkmcnt(9)
    v_mfma_f32_32x32x16_bf16 v[16:31], v[184:187], v[112:115], v[16:31]
    ds_read_b128 v[104:107], v4 offset:21504
    s_waitcnt vmcnt(10)
    ds_read_b64_tr_b16 v[136:137], v13 offset:2048
    ds_read_b64_tr_b16 v[138:139], v13 offset:3072
    s_waitcnt lgkmcnt(11)
    v_mfma_f32_32x32x16_bf16 v[32:47], v[184:187], v[116:119], v[32:47]
    ds_read_b128 v[108:111], v4 offset:54272
    buffer_load_dwordx4 v12, s[4:7], s54 offen offset:0 lds
    ds_read_b64_tr_b16 v[140:141], v14 offset:2048
    ds_read_b64_tr_b16 v[142:143], v14 offset:3072
    s_waitcnt lgkmcnt(11)
    v_mfma_f32_32x32x16_bf16 v[16:31], v[188:191], v[120:123], v[16:31]
    ds_read_b128 v[112:115], v4 offset:22528
    s_waitcnt lgkmcnt(9)
    v_mfma_f32_32x32x16_bf16 v[32:47], v[188:191], v[124:127], v[32:47]
    ds_read_b128 v[116:119], v4 offset:55296
    s_waitcnt lgkmcnt(9)
    v_mfma_f32_32x32x16_bf16 v[16:31], v[208:211], v[96:99], v[16:31]
    ds_read_b128 v[120:123], v4 offset:23552
    buffer_load_dwordx4 v1, s[4:7], s54 offen offset:1024 lds
    s_add_u32 m0, s55, 0
    s_add_u32 s54, s54, 65536
    s_waitcnt lgkmcnt(9)
    v_mfma_f32_32x32x16_bf16 v[32:47], v[208:211], v[100:103], v[32:47]
    ds_read_b128 v[124:127], v4 offset:56320
    s_waitcnt vmcnt(10)
    ds_read_b64_tr_b16 v[160:161], v13 offset:4096
    ds_read_b64_tr_b16 v[162:163], v13 offset:5120
    s_waitcnt lgkmcnt(11)
    v_mfma_f32_32x32x16_bf16 v[16:31], v[212:215], v[104:107], v[16:31]
    ds_read_b128 v[96:99], v4 offset:28672
    buffer_load_dwordx4 v12, s[4:7], s54 offen offset:0 lds
    ds_read_b64_tr_b16 v[164:165], v14 offset:4096
    ds_read_b64_tr_b16 v[166:167], v14 offset:5120
    s_waitcnt lgkmcnt(11)
    v_mfma_f32_32x32x16_bf16 v[32:47], v[212:215], v[108:111], v[32:47]
    ds_read_b128 v[100:103], v4 offset:61440
    s_waitcnt lgkmcnt(9)
    v_mfma_f32_32x32x16_bf16 v[16:31], v[216:219], v[112:115], v[16:31]
    ds_read_b128 v[104:107], v4 offset:29696
    buffer_load_dwordx4 v1, s[4:7], s54 offen offset:1024 lds
    s_add_u32 m0, s55, 2048
    s_add_u32 s54, s54, 65536
    s_waitcnt lgkmcnt(9)
    v_mfma_f32_32x32x16_bf16 v[32:47], v[216:219], v[116:119], v[32:47]
    ds_read_b128 v[108:111], v4 offset:62464
    s_waitcnt vmcnt(10)
    ds_read_b64_tr_b16 v[168:169], v13 offset:6144
    ds_read_b64_tr_b16 v[170:171], v13 offset:7168
    s_waitcnt lgkmcnt(11)
    v_mfma_f32_32x32x16_bf16 v[16:31], v[220:223], v[120:123], v[16:31]
    ds_read_b128 v[112:115], v4 offset:30720
    ds_read_b64_tr_b16 v[172:173], v14 offset:6144
    ds_read_b64_tr_b16 v[174:175], v14 offset:7168
    s_waitcnt lgkmcnt(13)
    v_mfma_f32_32x32x16_bf16 v[32:47], v[220:223], v[124:127], v[32:47]
    ds_read_b128 v[116:119], v4 offset:63488
    buffer_load_dwordx4 v12, s[4:7], s54 offen offset:0 lds
    s_waitcnt lgkmcnt(11)
    v_mfma_f32_32x32x16_bf16 v[16:31], v[240:243], v[96:99], v[16:31]
    ds_read_b128 v[120:123], v4 offset:31744
    s_waitcnt lgkmcnt(9)
    v_mfma_f32_32x32x16_bf16 v[32:47], v[240:243], v[100:103], v[32:47]
    ds_read_b128 v[124:127], v4 offset:64512
    buffer_load_dwordx4 v1, s[4:7], s54 offen offset:1024 lds
    s_add_u32 m0, s55, 4096
    s_add_u32 s54, s54, 65536
    s_waitcnt lgkmcnt(9)
    v_mfma_f32_32x32x16_bf16 v[16:31], v[244:247], v[104:107], v[16:31]
    ds_read_b128 v[96:99], v4 offset:0
    s_waitcnt vmcnt(10)
    ds_read_b64_tr_b16 v[192:193], v13 offset:8192
    ds_read_b64_tr_b16 v[194:195], v13 offset:9216
    s_waitcnt lgkmcnt(11)
    v_mfma_f32_32x32x16_bf16 v[32:47], v[244:247], v[108:111], v[32:47]
    ds_read_b128 v[100:103], v4 offset:32768
    buffer_load_dwordx4 v12, s[4:7], s54 offen offset:0 lds
    ds_read_b64_tr_b16 v[196:197], v14 offset:8192
    ds_read_b64_tr_b16 v[198:199], v14 offset:9216
    s_waitcnt lgkmcnt(11)
    v_mfma_f32_32x32x16_bf16 v[16:31], v[248:251], v[112:115], v[16:31]
    ds_read_b128 v[104:107], v4 offset:1024
    s_waitcnt lgkmcnt(9)
    v_mfma_f32_32x32x16_bf16 v[32:47], v[248:251], v[116:119], v[32:47]
    ds_read_b128 v[108:111], v4 offset:33792
    s_waitcnt lgkmcnt(9)
    v_mfma_f32_32x32x16_bf16 v[16:31], v[252:255], v[120:123], v[16:31]
    ds_read_b128 v[112:115], v4 offset:2048
    buffer_load_dwordx4 v1, s[4:7], s54 offen offset:1024 lds
    s_add_u32 m0, s55, 6144
    s_add_u32 s54, s54, 65536
    s_waitcnt lgkmcnt(9)
    v_mfma_f32_32x32x16_bf16 v[32:47], v[252:255], v[124:127], v[32:47]
    ds_read_b128 v[116:119], v4 offset:34816
    s_waitcnt vmcnt(10)
    ds_read_b64_tr_b16 v[200:201], v13 offset:10240
    ds_read_b64_tr_b16 v[202:203], v13 offset:11264
    s_waitcnt lgkmcnt(11)
    v_mfma_f32_32x32x16_bf16 v[48:63], a[0:3], v[96:99], 0
    ds_read_b128 v[120:123], v4 offset:3072
    buffer_load_dwordx4 v12, s[4:7], s54 offen offset:0 lds
    ds_read_b64_tr_b16 v[204:205], v14 offset:10240
    ds_read_b64_tr_b16 v[206:207], v14 offset:11264
    s_waitcnt lgkmcnt(11)
    v_mfma_f32_32x32x16_bf16 v[64:79], a[0:3], v[100:103], 0
    ds_read_b128 v[124:127], v4 offset:35840
    s_waitcnt lgkmcnt(9)
    v_mfma_f32_32x32x16_bf16 v[48:63], a[4:7], v[104:107], v[48:63]
    ds_read_b128 v[96:99], v4 offset:8192
    buffer_load_dwordx4 v1, s[4:7], s54 offen offset:1024 lds
    s_add_u32 m0, s55, 8192
    s_add_u32 s54, s54, 65536
    s_waitcnt lgkmcnt(9)
    v_mfma_f32_32x32x16_bf16 v[64:79], a[4:7], v[108:111], v[64:79]
    ds_read_b128 v[100:103], v4 offset:40960
    v_max_f32 v16, 0, v16
    v_max_f32 v17, 0, v17
    v_max_f32 v18, 0, v18
    v_max_f32 v19, 0, v19
    s_waitcnt lgkmcnt(9)
    v_mfma_f32_32x32x16_bf16 v[48:63], a[8:11], v[112:115], v[48:63]
    ds_read_b128 v[104:107], v4 offset:9216
    v_max_f32 v20, 0, v20
    v_max_f32 v21, 0, v21
    v_max_f32 v22, 0, v22
    v_max_f32 v23, 0, v23
    s_waitcnt lgkmcnt(9)
    v_mfma_f32_32x32x16_bf16 v[64:79], a[8:11], v[116:119], v[64:79]
    ds_read_b128 v[108:111], v4 offset:41984
    buffer_load_dwordx4 v12, s[4:7], s54 offen offset:0 lds
    v_mul_f32 v16, v16, v24
    v_mul_f32 v17, v17, v25
    s_waitcnt lgkmcnt(7)
    v_mfma_f32_32x32x16_bf16 v[48:63], a[12:15], v[120:123], v[48:63]
    ds_read_b128 v[112:115], v4 offset:10240
    v_mul_f32 v18, v18, v26
    v_mul_f32 v19, v19, v27
    v_mul_f32 v20, v20, v28
    v_mul_f32 v21, v21, v29
    s_waitcnt lgkmcnt(5)
    v_mfma_f32_32x32x16_bf16 v[64:79], a[12:15], v[124:127], v[64:79]
    ds_read_b128 v[116:119], v4 offset:43008
    buffer_load_dwordx4 v1, s[4:7], s54 offen offset:1024 lds
    s_add_u32 m0, s55, 10240
    s_add_u32 s54, s54, 65536
    s_waitcnt lgkmcnt(5)
    v_mfma_f32_32x32x16_bf16 v[48:63], a[32:35], v[96:99], v[48:63]
    ds_read_b128 v[120:123], v4 offset:11264
    v_mul_f32 v22, v22, v30
    v_mul_f32 v23, v23, v31
    v_cvt_pk_bf16_f32 v8, v16, v17
    v_cvt_pk_bf16_f32 v9, v18, v19
    s_waitcnt lgkmcnt(5)
    v_mfma_f32_32x32x16_bf16 v[64:79], a[32:35], v[100:103], v[64:79]
    ds_read_b128 v[124:127], v4 offset:44032
    buffer_load_dwordx4 v12, s[4:7], s54 offen offset:0 lds
    v_cvt_pk_bf16_f32 v10, v20, v21
    v_cvt_pk_bf16_f32 v11, v22, v23
    s_waitcnt lgkmcnt(5)
    v_mfma_f32_32x32x16_bf16 v[48:63], a[36:39], v[104:107], v[48:63]
    ds_read_b128 v[96:99], v4 offset:16384
    buffer_store_dwordx4 v[8:11], v2, s[12:15], s58 offen
    s_waitcnt lgkmcnt(5)
    v_mfma_f32_32x32x16_bf16 v[64:79], a[36:39], v[108:111], v[64:79]
    ds_read_b128 v[100:103], v4 offset:49152
    buffer_store_dwordx4 v[8:11], v2, s[16:19], s58 offen sc1
    v_max_f32 v32, 0, v32
    s_waitcnt lgkmcnt(5)
    v_mfma_f32_32x32x16_bf16 v[48:63], a[40:43], v[112:115], v[48:63]
    ds_read_b128 v[104:107], v4 offset:17408
    buffer_load_dwordx4 v1, s[4:7], s54 offen offset:1024 lds
    s_add_u32 m0, s55, 12288
    s_add_u32 s54, s54, 65536
    s_waitcnt lgkmcnt(5)
    v_mfma_f32_32x32x16_bf16 v[64:79], a[40:43], v[116:119], v[64:79]
    ds_read_b128 v[108:111], v4 offset:50176
    v_max_f32 v33, 0, v33
    v_max_f32 v34, 0, v34
    v_max_f32 v35, 0, v35
    v_max_f32 v36, 0, v36
    s_waitcnt lgkmcnt(5)
    v_mfma_f32_32x32x16_bf16 v[48:63], a[44:47], v[120:123], v[48:63]
    ds_read_b128 v[112:115], v4 offset:18432
    v_max_f32 v37, 0, v37
    v_max_f32 v38, 0, v38
    v_max_f32 v39, 0, v39
    v_mul_f32 v32, v32, v40
    s_waitcnt lgkmcnt(5)
    v_mfma_f32_32x32x16_bf16 v[64:79], a[44:47], v[124:127], v[64:79]
    ds_read_b128 v[116:119], v4 offset:51200
    v_mul_f32 v33, v33, v41
    v_mul_f32 v34, v34, v42
    v_mul_f32 v35, v35, v43
    v_mul_f32 v36, v36, v44
    s_waitcnt lgkmcnt(5)
    v_mfma_f32_32x32x16_bf16 v[48:63], a[64:67], v[96:99], v[48:63]
    ds_read_b128 v[120:123], v4 offset:19456
    v_mul_f32 v37, v37, v45
    v_mul_f32 v38, v38, v46
    v_mul_f32 v39, v39, v47
    v_cvt_pk_bf16_f32 v8, v32, v33
    s_waitcnt lgkmcnt(5)
    v_mfma_f32_32x32x16_bf16 v[64:79], a[64:67], v[100:103], v[64:79]
    ds_read_b128 v[124:127], v4 offset:52224
    v_cvt_pk_bf16_f32 v9, v34, v35
    v_cvt_pk_bf16_f32 v10, v36, v37
    v_cvt_pk_bf16_f32 v11, v38, v39
    s_waitcnt lgkmcnt(5)
    v_mfma_f32_32x32x16_bf16 v[48:63], a[68:71], v[104:107], v[48:63]
    ds_read_b128 v[96:99], v4 offset:24576
    buffer_store_dwordx4 v[8:11], v2, s[12:15], s59 offen
    s_waitcnt lgkmcnt(5)
    v_mfma_f32_32x32x16_bf16 v[64:79], a[68:71], v[108:111], v[64:79]
    ds_read_b128 v[100:103], v4 offset:57344
    buffer_store_dwordx4 v[8:11], v2, s[16:19], s59 offen sc1
    s_waitcnt lgkmcnt(5)
    v_mfma_f32_32x32x16_bf16 v[48:63], a[72:75], v[112:115], v[48:63]
    ds_read_b128 v[104:107], v4 offset:25600
    s_waitcnt vmcnt(18)
    ds_read_b64_tr_b16 v[224:225], v13 offset:12288
    ds_read_b64_tr_b16 v[226:227], v13 offset:13312
    s_waitcnt lgkmcnt(7)
    v_mfma_f32_32x32x16_bf16 v[64:79], a[72:75], v[116:119], v[64:79]
    ds_read_b128 v[108:111], v4 offset:58368
    ds_read_b64_tr_b16 v[228:229], v14 offset:12288
    ds_read_b64_tr_b16 v[230:231], v14 offset:13312
    s_waitcnt lgkmcnt(9)
    v_mfma_f32_32x32x16_bf16 v[48:63], a[76:79], v[120:123], v[48:63]
    ds_read_b128 v[112:115], v4 offset:26624
    s_waitcnt vmcnt(16)
    ds_read_b64_tr_b16 v[232:233], v13 offset:14336
    ds_read_b64_tr_b16 v[234:235], v13 offset:15360
    s_waitcnt lgkmcnt(11)
    v_mfma_f32_32x32x16_bf16 v[64:79], a[76:79], v[124:127], v[64:79]
    ds_read_b128 v[116:119], v4 offset:59392
    ds_read_b64_tr_b16 v[236:237], v14 offset:14336
    ds_read_b64_tr_b16 v[238:239], v14 offset:15360
    s_waitcnt lgkmcnt(13)
    v_mfma_f32_32x32x16_bf16 v[48:63], a[96:99], v[96:99], v[48:63]
    ds_read_b128 v[120:123], v4 offset:27648
    s_waitcnt vmcnt(14)
    ds_read_b64_tr_b16 v[144:145], v13 offset:0
    ds_read_b64_tr_b16 v[146:147], v13 offset:1024
    s_waitcnt lgkmcnt(15)
    v_mfma_f32_32x32x16_bf16 v[64:79], a[96:99], v[100:103], v[64:79]
    ds_read_b128 v[124:127], v4 offset:60416
    ds_read_b64_tr_b16 v[148:149], v14 offset:0
    ds_read_b64_tr_b16 v[150:151], v14 offset:1024
    s_waitcnt lgkmcnt(15)
    v_mfma_f32_32x32x16_bf16 v[48:63], a[100:103], v[104:107], v[48:63]
    ds_read_b128 v[96:99], v4 offset:4096
    s_waitcnt vmcnt(12)
    ds_read_b64_tr_b16 v[152:153], v13 offset:2048
    ds_read_b64_tr_b16 v[154:155], v13 offset:3072
    s_waitcnt lgkmcnt(15)
    v_mfma_f32_32x32x16_bf16 v[64:79], a[100:103], v[108:111], v[64:79]
    ds_read_b128 v[100:103], v4 offset:36864
    ds_read_b64_tr_b16 v[156:157], v14 offset:2048
    ds_read_b64_tr_b16 v[158:159], v14 offset:3072
    s_waitcnt lgkmcnt(15)
    v_mfma_f32_32x32x16_bf16 v[48:63], a[104:107], v[112:115], v[48:63]
    ds_read_b128 v[104:107], v4 offset:5120
    s_waitcnt vmcnt(10)
    ds_read_b64_tr_b16 v[176:177], v13 offset:4096
    ds_read_b64_tr_b16 v[178:179], v13 offset:5120
    s_waitcnt lgkmcnt(15)
    v_mfma_f32_32x32x16_bf16 v[64:79], a[104:107], v[116:119], v[64:79]
    ds_read_b128 v[108:111], v4 offset:37888
    buffer_load_dwordx4 v12, s[4:7], s54 offen offset:0 lds
    ds_read_b64_tr_b16 v[180:181], v14 offset:4096
    ds_read_b64_tr_b16 v[182:183], v14 offset:5120
    s_waitcnt lgkmcnt(15)
    v_mfma_f32_32x32x16_bf16 v[48:63], a[108:111], v[120:123], v[48:63]
    ds_read_b128 v[112:115], v4 offset:6144
    s_waitcnt vmcnt(9)
    ds_read_b64_tr_b16 v[184:185], v13 offset:6144
    ds_read_b64_tr_b16 v[186:187], v13 offset:7168
    s_waitcnt lgkmcnt(15)
    v_mfma_f32_32x32x16_bf16 v[64:79], a[108:111], v[124:127], v[64:79]
    ds_read_b128 v[116:119], v4 offset:38912
    buffer_load_dwordx4 v1, s[4:7], s54 offen offset:1024 lds
    s_add_u32 m0, s55, 14336
    s_add_u32 s54, s54, 65536
    s_waitcnt lgkmcnt(15)
    v_mfma_f32_32x32x16_bf16 v[48:63], a[16:19], v[96:99], v[48:63]
    ds_read_b128 v[120:123], v4 offset:7168
    ds_read_b64_tr_b16 v[188:189], v14 offset:6144
    ds_read_b64_tr_b16 v[190:191], v14 offset:7168
    s_waitcnt lgkmcnt(15)
    v_mfma_f32_32x32x16_bf16 v[64:79], a[16:19], v[100:103], v[64:79]
    ds_read_b128 v[124:127], v4 offset:39936
    buffer_load_dwordx4 v12, s[4:7], s54 offen offset:0 lds
    s_waitcnt lgkmcnt(13)
    v_mfma_f32_32x32x16_bf16 v[48:63], a[20:23], v[104:107], v[48:63]
    ds_read_b128 v[96:99], v4 offset:12288
    s_waitcnt vmcnt(9)
    ds_read_b64_tr_b16 v[208:209], v13 offset:8192
    ds_read_b64_tr_b16 v[210:211], v13 offset:9216
    s_waitcnt lgkmcnt(13)
    v_mfma_f32_32x32x16_bf16 v[64:79], a[20:23], v[108:111], v[64:79]
    ds_read_b128 v[100:103], v4 offset:45056
    s_waitcnt vmcnt(3)
    buffer_store_dword v7, off, s[12:15], s60 offset:256
    s_waitcnt lgkmcnt(11)
    v_mfma_f32_32x32x16_bf16 v[48:63], a[24:27], v[112:115], v[48:63]
    ds_read_b128 v[104:107], v4 offset:13312
    buffer_load_dwordx4 v1, s[4:7], s54 offen offset:1024 lds
    s_add_u32 m0, s55, 0
    s_add_u32 s54, s54, 65536
    s_waitcnt lgkmcnt(9)
    v_mfma_f32_32x32x16_bf16 v[64:79], a[24:27], v[116:119], v[64:79]
    ds_read_b128 v[108:111], v4 offset:46080
    buffer_store_dword v7, off, s[16:19], s60 offset:256 sc1
    ds_read_b64_tr_b16 v[212:213], v14 offset:8192
    ds_read_b64_tr_b16 v[214:215], v14 offset:9216
    s_waitcnt lgkmcnt(11)
    v_mfma_f32_32x32x16_bf16 v[48:63], a[28:31], v[120:123], v[48:63]
    ds_read_b128 v[112:115], v4 offset:14336
    buffer_load_dwordx4 v12, s[4:7], s54 offen offset:0 lds
    s_waitcnt lgkmcnt(9)
    v_mfma_f32_32x32x16_bf16 v[64:79], a[28:31], v[124:127], v[64:79]
    ds_read_b128 v[116:119], v4 offset:47104
    ds_read_b64_tr_b16 v[216:217], v13 offset:10240
    ds_read_b64_tr_b16 v[218:219], v13 offset:11264
    s_waitcnt lgkmcnt(11)
    v_mfma_f32_32x32x16_bf16 v[48:63], a[48:51], v[96:99], v[48:63]
    ds_read_b128 v[120:123], v4 offset:15360
    buffer_load_dwordx4 v1, s[4:7], s54 offen offset:1024 lds
    s_add_u32 m0, s55, 2048
    s_add_u32 s54, s54, 65536
    s_waitcnt lgkmcnt(9)
    v_mfma_f32_32x32x16_bf16 v[64:79], a[48:51], v[100:103], v[64:79]
    ds_read_b128 v[124:127], v4 offset:48128
    ds_read_b64_tr_b16 v[220:221], v14 offset:10240
    ds_read_b64_tr_b16 v[222:223], v14 offset:11264
    s_waitcnt lgkmcnt(11)
    v_mfma_f32_32x32x16_bf16 v[48:63], a[52:55], v[104:107], v[48:63]
    ds_read_b128 v[96:99], v4 offset:20480
    s_waitcnt lgkmcnt(11)
    v_mfma_f32_32x32x16_bf16 v[64:79], a[52:55], v[108:111], v[64:79]
    ds_read_b128 v[100:103], v4 offset:53248
    buffer_load_dwordx4 v12, s[4:7], s54 offen offset:0 lds
    s_waitcnt lgkmcnt(9)
    v_mfma_f32_32x32x16_bf16 v[48:63], a[56:59], v[112:115], v[48:63]
    ds_read_b128 v[104:107], v4 offset:21504
    s_waitcnt lgkmcnt(9)
    v_mfma_f32_32x32x16_bf16 v[64:79], a[56:59], v[116:119], v[64:79]
    ds_read_b128 v[108:111], v4 offset:54272
    buffer_load_dwordx4 v1, s[4:7], s54 offen offset:1024 lds
    s_add_u32 m0, s55, 4096
    s_add_u32 s54, s54, 65536
    s_waitcnt lgkmcnt(7)
    v_mfma_f32_32x32x16_bf16 v[48:63], a[60:63], v[120:123], v[48:63]
    ds_read_b128 v[112:115], v4 offset:22528
    s_waitcnt lgkmcnt(7)
    v_mfma_f32_32x32x16_bf16 v[64:79], a[60:63], v[124:127], v[64:79]
    ds_read_b128 v[116:119], v4 offset:55296
    buffer_load_dwordx4 v12, s[4:7], s54 offen offset:0 lds
    s_waitcnt lgkmcnt(5)
    v_mfma_f32_32x32x16_bf16 v[48:63], a[80:83], v[96:99], v[48:63]
    ds_read_b128 v[120:123], v4 offset:23552
    s_waitcnt lgkmcnt(5)
    v_mfma_f32_32x32x16_bf16 v[64:79], a[80:83], v[100:103], v[64:79]
    ds_read_b128 v[124:127], v4 offset:56320
    s_waitcnt lgkmcnt(5)
    v_mfma_f32_32x32x16_bf16 v[48:63], a[84:87], v[104:107], v[48:63]
    ds_read_b128 v[96:99], v4 offset:28672
    buffer_load_dwordx4 v1, s[4:7], s54 offen offset:1024 lds
    s_add_u32 m0, s55, 6144
    s_add_u32 s54, s54, 65536
    s_waitcnt lgkmcnt(5)
    v_mfma_f32_32x32x16_bf16 v[64:79], a[84:87], v[108:111], v[64:79]
    ds_read_b128 v[100:103], v4 offset:61440
    s_waitcnt lgkmcnt(5)
    v_mfma_f32_32x32x16_bf16 v[48:63], a[88:91], v[112:115], v[48:63]
    ds_read_b128 v[104:107], v4 offset:29696
    buffer_load_dwordx4 v12, s[4:7], s54 offen offset:0 lds
    s_waitcnt lgkmcnt(5)
    v_mfma_f32_32x32x16_bf16 v[64:79], a[88:91], v[116:119], v[64:79]
    ds_read_b128 v[108:111], v4 offset:62464
    buffer_load_dword v5, v15, s[8:11], s46 offen offset:256 sc1
    s_waitcnt lgkmcnt(5)
    v_mfma_f32_32x32x16_bf16 v[48:63], a[92:95], v[120:123], v[48:63]
    ds_read_b128 v[112:115], v4 offset:30720
    buffer_load_dwordx4 v1, s[4:7], s54 offen offset:1024 lds
    s_add_u32 m0, s55, 8192
    s_add_u32 s54, s54, 65536
    s_waitcnt lgkmcnt(5)
    v_mfma_f32_32x32x16_bf16 v[64:79], a[92:95], v[124:127], v[64:79]
    ds_read_b128 v[116:119], v4 offset:63488
    s_waitcnt vmcnt(13)
    ds_read_b64_tr_b16 v[240:241], v13 offset:12288
    ds_read_b64_tr_b16 v[242:243], v13 offset:13312
    s_waitcnt lgkmcnt(7)
    v_mfma_f32_32x32x16_bf16 v[48:63], a[112:115], v[96:99], v[48:63]
    ds_read_b128 v[120:123], v4 offset:31744
    ds_read_b64_tr_b16 v[244:245], v14 offset:12288
    ds_read_b64_tr_b16 v[246:247], v14 offset:13312
    s_waitcnt lgkmcnt(9)
    v_mfma_f32_32x32x16_bf16 v[64:79], a[112:115], v[100:103], v[64:79]
    ds_read_b128 v[124:127], v4 offset:64512
    buffer_load_dwordx4 v12, s[4:7], s54 offen offset:0 lds
    s_waitcnt lgkmcnt(9)
    v_mfma_f32_32x32x16_bf16 v[48:63], a[116:119], v[104:107], v[48:63]
    ds_read_b128 v[96:99], v4 offset:0
    s_waitcnt lgkmcnt(9)
    v_mfma_f32_32x32x16_bf16 v[64:79], a[116:119], v[108:111], v[64:79]
    ds_read_b128 v[100:103], v4 offset:32768
    buffer_load_dwordx4 v1, s[4:7], s54 offen offset:1024 lds
    s_add_u32 m0, s55, 10240
    s_add_u32 s54, s54, 65536
    s_waitcnt lgkmcnt(9)
    v_mfma_f32_32x32x16_bf16 v[48:63], a[120:123], v[112:115], v[48:63]
    ds_read_b128 v[104:107], v4 offset:1024
    s_waitcnt vmcnt(12)
    ds_read_b64_tr_b16 v[248:249], v13 offset:14336
    ds_read_b64_tr_b16 v[250:251], v13 offset:15360
    s_waitcnt lgkmcnt(11)
    v_mfma_f32_32x32x16_bf16 v[64:79], a[120:123], v[116:119], v[64:79]
    ds_read_b128 v[108:111], v4 offset:33792
    buffer_load_dwordx4 v12, s[4:7], s54 offen offset:0 lds
    ds_read_b64_tr_b16 v[252:253], v14 offset:14336
    ds_read_b64_tr_b16 v[254:255], v14 offset:15360
    s_waitcnt lgkmcnt(11)
    v_mfma_f32_32x32x16_bf16 v[48:63], a[124:127], v[120:123], v[48:63]
    ds_read_b128 v[112:115], v4 offset:2048
    s_waitcnt lgkmcnt(9)
    v_mfma_f32_32x32x16_bf16 v[64:79], a[124:127], v[124:127], v[64:79]
    ds_read_b128 v[116:119], v4 offset:34816
    s_cmp_ge_u32 s45, 22
    s_cbranch_scc1 L_no_unit2
    s_waitcnt lgkmcnt(9)
    v_mfma_f32_32x32x16_bf16 v[16:31], a[128:131], v[96:99], 0
    ds_read_b128 v[120:123], v4 offset:3072
    buffer_load_dwordx4 v1, s[4:7], s54 offen offset:1024 lds
    s_waitcnt lgkmcnt(9)
    v_mfma_f32_32x32x16_bf16 v[32:47], a[128:131], v[100:103], 0
    ds_read_b128 v[124:127], v4 offset:35840
    s_waitcnt vmcnt(5)
    v_cmp_ne_u32 vcc, v7, v5
    s_nop 0
    s_cbranch_vccnz L_late_15
L_ok_16:
    s_waitcnt lgkmcnt(9)
    v_mfma_f32_32x32x16_bf16 v[16:31], a[132:135], v[104:107], v[16:31]
    ds_read_b128 v[96:99], v4 offset:8192
    buffer_load_dwordx4 a[96:99], v2, s[8:11], s56 offen sc1
    s_waitcnt lgkmcnt(7)
    v_mfma_f32_32x32x16_bf16 v[32:47], a[132:135], v[108:111], v[32:47]
    ds_read_b128 v[100:103], v4 offset:40960
    v_max_f32 v48, 0, v48
    v_max_f32 v49, 0, v49
    v_max_f32 v50, 0, v50
    v_max_f32 v51, 0, v51
    s_waitcnt lgkmcnt(5)
    v_mfma_f32_32x32x16_bf16 v[16:31], a[136:139], v[112:115], v[16:31]
    ds_read_b128 v[104:107], v4 offset:9216
    buffer_load_dwordx4 a[100:103], v2, s[8:11], s57 offen sc1
    s_add_u32 s56, s56, 4096
    v_max_f32 v52, 0, v52
    s_waitcnt lgkmcnt(5)
    v_mfma_f32_32x32x16_bf16 v[32:47], a[136:139], v[116:119], v[32:47]
    ds_read_b128 v[108:111], v4 offset:41984
    v_max_f32 v53, 0, v53
    v_max_f32 v54, 0, v54
    v_max_f32 v55, 0, v55
    v_mul_f32 v48, v48, v56
    s_waitcnt lgkmcnt(5)
    v_mfma_f32_32x32x16_bf16 v[16:31], a[140:143], v[120:123], v[16:31]
    ds_read_b128 v[112:115], v4 offset:10240
    buffer_load_dwordx4 a[104:107], v2, s[8:11], s56 offen sc1
    s_add_u32 s57, s57, 4096
    v_mul_f32 v49, v49, v57
    s_waitcnt lgkmcnt(5)
    v_mfma_f32_32x32x16_bf16 v[32:47], a[140:143], v[124:127], v[32:47]
    ds_read_b128 v[116:119], v4 offset:43008
    v_mul_f32 v50, v50, v58
    v_mul_f32 v51, v51, v59
    v_mul_f32 v52, v52, v60
    v_mul_f32 v53, v53, v61
    s_waitcnt lgkmcnt(5)
    v_mfma_f32_32x32x16_bf16 v[16:31], a[160:163], v[96:99], v[16:31]
    ds_read_b128 v[120:123], v4 offset:11264
    buffer_load_dwordx4 a[108:111], v2, s[8:11], s57 offen sc1
    s_add_u32 s56, s56, 4096
    v_mul_f32 v54, v54, v62
    s_waitcnt lgkmcnt(5)
    v_mfma_f32_32x32x16_bf16 v[32:47], a[160:163], v[100:103], v[32:47]
    ds_read_b128 v[124:127], v4 offset:44032
    v_mul_f32 v55, v55, v63
    v_cvt_pk_bf16_f32 v8, v48, v49
    v_cvt_pk_bf16_f32 v9, v50, v51
    v_cvt_pk_bf16_f32 v10, v52, v53
    s_waitcnt lgkmcnt(5)
    v_mfma_f32_32x32x16_bf16 v[16:31], a[164:167], v[104:107], v[16:31]
    ds_read_b128 v[96:99], v4 offset:16384
    buffer_load_dwordx4 a[16:19], v2, s[8:11], s56 offen sc1
    s_add_u32 s57, s57, 4096
    v_cvt_pk_bf16_f32 v11, v54, v55
    s_waitcnt lgkmcnt(5)
    v_mfma_f32_32x32x16_bf16 v[32:47], a[164:167], v[108:111], v[32:47]
    ds_read_b128 v[100:103], v4 offset:49152
    buffer_store_dwordx4 v[8:11], v2, s[68:71], s63 offen
    s_waitcnt lgkmcnt(5)
    v_mfma_f32_32x32x16_bf16 v[16:31], a[168:171], v[112:115], v[16:31]
    ds_read_b128 v[104:107], v4 offset:17408
    buffer_load_dwordx4 a[20:23], v2, s[8:11], s57 offen sc1
    s_add_u32 s56, s56, 4096
    s_waitcnt lgkmcnt(5)
    v_mfma_f32_32x32x16_bf16 v[32:47], a[168:171], v[116:119], v[32:47]
    ds_read_b128 v[108:111], v4 offset:50176
    buffer_store_dwordx4 v[8:11], v2, s[72:75], s63 offen sc1
    v_max_f32 v64, 0, v64
    s_waitcnt lgkmcnt(5)
    v_mfma_f32_32x32x16_bf16 v[16:31], a[172:175], v[120:123], v[16:31]
    ds_read_b128 v[112:115], v4 offset:18432
    buffer_load_dwordx4 a[24:27], v2, s[8:11], s56 offen sc1
    s_add_u32 s57, s57, 4096
    v_max_f32 v65, 0, v65
    s_waitcnt lgkmcnt(5)
    v_mfma_f32_32x32x16_bf16 v[32:47], a[172:175], v[124:127], v[32:47]
    ds_read_b128 v[116:119], v4 offset:51200
    v_max_f32 v66, 0, v66
    v_max_f32 v67, 0, v67
    v_max_f32 v68, 0, v68
    v_max_f32 v69, 0, v69
    s_waitcnt lgkmcnt(5)
    v_mfma_f32_32x32x16_bf16 v[16:31], a[192:195], v[96:99], v[16:31]
    ds_read_b128 v[120:123], v4 offset:19456
    buffer_load_dwordx4 a[28:31], v2, s[8:11], s57 offen sc1
    s_add_u32 s56, s56, 4096
    v_max_f32 v70, 0, v70
    s_waitcnt lgkmcnt(5)
    v_mfma_f32_32x32x16_bf16 v[32:47], a[192:195], v[100:103], v[32:47]
    ds_read_b128 v[124:127], v4 offset:52224
    v_max_f32 v71, 0, v71
    v_mul_f32 v64, v64, v72
    v_mul_f32 v65, v65, v73
    v_mul_f32 v66, v66, v74
    s_waitcnt lgkmcnt(5)
    v_mfma_f32_32x32x16_bf16 v[16:31], a[196:199], v[104:107], v[16:31]
    ds_read_b128 v[96:99], v4 offset:24576
    buffer_load_dwordx4 a[48:51], v2, s[8:11], s56 offen sc1
    s_add_u32 s57, s57, 4096
    v_mul_f32 v67, v67, v75
    s_waitcnt lgkmcnt(5)
    v_mfma_f32_32x32x16_bf16 v[32:47], a[196:199], v[108:111], v[32:47]
    ds_read_b128 v[100:103], v4 offset:57344
    v_mul_f32 v68, v68, v76
    v_mul_f32 v69, v69, v77
    v_mul_f32 v70, v70, v78
    v_mul_f32 v71, v71, v79
    s_waitcnt lgkmcnt(5)
    v_mfma_f32_32x32x16_bf16 v[16:31], a[200:203], v[112:115], v[16:31]
    ds_read_b128 v[104:107], v4 offset:25600
    buffer_load_dwordx4 a[52:55], v2, s[8:11], s57 offen sc1
    s_add_u32 s56, s56, 4096
    v_cvt_pk_bf16_f32 v8, v64, v65
    s_waitcnt lgkmcnt(5)
    v_mfma_f32_32x32x16_bf16 v[32:47], a[200:203], v[116:119], v[32:47]
    ds_read_b128 v[108:111], v4 offset:58368
    v_cvt_pk_bf16_f32 v9, v66, v67
    v_cvt_pk_bf16_f32 v10, v68, v69
    v_cvt_pk_bf16_f32 v11, v70, v71
    s_waitcnt lgkmcnt(5)
    v_mfma_f32_32x32x16_bf16 v[16:31], a[204:207], v[120:123], v[16:31]
    ds_read_b128 v[112:115], v4 offset:26624
    buffer_load_dwordx4 a[56:59], v2, s[8:11], s56 offen sc1
    s_add_u32 s57, s57, 4096
    s_waitcnt lgkmcnt(5)
    v_mfma_f32_32x32x16_bf16 v[32:47], a[204:207], v[124:127], v[32:47]
    ds_read_b128 v[116:119], v4 offset:59392
    buffer_store_dwordx4 v[8:11], v2, s[68:71], s64 offen
    s_waitcnt lgkmcnt(5)
    v_mfma_f32_32x32x16_bf16 v[16:31], a[224:227], v[96:99], v[16:31]
    ds_read_b128 v[120:123], v4 offset:27648
    buffer_load_dwordx4 a[60:63], v2, s[8:11], s57 offen sc1
    s_add_u32 s56, s56, 4096
    s_waitcnt lgkmcnt(5)
    v_mfma_f32_32x32x16_bf16 v[32:47], a[224:227], v[100:103], v[32:47]
    ds_read_b128 v[124:127], v4 offset:60416
    buffer_store_dwordx4 v[8:11], v2, s[72:75], s64 offen sc1
    s_waitcnt lgkmcnt(5)
    v_mfma_f32_32x32x16_bf16 v[16:31], a[228:231], v[104:107], v[16:31]
    ds_read_b128 v[96:99], v4 offset:4096
    buffer_load_dwordx4 a[80:83], v2, s[8:11], s56 offen sc1
    s_add_u32 s57, s57, 4096
    s_waitcnt lgkmcnt(5)
    v_mfma_f32_32x32x16_bf16 v[32:47], a[228:231], v[108:111], v[32:47]
    ds_read_b128 v[100:103], v4 offset:36864
    ds_read_b64_tr_b16 a[0:1], v13 offset:0
    ds_read_b64_tr_b16 a[2:3], v13 offset:1024
    s_waitcnt lgkmcnt(7)
    v_mfma_f32_32x32x16_bf16 v[16:31], a[232:235], v[112:115], v[16:31]
    ds_read_b128 v[104:107], v4 offset:5120
    buffer_load_dwordx4 a[84:87], v2, s[8:11], s57 offen sc1
    s_add_u32 s56, s56, 4096
    s_waitcnt lgkmcnt(7)
    v_mfma_f32_32x32x16_bf16 v[32:47], a[232:235], v[116:119], v[32:47]
    ds_read_b128 v[108:111], v4 offset:37888
    ds_read_b64_tr_b16 a[4:5], v14 offset:0
    ds_read_b64_tr_b16 a[6:7], v14 offset:1024
    s_waitcnt lgkmcnt(9)
    v_mfma_f32_32x32x16_bf16 v[16:31], a[236:239], v[120:123], v[16:31]
    ds_read_b128 v[112:115], v4 offset:6144
    buffer_load_dwordx4 a[88:91], v2, s[8:11], s56 offen sc1
    s_add_u32 s57, s57, 4096
    s_waitcnt lgkmcnt(9)
    v_mfma_f32_32x32x16_bf16 v[32:47], a[236:239], v[124:127], v[32:47]
    ds_read_b128 v[116:119], v4 offset:38912
    ds_read_b64_tr_b16 a[8:9], v13 offset:2048
    ds_read_b64_tr_b16 a[10:11], v13 offset:3072
    s_waitcnt lgkmcnt(11)
    v_mfma_f32_32x32x16_bf16 v[16:31], a[144:147], v[96:99], v[16:31]
    ds_read_b128 v[120:123], v4 offset:7168
    buffer_load_dwordx4 a[92:95], v2, s[8:11], s57 offen sc1
    s_add_u32 s56, s56, 4290744320
    s_waitcnt lgkmcnt(11)
    v_mfma_f32_32x32x16_bf16 v[32:47], a[144:147], v[100:103], v[32:47]
    ds_read_b128 v[124:127], v4 offset:39936
    ds_read_b64_tr_b16 a[12:13], v14 offset:2048
    ds_read_b64_tr_b16 a[14:15], v14 offset:3072
    s_waitcnt lgkmcnt(11)
    v_mfma_f32_32x32x16_bf16 v[16:31], a[148:151], v[104:107], v[16:31]
    ds_read_b128 v[96:99], v4 offset:12288
    ds_read_b64_tr_b16 a[32:33], v13 offset:4096
    ds_read_b64_tr_b16 a[34:35], v13 offset:5120
    s_waitcnt lgkmcnt(13)
    v_mfma_f32_32x32x16_bf16 v[32:47], a[148:151], v[108:111], v[32:47]
    ds_read_b128 v[100:103], v4 offset:45056
    ds_read_b64_tr_b16 a[36:37], v14 offset:4096
    ds_read_b64_tr_b16 a[38:39], v14 offset:5120
    s_waitcnt lgkmcnt(13)
    v_mfma_f32_32x32x16_bf16 v[16:31], a[152:155], v[112:115], v[16:31]
    ds_read_b128 v[104:107], v4 offset:13312
    s_waitcnt vmcnt(24)
    ds_read_b64_tr_b16 a[40:41], v13 offset:6144
    ds_read_b64_tr_b16 a[42:43], v13 offset:7168
    s_waitcnt lgkmcnt(15)
    v_mfma_f32_32x32x16_bf16 v[32:47], a[152:155], v[116:119], v[32:47]
    ds_read_b128 v[108:111], v4 offset:46080
    ds_read_b64_tr_b16 a[44:45], v14 offset:6144
    ds_read_b64_tr_b16 a[46:47], v14 offset:7168
    s_waitcnt lgkmcnt(15)
    v_mfma_f32_32x32x16_bf16 v[16:31], a[156:159], v[120:123], v[16:31]
    ds_read_b128 v[112:115], v4 offset:14336
    s_waitcnt vmcnt(22)
    ds_read_b64_tr_b16 a[64:65], v13 offset:8192
    ds_read_b64_tr_b16 a[66:67], v13 offset:9216
    s_waitcnt lgkmcnt(15)
    v_mfma_f32_32x32x16_bf16 v[32:47], a[156:159], v[124:127], v[32:47]
    ds_read_b128 v[116:119], v4 offset:47104
    ds_read_b64_tr_b16 a[68:69], v14 offset:8192
    ds_read_b64_tr_b16 a[70:71], v14 offset:9216
    s_waitcnt lgkmcnt(15)
    v_mfma_f32_32x32x16_bf16 v[16:31], a[176:179], v[96:99], v[16:31]
    ds_read_b128 v[120:123], v4 offset:15360
    s_waitcnt vmcnt(20)
    ds_read_b64_tr_b16 a[72:73], v13 offset:10240
    ds_read_b64_tr_b16 a[74:75], v13 offset:11264
    s_waitcnt lgkmcnt(15)
    v_mfma_f32_32x32x16_bf16 v[32:47], a[176:179], v[100:103], v[32:47]
    ds_read_b128 v[124:127], v4 offset:48128
    ds_read_b64_tr_b16 a[76:77], v14 offset:10240
    ds_read_b64_tr_b16 a[78:79], v14 offset:11264
    s_waitcnt lgkmcnt(15)
    v_mfma_f32_32x32x16_bf16 v[16:31], a[180:183], v[104:107], v[16:31]
    ds_read_b128 v[96:99], v4 offset:20480
    s_waitcnt lgkmcnt(15)
    v_mfma_f32_32x32x16_bf16 v[32:47], a[180:183], v[108:111], v[32:47]
    ds_read_b128 v[100:103], v4 offset:53248
    s_waitcnt vmcnt(0)
    buffer_store_dword v7, off, s[12:15], s60 offset:384
    s_waitcnt lgkmcnt(13)
    v_mfma_f32_32x32x16_bf16 v[16:31], a[184:187], v[112:115], v[16:31]
    ds_read_b128 v[104:107], v4 offset:21504
    buffer_store_dword v7, off, s[16:19], s60 offset:384 sc1
    s_waitcnt lgkmcnt(11)
    v_mfma_f32_32x32x16_bf16 v[32:47], a[184:187], v[116:119], v[32:47]
    ds_read_b128 v[108:111], v4 offset:54272
    s_waitcnt lgkmcnt(9)
    v_mfma_f32_32x32x16_bf16 v[16:31], a[188:191], v[120:123], v[16:31]
    ds_read_b128 v[112:115], v4 offset:22528
    s_waitcnt lgkmcnt(7)
    v_mfma_f32_32x32x16_bf16 v[32:47], a[188:191], v[124:127], v[32:47]
    ds_read_b128 v[116:119], v4 offset:55296
    s_waitcnt lgkmcnt(5)
    v_mfma_f32_32x32x16_bf16 v[16:31], a[208:211], v[96:99], v[16:31]
    ds_read_b128 v[120:123], v4 offset:23552
    s_waitcnt lgkmcnt(5)
    v_mfma_f32_32x32x16_bf16 v[32:47], a[208:211], v[100:103], v[32:47]
    ds_read_b128 v[124:127], v4 offset:56320
    s_waitcnt lgkmcnt(5)
    v_mfma_f32_32x32x16_bf16 v[16:31], a[212:215], v[104:107], v[16:31]
    ds_read_b128 v[96:99], v4 offset:28672
    s_waitcnt lgkmcnt(5)
    v_mfma_f32_32x32x16_bf16 v[32:47], a[212:215], v[108:111], v[32:47]
    ds_read_b128 v[100:103], v4 offset:61440
    s_waitcnt lgkmcnt(5)
    v_mfma_f32_32x32x16_bf16 v[16:31], a[216:219], v[112:115], v[16:31]
    ds_read_b128 v[104:107], v4 offset:29696
    s_waitcnt lgkmcnt(5)
    v_mfma_f32_32x32x16_bf16 v[32:47], a[216:219], v[116:119], v[32:47]
    ds_read_b128 v[108:111], v4 offset:62464
    s_waitcnt lgkmcnt(5)
    v_mfma_f32_32x32x16_bf16 v[16:31], a[220:223], v[120:123], v[16:31]
    ds_read_b128 v[112:115], v4 offset:30720
    buffer_load_dword v5, v15, s[8:11], s46 offen offset:384 sc1
    s_waitcnt lgkmcnt(5)
    v_mfma_f32_32x32x16_bf16 v[32:47], a[220:223], v[124:127], v[32:47]
    ds_read_b128 v[116:119], v4 offset:63488
    s_waitcnt lgkmcnt(5)
    v_mfma_f32_32x32x16_bf16 v[16:31], a[240:243], v[96:99], v[16:31]
    ds_read_b128 v[120:123], v4 offset:31744
    s_waitcnt lgkmcnt(5)
    v_mfma_f32_32x32x16_bf16 v[32:47], a[240:243], v[100:103], v[32:47]
    ds_read_b128 v[124:127], v4 offset:64512
    s_waitcnt lgkmcnt(5)
    v_mfma_f32_32x32x16_bf16 v[16:31], a[244:247], v[104:107], v[16:31]
    s_waitcnt lgkmcnt(4)
    v_mfma_f32_32x32x16_bf16 v[32:47], a[244:247], v[108:111], v[32:47]
    s_waitcnt lgkmcnt(3)
    v_mfma_f32_32x32x16_bf16 v[16:31], a[248:251], v[112:115], v[16:31]
    s_waitcnt lgkmcnt(2)
    v_mfma_f32_32x32x16_bf16 v[32:47], a[248:251], v[116:119], v[32:47]
    s_waitcnt lgkmcnt(1)
    v_mfma_f32_32x32x16_bf16 v[16:31], a[252:255], v[120:123], v[16:31]
    s_waitcnt lgkmcnt(0)
    v_mfma_f32_32x32x16_bf16 v[32:47], a[252:255], v[124:127], v[32:47]
L_up_done:
    v_mfma_f32_32x32x16_bf16 v[48:63], v[132:135], a[96:99], 0
    v_mfma_f32_32x32x16_bf16 v[64:79], v[132:135], a[100:103], 0
    s_waitcnt vmcnt(0)
    v_cmp_ne_u32 vcc, v7, v5
    s_nop 0
    s_cbranch_vccnz L_late_18
L_ok_19:
    s_nop 3
    v_max_f32 v16, 0, v16
    v_mfma_f32_32x32x16_bf16 v[48:63], v[140:143], a[104:107], v[48:63]
    v_max_f32 v17, 0, v17
    v_max_f32 v18, 0, v18
    v_max_f32 v19, 0, v19
    v_max_f32 v20, 0, v20
    v_max_f32 v21, 0, v21
    v_mfma_f32_32x32x16_bf16 v[64:79], v[140:143], a[108:111], v[64:79]
    v_max_f32 v22, 0, v22
    v_max_f32 v23, 0, v23
    v_mul_f32 v16, v16, v24
    v_mul_f32 v17, v17, v25
    v_mul_f32 v18, v18, v26
    v_mfma_f32_32x32x16_bf16 v[48:63], v[164:167], a[16:19], v[48:63]
    v_mul_f32 v19, v19, v27
    v_mul_f32 v20, v20, v28
    v_mul_f32 v21, v21, v29
    v_mul_f32 v22, v22, v30
    v_mul_f32 v23, v23, v31
    v_mfma_f32_32x32x16_bf16 v[64:79], v[164:167], a[20:23], v[64:79]
    v_cvt_pk_bf16_f32 v8, v16, v17
    v_cvt_pk_bf16_f32 v9, v18, v19
    v_cvt_pk_bf16_f32 v10, v20, v21
    v_cvt_pk_bf16_f32 v11, v22, v23
    v_mfma_f32_32x32x16_bf16 v[48:63], v[172:175], a[24:27], v[48:63]
    buffer_store_dwordx4 v[8:11], v2, s[12:15], s58 offen
    v_mfma_f32_32x32x16_bf16 v[64:79], v[172:175], a[28:31], v[64:79]
    buffer_store_dwordx4 v[8:11], v2, s[16:19], s58 offen sc1
    v_max_f32 v32, 0, v32
    v_max_f32 v33, 0, v33
    v_mfma_f32_32x32x16_bf16 v[48:63], v[196:199], a[48:51], v[48:63]
    v_max_f32 v34, 0, v34
    v_max_f32 v35, 0, v35
    v_max_f32 v36, 0, v36
    v_max_f32 v37, 0, v37
    v_max_f32 v38, 0, v38
    v_mfma_f32_32x32x16_bf16 v[64:79], v[196:199], a[52:55], v[64:79]
    v_max_f32 v39, 0, v39
    v_mul_f32 v32, v32, v40
    v_mul_f32 v33, v33, v41
    v_mul_f32 v34, v34, v42
    v_mul_f32 v35, v35, v43
    v_mfma_f32_32x32x16_bf16 v[48:63], v[204:207], a[56:59], v[48:63]
    v_mul_f32 v36, v36, v44
    v_mul_f32 v37, v37, v45
    v_mul_f32 v38, v38, v46
    v_mul_f32 v39, v39, v47
    v_cvt_pk_bf16_f32 v8, v32, v33
    v_mfma_f32_32x32x16_bf16 v[64:79], v[204:207], a[60:63], v[64:79]
    v_cvt_pk_bf16_f32 v9, v34, v35
    v_cvt_pk_bf16_f32 v10, v36, v37
    v_cvt_pk_bf16_f32 v11, v38, v39
    v_mfma_f32_32x32x16_bf16 v[48:63], v[228:231], a[80:83], v[48:63]
    buffer_store_dwordx4 v[8:11], v2, s[12:15], s59 offen
    v_mfma_f32_32x32x16_bf16 v[64:79], v[228:231], a[84:87], v[64:79]
    buffer_store_dwordx4 v[8:11], v2, s[16:19], s59 offen sc1
    v_mfma_f32_32x32x16_bf16 v[16:31], v[128:131], a[96:99], 0
    buffer_load_dwordx4 a[112:115], v2, s[24:27], s56 offen sc1
    s_add_u32 s57, s57, 4290744320
    v_mfma_f32_32x32x16_bf16 v[32:47], v[128:131], a[100:103], 0
    v_mfma_f32_32x32x16_bf16 v[16:31], v[136:139], a[104:107], v[16:31]
    buffer_load_dwordx4 a[116:119], v2, s[24:27], s57 offen sc1
    s_add_u32 s56, s56, 4096
    v_mfma_f32_32x32x16_bf16 v[32:47], v[136:139], a[108:111], v[32:47]
    v_mfma_f32_32x32x16_bf16 v[16:31], v[160:163], a[16:19], v[16:31]
    buffer_load_dwordx4 a[120:123], v2, s[24:27], s56 offen sc1
    s_add_u32 s57, s57, 4096
    v_mfma_f32_32x32x16_bf16 v[32:47], v[160:163], a[20:23], v[32:47]
    v_mfma_f32_32x32x16_bf16 v[16:31], v[168:171], a[24:27], v[16:31]
    buffer_load_dwordx4 a[124:127], v2, s[24:27], s57 offen sc1
    s_add_u32 s56, s56, 4096
    v_mfma_f32_32x32x16_bf16 v[32:47], v[168:171], a[28:31], v[32:47]
    v_mfma_f32_32x32x16_bf16 v[16:31], v[192:195], a[48:51], v[16:31]
    buffer_load_dwordx4 a[128:131], v2, s[24:27], s56 offen sc1
    s_add_u32 s57, s57, 4096
    v_mfma_f32_32x32x16_bf16 v[32:47], v[192:195], a[52:55], v[32:47]
    v_mfma_f32_32x32x16_bf16 v[16:31], v[200:203], a[56:59], v[16:31]
    buffer_load_dwordx4 a[132:135], v2, s[24:27], s57 offen sc1
    s_add_u32 s56, s56, 4096
    v_mfma_f32_32x32x16_bf16 v[32:47], v[200:203], a[60:63], v[32:47]
    v_mfma_f32_32x32x16_bf16 v[16:31], v[224:227], a[80:83], v[16:31]
    buffer_load_dwordx4 a[136:139], v2, s[24:27], s56 offen sc1
    s_add_u32 s57, s57, 4096
    v_mfma_f32_32x32x16_bf16 v[32:47], v[224:227], a[84:87], v[32:47]
    s_waitcnt vmcnt(7)
    buffer_store_dword v7, off, s[12:15], s60 offset:512
    buffer_store_dword v7, off, s[16:19], s60 offset:512 sc1
    v_mfma_f32_32x32x16_bf16 v[16:31], v[232:235], a[88:91], v[16:31]
    buffer_load_dwordx4 a[140:143], v2, s[24:27], s57 offen sc1
    s_add_u32 s56, s56, 4096
    v_mfma_f32_32x32x16_bf16 v[32:47], v[232:235], a[92:95], v[32:47]
    v_mfma_f32_32x32x16_bf16 v[48:63], v[236:239], a[88:91], v[48:63]
    buffer_load_dwordx4 a[160:163], v2, s[24:27], s56 offen sc1
    s_add_u32 s57, s57, 4096
    v_mfma_f32_32x32x16_bf16 v[64:79], v[236:239], a[92:95], v[64:79]
    s_waitcnt vmcnt(10)
    v_mfma_f32_32x32x16_bf16 v[16:31], v[144:147], a[112:115], v[16:31]
    buffer_load_dwordx4 a[164:167], v2, s[24:27], s57 offen sc1
    s_add_u32 s56, s56, 4096
    s_waitcnt vmcnt(10)
    v_mfma_f32_32x32x16_bf16 v[32:47], v[144:147], a[116:119], v[32:47]
    v_mfma_f32_32x32x16_bf16 v[48:63], v[148:151], a[112:115], v[48:63]
    buffer_load_dwordx4 a[168:171], v2, s[24:27], s56 offen sc1
    s_add_u32 s57, s57, 4096
    v_mfma_f32_32x32x16_bf16 v[64:79], v[148:151], a[116:119], v[64:79]
    s_waitcnt vmcnt(10)
    v_mfma_f32_32x32x16_bf16 v[16:31], v[152:155], a[120:123], v[16:31]
    buffer_load_dwordx4 a[172:175], v2, s[24:27], s57 offen sc1
    s_add_u32 s56, s56, 4096
    buffer_load_dword v5, v3, s[8:11], s61 offen offset:512 sc1
    s_waitcnt vmcnt(11)
    v_mfma_f32_32x32x16_bf16 v[32:47], v[152:155], a[124:127], v[32:47]
    v_mfma_f32_32x32x16_bf16 v[48:63], v[156:159], a[120:123], v[48:63]
    buffer_load_dwordx4 a[192:195], v2, s[24:27], s56 offen sc1
    s_add_u32 s57, s57, 4096
    v_mfma_f32_32x32x16_bf16 v[64:79], v[156:159], a[124:127], v[64:79]
    s_waitcnt vmcnt(11)
    v_mfma_f32_32x32x16_bf16 v[16:31], v[176:179], a[128:131], v[16:31]
    buffer_load_dwordx4 a[196:199], v2, s[24:27], s57 offen sc1
    s_add_u32 s56, s56, 4096
    s_waitcnt vmcnt(11)
    v_mfma_f32_32x32x16_bf16 v[32:47], v[176:179], a[132:135], v[32:47]
    v_mfma_f32_32x32x16_bf16 v[48:63], v[180:183], a[128:131], v[48:63]
    buffer_load_dwordx4 a[200:203], v2, s[24:27], s56 offen sc1
    s_add_u32 s57, s57, 4096
    v_mfma_f32_32x32x16_bf16 v[64:79], v[180:183], a[132:135], v[64:79]
    s_waitcnt vmcnt(11)
    v_mfma_f32_32x32x16_bf16 v[16:31], v[184:187], a[136:139], v[16:31]
    buffer_load_dwordx4 a[204:207], v2, s[24:27], s57 offen sc1
    s_add_u32 s56, s56, 4186112
    s_waitcnt vmcnt(9)
    v_mfma_f32_32x32x16_bf16 v[32:47], v[184:187], a[140:143], v[32:47]
    v_mfma_f32_32x32x16_bf16 v[48:63], v[188:191], a[136:139], v[48:63]
    s_waitcnt vmcnt(4)
    v_cmp_ne_u32 vcc, v7, v5
    s_nop 0
    s_cbranch_vccnz L_late_21
L_ok_22:
    v_mfma_f32_32x32x16_bf16 v[64:79], v[188:191], a[140:143], v[64:79]
    buffer_load_dwordx4 a[184:187], v2, s[8:11], s56 offen sc1
    s_add_u32 s57, s57, 4186112
    v_mfma_f32_32x32x16_bf16 v[16:31], v[208:211], a[160:163], v[16:31]
    buffer_load_dwordx4 a[188:191], v2, s[8:11], s57 offen sc1
    s_add_u32 s57, s57, 4294946816
    v_mfma_f32_32x32x16_bf16 v[32:47], v[208:211], a[164:167], v[32:47]
    v_mfma_f32_32x32x16_bf16 v[48:63], v[212:215], a[160:163], v[48:63]
    buffer_load_dwordx4 a[228:231], v2, s[8:11], s57 offen sc1
    s_add_u32 s57, s57, 4096
    v_mfma_f32_32x32x16_bf16 v[64:79], v[212:215], a[164:167], v[64:79]
    buffer_load_dwordx4 a[236:239], v2, s[8:11], s57 offen sc1
    s_add_u32 s57, s57, 4096
    v_mfma_f32_32x32x16_bf16 v[16:31], v[216:219], a[168:171], v[16:31]
    v_add_u32 v8, s55, v2
    s_xor_b32 s38, s32, 1
    s_lshl_b32 s38, s38, 14
    v_add_u32 v9, s38, v2
    v_mfma_f32_32x32x16_bf16 v[32:47], v[216:219], a[172:175], v[32:47]
    buffer_load_dwordx4 a[148:151], v2, s[8:11], s57 offen sc1
    s_add_u32 s57, s57, 4096
    v_mfma_f32_32x32x16_bf16 v[48:63], v[220:223], a[168:171], v[48:63]
    buffer_load_dwordx4 a[156:159], v2, s[8:11], s57 offen sc1
    s_add_u32 s57, s57, 4096
    v_mfma_f32_32x32x16_bf16 v[64:79], v[220:223], a[172:175], v[64:79]
    s_waitcnt vmcnt(6)
    buffer_store_dword v7, off, s[12:15], s60 offset:640
    buffer_store_dword v7, off, s[16:19], s60 offset:640 sc1
    v_mfma_f32_32x32x16_bf16 v[16:31], v[240:243], a[192:195], v[16:31]
    buffer_load_dwordx4 a[180:183], v2, s[8:11], s57 offen sc1
    s_add_u32 s56, s56, 4294946816
    v_mfma_f32_32x32x16_bf16 v[32:47], v[240:243], a[196:199], v[32:47]
    buffer_load_dwordx4 a[224:227], v2, s[8:11], s56 offen sc1
    s_add_u32 s56, s56, 4096
    v_mfma_f32_32x32x16_bf16 v[48:63], v[244:247], a[192:195], v[48:63]
    s_xor_b32 s38, s32, 2
    s_lshl_b32 s38, s38, 14
    v_add_u32 v10, s38, v2
    v_mfma_f32_32x32x16_bf16 v[64:79], v[244:247], a[196:199], v[64:79]
    buffer_load_dwordx4 a[232:235], v2, s[8:11], s56 offen sc1
    s_add_u32 s56, s56, 4096
    s_waitcnt lgkmcnt(15)
    v_mfma_f32_32x32x16_bf16 v[16:31], v[248:251], a[200:203], v[16:31]
    buffer_load_dwordx4 a[144:147], v2, s[8:11], s56 offen sc1
    s_add_u32 s56, s56, 4096
    v_mfma_f32_32x32x16_bf16 v[32:47], v[248:251], a[204:207], v[32:47]
    s_xor_b32 s38, s32, 3
    s_lshl_b32 s38, s38, 14
    v_add_u32 v11, s38, v2
    ds_read_b128 v[96:99], v6 offset:768
    v_mfma_f32_32x32x16_bf16 v[48:63], v[252:255], a[200:203], v[48:63]
    buffer_load_dwordx4 a[152:155], v2, s[8:11], s56 offen sc1
    s_add_u32 s56, s56, 4096
    ds_read_b128 v[100:103], v6 offset:800
    v_mfma_f32_32x32x16_bf16 v[64:79], v[252:255], a[204:207], v[64:79]
    buffer_load_dwordx4 a[176:179], v2, s[8:11], s56 offen sc1
    s_cmp_ge_u32 s32, 2
    s_cbranch_scc1 L_down_tail
    s_waitcnt vmcnt(13) lgkmcnt(4)
    v_mfma_f32_32x32x16_bf16 v[16:31], a[72:75], a[184:187], v[16:31]
    s_waitcnt vmcnt(12)
    v_mfma_f32_32x32x16_bf16 v[32:47], a[72:75], a[188:191], v[32:47]
    s_waitcnt lgkmcnt(2)
    v_mfma_f32_32x32x16_bf16 v[48:63], a[76:79], a[184:187], v[48:63]
    v_mfma_f32_32x32x16_bf16 v[64:79], a[76:79], a[188:191], v[64:79]
L_down_tail:
    s_waitcnt vmcnt(11)
    v_mfma_f32_32x32x16_bf16 v[64:79], a[4:7], a[228:231], v[64:79]
    ds_read_b128 v[104:107], v6 offset:832
    ds_read_b128 v[108:111], v6 offset:864
    s_waitcnt vmcnt(10)
    v_mfma_f32_32x32x16_bf16 v[64:79], a[12:15], a[236:239], v[64:79]
    s_waitcnt vmcnt(9) lgkmcnt(15)
    v_mfma_f32_32x32x16_bf16 v[64:79], a[36:39], a[148:151], v[64:79]
    s_waitcnt vmcnt(8) lgkmcnt(12)
    v_mfma_f32_32x32x16_bf16 v[64:79], a[44:47], a[156:159], v[64:79]
    s_waitcnt vmcnt(5) lgkmcnt(8)
    v_mfma_f32_32x32x16_bf16 v[64:79], a[68:71], a[180:183], v[64:79]
    s_nop 4
    s_waitcnt vmcnt(4)
    v_mfma_f32_32x32x16_bf16 v[48:63], a[4:7], a[224:227], v[48:63]
    s_nop 4
    s_waitcnt vmcnt(3)
    v_mfma_f32_32x32x16_bf16 v[48:63], a[12:15], a[232:235], v[48:63]
    ds_write_b128 v8, v[64:67] offset:8192
    s_waitcnt vmcnt(2)
    v_mfma_f32_32x32x16_bf16 v[48:63], a[36:39], a[144:147], v[48:63]
    ds_write_b128 v8, v[68:71] offset:9216
    s_waitcnt vmcnt(1)
    v_mfma_f32_32x32x16_bf16 v[48:63], a[44:47], a[152:155], v[48:63]
    ds_write_b128 v8, v[72:75] offset:10240
    s_waitcnt vmcnt(0)
    v_mfma_f32_32x32x16_bf16 v[48:63], a[68:71], a[176:179], v[48:63]
    ds_write_b128 v8, v[76:79] offset:11264
    v_mfma_f32_32x32x16_bf16 v[32:47], a[0:3], a[228:231], v[32:47]
    s_nop 4
    v_mfma_f32_32x32x16_bf16 v[32:47], a[8:11], a[236:239], v[32:47]
    s_nop 4
    v_mfma_f32_32x32x16_bf16 v[32:47], a[32:35], a[148:151], v[32:47]
    ds_write_b128 v8, v[48:51] offset:4096
    v_mfma_f32_32x32x16_bf16 v[32:47], a[40:43], a[156:159], v[32:47]
    buffer_load_dword v5, v15, s[8:11], s46 offen offset:640 sc1
    ds_write_b128 v8, v[52:55] offset:5120
    v_mfma_f32_32x32x16_bf16 v[32:47], a[64:67], a[180:183], v[32:47]
    ds_write_b128 v8, v[56:59] offset:6144
    v_mfma_f32_32x32x16_bf16 v[16:31], a[0:3], a[224:227], v[16:31]
    ds_write_b128 v8, v[60:63] offset:7168
    v_mfma_f32_32x32x16_bf16 v[16:31], a[8:11], a[232:235], v[16:31]
    s_nop 4
    v_mfma_f32_32x32x16_bf16 v[16:31], a[32:35], a[144:147], v[16:31]
    s_nop 4
    v_mfma_f32_32x32x16_bf16 v[16:31], a[40:43], a[152:155], v[16:31]
    ds_write_b128 v8, v[32:35] offset:0
    v_mfma_f32_32x32x16_bf16 v[16:31], a[64:67], a[176:179], v[16:31]
    ds_write_b128 v8, v[36:39] offset:1024
    ds_write_b128 v8, v[40:43] offset:2048
    ds_write_b128 v8, v[44:47] offset:3072
    s_waitcnt lgkmcnt(0)
    s_barrier
    ds_read_b128 v[128:131], v9 offset:0
    ds_read_b128 v[144:147], v10 offset:4096
    ds_read_b128 v[160:163], v11 offset:8192
    ds_read_b128 v[132:135], v9 offset:1024
    ds_read_b128 v[148:151], v10 offset:5120
    ds_read_b128 v[164:167], v11 offset:9216
    ds_read_b128 v[136:139], v9 offset:2048
    ds_read_b128 v[152:155], v10 offset:6144
    ds_read_b128 v[168:171], v11 offset:10240
    ds_read_b128 v[140:143], v9 offset:3072
    ds_read_b128 v[156:159], v10 offset:7168
    ds_read_b128 v[172:175], v11 offset:11264
    s_waitcnt vmcnt(0)
    v_cmp_ne_u32 vcc, v7, v5
    s_nop 0
    s_cbranch_vccnz L_late_24
L_ok_25:
    s_waitcnt lgkmcnt(11)
    v_pk_add_f32 v[16:17], v[16:17], v[128:129]
    s_waitcnt lgkmcnt(9)
    v_pk_add_f32 v[144:145], v[144:145], v[160:161]
    v_pk_add_f32 v[16:17], v[16:17], v[144:145]
    v_pk_fma_f32 v[16:17], v[16:17], v[96:97], v[80:81]
    v_cvt_pk_bf16_f32 v32, v16, v17
    v_pk_add_f32 v[18:19], v[18:19], v[130:131]
    v_pk_add_f32 v[146:147], v[146:147], v[162:163]
    v_pk_add_f32 v[18:19], v[18:19], v[146:147]
    v_pk_fma_f32 v[18:19], v[18:19], v[98:99], v[82:83]
    v_cvt_pk_bf16_f32 v33, v18, v19
    s_waitcnt lgkmcnt(8)
    v_pk_add_f32 v[20:21], v[20:21], v[132:133]
    s_waitcnt lgkmcnt(6)
    v_pk_add_f32 v[148:149], v[148:149], v[164:165]
    v_pk_add_f32 v[20:21], v[20:21], v[148:149]
    v_pk_fma_f32 v[20:21], v[20:21], v[100:101], v[84:85]
    v_cvt_pk_bf16_f32 v34, v20, v21
    v_pk_add_f32 v[22:23], v[22:23], v[134:135]
    v_pk_add_f32 v[150:151], v[150:151], v[166:167]
    v_pk_add_f32 v[22:23], v[22:23], v[150:151]
    v_pk_fma_f32 v[22:23], v[22:23], v[102:103], v[86:87]
    v_cvt_pk_bf16_f32 v35, v22, v23
    v_permlane32_swap_b32 v32, v34
    s_nop 0
    v_permlane32_swap_b32 v33, v35
    buffer_store_dwordx4 v[32:35], v0, s[24:27], s52 offen offset:0
    s_waitcnt lgkmcnt(5)
    v_pk_add_f32 v[24:25], v[24:25], v[136:137]
    s_waitcnt lgkmcnt(3)
    v_pk_add_f32 v[152:153], v[152:153], v[168:169]
    v_pk_add_f32 v[24:25], v[24:25], v[152:153]
    v_pk_fma_f32 v[24:25], v[24:25], v[104:105], v[88:89]
    v_cvt_pk_bf16_f32 v36, v24, v25
    v_pk_add_f32 v[26:27], v[26:27], v[138:139]
    v_pk_add_f32 v[154:155], v[154:155], v[170:171]
    v_pk_add_f32 v[26:27], v[26:27], v[154:155]
    v_pk_fma_f32 v[26:27], v[26:27], v[106:107], v[90:91]
    v_cvt_pk_bf16_f32 v37, v26, v27
    s_waitcnt lgkmcnt(2)
    v_pk_add_f32 v[28:29], v[28:29], v[140:141]
    s_waitcnt lgkmcnt(0)
    v_pk_add_f32 v[156:157], v[156:157], v[172:173]
    v_pk_add_f32 v[28:29], v[28:29], v[156:157]
    v_pk_fma_f32 v[28:29], v[28:29], v[108:109], v[92:93]
    v_cvt_pk_bf16_f32 v38, v28, v29
    v_pk_add_f32 v[30:31], v[30:31], v[142:143]
    v_pk_add_f32 v[158:159], v[158:159], v[174:175]
    v_pk_add_f32 v[30:31], v[30:31], v[158:159]
    v_pk_fma_f32 v[30:31], v[30:31], v[110:111], v[94:95]
    v_cvt_pk_bf16_f32 v39, v30, v31
    v_permlane32_swap_b32 v36, v38
    s_nop 0
    v_permlane32_swap_b32 v37, v39
    buffer_store_dwordx4 v[36:39], v0, s[24:27], s52 offen offset:32
    s_endpgm
L_late_15:
    s_mov_b32 s3, 0
L_lspin_17:
    buffer_load_dword v5, v15, s[8:11], s46 offen offset:256 sc1
    s_waitcnt vmcnt(0)
    v_cmp_ne_u32 vcc, v7, v5
    s_nop 0
    s_cbranch_vccz L_ok_16
    s_add_u32 s3, s3, 1
    s_cmp_lt_u32 s3, 262144
    s_cbranch_scc1 L_lspin_17
    s_branch L_ok_16
L_late_18:
    s_mov_b32 s3, 0
L_lspin_20:
    buffer_load_dword v5, v15, s[8:11], s46 offen offset:384 sc1
    s_waitcnt vmcnt(0)
    v_cmp_ne_u32 vcc, v7, v5
    s_nop 0
    s_cbranch_vccz L_ok_19
    s_add_u32 s3, s3, 1
    s_cmp_lt_u32 s3, 262144
    s_cbranch_scc1 L_lspin_20
    s_branch L_ok_19
L_late_21:
    s_mov_b32 s3, 0
L_lspin_23:
    buffer_load_dword v5, v3, s[8:11], s61 offen offset:512 sc1
    s_waitcnt vmcnt(0)
    v_cmp_ne_u32 vcc, v7, v5
    s_nop 0
    s_cbranch_vccz L_ok_22
    s_add_u32 s3, s3, 1
    s_cmp_lt_u32 s3, 262144
    s_cbranch_scc1 L_lspin_23
    s_branch L_ok_22
L_no_unit2:
    buffer_load_dwordx4 v1, s[4:7], s54 offen offset:1024 lds
    s_waitcnt vmcnt(5)
    v_cmp_ne_u32 vcc, v7, v5
    s_nop 0
    s_cbranch_vccnz L_late_1001
L_ok_1002:
    buffer_load_dwordx4 a[96:99], v2, s[8:11], s56 offen sc1
    v_max_f32 v48, 0, v48
    v_max_f32 v49, 0, v49
    v_max_f32 v50, 0, v50
    v_max_f32 v51, 0, v51
    buffer_load_dwordx4 a[100:103], v2, s[8:11], s57 offen sc1
    s_add_u32 s56, s56, 4096
    v_max_f32 v52, 0, v52
    v_max_f32 v53, 0, v53
    v_max_f32 v54, 0, v54
    v_max_f32 v55, 0, v55
    v_mul_f32 v48, v48, v56
    buffer_load_dwordx4 a[104:107], v2, s[8:11], s56 offen sc1
    s_add_u32 s57, s57, 4096
    v_mul_f32 v49, v49, v57
    v_mul_f32 v50, v50, v58
    v_mul_f32 v51, v51, v59
    v_mul_f32 v52, v52, v60
    v_mul_f32 v53, v53, v61
    buffer_load_dwordx4 a[108:111], v2, s[8:11], s57 offen sc1
    s_add_u32 s56, s56, 4096
    v_mul_f32 v54, v54, v62
    v_mul_f32 v55, v55, v63
    v_cvt_pk_bf16_f32 v8, v48, v49
    v_cvt_pk_bf16_f32 v9, v50, v51
    v_cvt_pk_bf16_f32 v10, v52, v53
    buffer_load_dwordx4 a[16:19], v2, s[8:11], s56 offen sc1
    s_add_u32 s57, s57, 4096
    v_cvt_pk_bf16_f32 v11, v54, v55
    buffer_store_dwordx4 v[8:11], v2, s[68:71], s63 offen
    buffer_load_dwordx4 a[20:23], v2, s[8:11], s57 offen sc1
    s_add_u32 s56, s56, 4096
    buffer_store_dwordx4 v[8:11], v2, s[72:75], s63 offen sc1
    v_max_f32 v64, 0, v64
    buffer_load_dwordx4 a[24:27], v2, s[8:11], s56 offen sc1
    s_add_u32 s57, s57, 4096
    v_max_f32 v65, 0, v65
    v_max_f32 v66, 0, v66
    v_max_f32 v67, 0, v67
    v_max_f32 v68, 0, v68
    v_max_f32 v69, 0, v69
    buffer_load_dwordx4 a[28:31], v2, s[8:11], s57 offen sc1
    s_add_u32 s56, s56, 4096
    v_max_f32 v70, 0, v70
    v_max_f32 v71, 0, v71
    v_mul_f32 v64, v64, v72
    v_mul_f32 v65, v65, v73
    v_mul_f32 v66, v66, v74
    buffer_load_dwordx4 a[48:51], v2, s[8:11], s56 offen sc1
    s_add_u32 s57, s57, 4096
    v_mul_f32 v67, v67, v75
    v_mul_f32 v68, v68, v76
    v_mul_f32 v69, v69, v77
    v_mul_f32 v70, v70, v78
    v_mul_f32 v71, v71, v79
    buffer_load_dwordx4 a[52:55], v2, s[8:11], s57 offen sc1
    s_add_u32 s56, s56, 4096
    v_cvt_pk_bf16_f32 v8, v64, v65
    v_cvt_pk_bf16_f32 v9, v66, v67
    v_cvt_pk_bf16_f32 v10, v68, v69
    v_cvt_pk_bf16_f32 v11, v70, v71
    buffer_load_dwordx4 a[56:59], v2, s[8:11], s56 offen sc1
    s_add_u32 s57, s57, 4096
    buffer_store_dwordx4 v[8:11], v2, s[68:71], s64 offen
    buffer_load_dwordx4 a[60:63], v2, s[8:11], s57 offen sc1
    s_add_u32 s56, s56, 4096
    buffer_store_dwordx4 v[8:11], v2, s[72:75], s64 offen sc1
    buffer_load_dwordx4 a[80:83], v2, s[8:11], s56 offen sc1
    s_add_u32 s57, s57, 4096
    ds_read_b64_tr_b16 a[0:1], v13 offset:0
    ds_read_b64_tr_b16 a[2:3], v13 offset:1024
    buffer_load_dwordx4 a[84:87], v2, s[8:11], s57 offen sc1
    s_add_u32 s56, s56, 4096
    ds_read_b64_tr_b16 a[4:5], v14 offset:0
    ds_read_b64_tr_b16 a[6:7], v14 offset:1024
    buffer_load_dwordx4 a[88:91], v2, s[8:11], s56 offen sc1
    s_add_u32 s57, s57, 4096
    ds_read_b64_tr_b16 a[8:9], v13 offset:2048
    ds_read_b64_tr_b16 a[10:11], v13 offset:3072
    buffer_load_dwordx4 a[92:95], v2, s[8:11], s57 offen sc1
    s_add_u32 s56, s56, 4290744320
    ds_read_b64_tr_b16 a[12:13], v14 offset:2048
    ds_read_b64_tr_b16 a[14:15], v14 offset:3072
    ds_read_b64_tr_b16 a[32:33], v13 offset:4096
    ds_read_b64_tr_b16 a[34:35], v13 offset:5120
    ds_read_b64_tr_b16 a[36:37], v14 offset:4096
    ds_read_b64_tr_b16 a[38:39], v14 offset:5120
    s_waitcnt vmcnt(24)
    ds_read_b64_tr_b16 a[40:41], v13 offset:6144
    ds_read_b64_tr_b16 a[42:43], v13 offset:7168
    ds_read_b64_tr_b16 a[44:45], v14 offset:6144
    ds_read_b64_tr_b16 a[46:47], v14 offset:7168
    s_waitcnt vmcnt(22)
    ds_read_b64_tr_b16 a[64:65], v13 offset:8192
    ds_read_b64_tr_b16 a[66:67], v13 offset:9216
    ds_read_b64_tr_b16 a[68:69], v14 offset:8192
    ds_read_b64_tr_b16 a[70:71], v14 offset:9216
    s_waitcnt vmcnt(20)
    ds_read_b64_tr_b16 a[72:73], v13 offset:10240
    ds_read_b64_tr_b16 a[74:75], v13 offset:11264
    ds_read_b64_tr_b16 a[76:77], v14 offset:10240
    ds_read_b64_tr_b16 a[78:79], v14 offset:11264
    s_waitcnt vmcnt(0)
    buffer_store_dword v7, off, s[12:15], s60 offset:384
    buffer_store_dword v7, off, s[16:19], s60 offset:384 sc1
    buffer_load_dword v5, v15, s[8:11], s46 offen offset:384 sc1
    s_mov_b32 s58, 33554432
    s_mov_b32 s59, 33554432
    s_branch L_up_done
L_late_1001:
    s_mov_b32 s3, 0
L_lspin_1003:
    buffer_load_dword v5, v15, s[8:11], s46 offen offset:256 sc1
    s_waitcnt vmcnt(0)
    v_cmp_ne_u32 vcc, v7, v5
    s_nop 0
    s_cbranch_vccz L_ok_1002
    s_add_u32 s3, s3, 1
    s_cmp_lt_u32 s3, 262144
    s_cbranch_scc1 L_lspin_1003
    s_branch L_ok_1002
L_late_24:
    s_mov_b32 s3, 0
L_lspin_26:
    buffer_load_dword v5, v15, s[8:11], s46 offen offset:640 sc1
    s_waitcnt vmcnt(0)
    v_cmp_ne_u32 vcc, v7, v5
    s_nop 0
    s_cbranch_vccz L_ok_25
    s_add_u32 s3, s3, 1
    s_cmp_lt_u32 s3, 262144
    s_cbranch_scc1 L_lspin_26
    s_branch L_ok_25
L_end:
    s_endpgm
.section .rodata,"a"
.p2align 6
.amdhsa_kernel adaLN_cond__grouped_kv_mqa__glu_gated_reglu__prompt_kernel
  .amdhsa_next_free_vgpr 512
  .amdhsa_next_free_sgpr 76
  .amdhsa_accum_offset 256
  .amdhsa_group_segment_fixed_size 0
  .amdhsa_kernarg_size 112
  .amdhsa_user_sgpr_count 2
  .amdhsa_user_sgpr_kernarg_segment_ptr 1
  .amdhsa_system_sgpr_workgroup_id_x 1
  .amdhsa_float_denorm_mode_32 3
.end_amdhsa_kernel
```
